```python
import torch

def _softmax(x, axis=-1):
    return torch.softmax(x, dim=axis)

def _gelu(x):
    return torch.nn.functional.gelu(x, approximate='tanh')

def _silu(x):
    return torch.nn.functional.silu(x)

def _sigmoid(x):
    return torch.sigmoid(x)

def _layernorm(x, axis=-1, eps=1e-05):
    m = x.mean(dim=axis, keepdim=True)
    v = x.var(dim=axis, keepdim=True, unbiased=False)
    return (x - m) / torch.sqrt(v + eps)

def _scatter_add(tgt, idx, src, axis=0):
    return tgt.clone().index_add_(axis, idx, src)

def _segment_sum(src, seg, n):
    out = torch.zeros((n,) + src.shape[1:], dtype=src.dtype)
    return out.index_add_(0, seg, src)

def _pad(x, pw):
    flat = tuple((v for pair in reversed(pw) for v in pair))
    return torch.nn.functional.pad(x, flat)
kernel_name = 'adaLN_cond__grouped_kv_mqa__mixer_gmlp__prompt'

def setup_inputs():

    _w = lambda a: (lambda t: t.to(torch.bfloat16) if t.is_floating_point() else t)(torch.as_tensor(a))

    def _A_setup():
        B, S, D, H = (1, 2048, 640, 32)
        Dh = D // H
        return {'x': _w((lambda *s: torch.randn(*s, dtype=torch.bfloat16) * 0.05)(B, S, D)), 'wq': _w((lambda *s: torch.randn(*s, dtype=torch.bfloat16) * 0.05)(D, H * Dh)), 'wk': _w((lambda *s: torch.randn(*s, dtype=torch.bfloat16) * 0.05)(D, Dh)), 'wv': _w((lambda *s: torch.randn(*s, dtype=torch.bfloat16) * 0.05)(D, Dh)), 'wo': _w((lambda *s: torch.randn(*s, dtype=torch.bfloat16) * 0.05)(H * Dh, D))}
    _A_in = _A_setup()

    def _B_setup():
        B, S, D, F = (1, 2048, 640, 1536)
        Fh = F // 2
        return {'x': _w((lambda *s: torch.randn(*s, dtype=torch.bfloat16) * 0.05)(B, S, D)), 'w_in': _w((lambda *s: torch.randn(*s, dtype=torch.bfloat16) * 0.4)(D, 2 * Fh)), 'w_sp': _w(0.01 * (lambda *s: torch.randn(*s, dtype=torch.bfloat16) * 0.4)(S, S)), 'b_sp': _w(1.0 + 0.01 * (lambda *s: torch.randn(*s, dtype=torch.bfloat16) * 0.05)(S)), 'w_out': _w((lambda *s: torch.randn(*s, dtype=torch.bfloat16) * 0.05)(Fh, D))}
    _B_in = _B_setup()
    return {'A_x': _A_in['x'], 'A_wq': _A_in['wq'], 'A_wk': _A_in['wk'], 'A_wv': _A_in['wv'], 'A_wo': _A_in['wo'], 'B_x': _B_in['x'], 'B_w_in': _B_in['w_in'], 'B_w_sp': _B_in['w_sp'], 'B_b_sp': _B_in['b_sp'], 'B_w_out': _B_in['w_out'], 'c': _w((lambda *s: torch.randn(*s, dtype=torch.bfloat16) * 0.1)(1, 640) * 8.0), 'w_mod': _w((lambda *s: torch.randn(*s, dtype=torch.bfloat16) * 0.1)(640, 6 * 640) * 640 ** (-0.5) * 8.0)}

def reference(A_x, A_wq, A_wk, A_wv, A_wo, B_x, B_w_in, B_w_sp, B_b_sp, B_w_out, c, w_mod):

    def _A_ref(x, wq, wk, wv, wo):
        B, S, D = x.shape
        H = 32
        Dh = D // H
        q = (lambda x, *d: x.permute(*d))((x @ wq).reshape(B, S, H, Dh), 0, 2, 1, 3)
        k = x @ wk
        v = x @ wv
        scores = torch.einsum('bhqd,bkd->bhqk', q, k) * Dh ** (-0.5)
        p = _softmax(scores, axis=-1)
        o = torch.einsum('bhqk,bkd->bhqd', p, v)
        return (lambda x, *d: x.permute(*d))(o, 0, 2, 1, 3).reshape(B, S, H * Dh) @ wo

    def _B_ref(x, w_in, w_sp, b_sp, w_out):
        B, S, D = x.shape
        F = w_in.shape[-1]
        Fh = F // 2
        z = _gelu(torch.einsum('bsd,df->bsf', x, w_in))
        z1 = z[..., :Fh].clone()
        z2 = _layernorm(z[..., Fh:], axis=-1)
        g = torch.einsum('ts,bsf->btf', w_sp, z2) + b_sp[None, :, None]
        return torch.einsum('bsf,fd->bsd', z1 * g, w_out)
    x = A_x
    mod = (_silu(c) @ w_mod).reshape(c.shape[0], 6, 1, -1)
    sa, ca, ga, sb, cb, gb = (mod[:, 0].clone(), mod[:, 1].clone(), mod[:, 2].clone(), mod[:, 3].clone(), mod[:, 4].clone(), mod[:, 5].clone())
    h = _layernorm(x, axis=-1) * (1 + ca) + sa
    x = x + ga * _A_ref(h, A_wq, A_wk, A_wv, A_wo)
    h = _layernorm(x, axis=-1) * (1 + cb) + sb
    x = x + gb * _B_ref(h, B_w_in, B_w_sp, B_b_sp, B_w_out)
    return x
```

```asm
; @launch grid=(256,1,1) block=(640,1,1) lds=160064
.amdgcn_target "amdgcn-amd-amdhsa--gfx950"
.text
.globl adaLN_cond__grouped_kv_mqa__mixer_gmlp__prompt_kernel
.p2align 8
.type adaLN_cond__grouped_kv_mqa__mixer_gmlp__prompt_kernel,@function
adaLN_cond__grouped_kv_mqa__mixer_gmlp__prompt_kernel:
    s_cmp_ge_u32 s2, 256
    s_cbranch_scc1 L_k_exit
    s_load_dwordx2 s[4:5], s[0:1], 112
    s_load_dwordx2 s[44:45], s[0:1], 96
    s_load_dwordx4 s[56:59], s[0:1], 48
    s_load_dwordx2 s[52:53], s[0:1], 32
    s_load_dwordx2 s[54:55], s[0:1], 72
    s_load_dwordx2 s[60:61], s[0:1], 0
    s_load_dwordx2 s[62:63], s[0:1], 64
    v_and_b32 v4, 63, v0
    v_lshrrev_b32 v5, 6, v0
    v_lshlrev_b32 v1, 4, v4
    v_readfirstlane_b32 s14, v5
    v_and_b32 v2, 31, v4
    v_lshrrev_b32 v3, 5, v4
    s_and_b32 s12, s2, 7
    s_lshr_b32 s3, s2, 6
    s_lshl_b32 s3, s3, 3
    s_add_u32 s12, s12, s3
    s_bfe_u32 s13, s2, 0x30003
    s_mov_b32 s27, 0
    s_mov_b32 s37, 0
    s_cmp_ge_u32 s14, 4
    s_cbranch_scc1 L_k_p0other
    s_cmp_lt_u32 s13, 4
    s_cbranch_scc1 L_k_pq
    s_load_dwordx4 s[16:19], s[0:1], 80
    s_sub_u32 s6, s13, 4
    s_lshr_b32 s3, s6, 1
    s_lshl_b32 s3, s3, 5
    s_add_u32 s3, s3, s12
    s_lshl_b32 s3, s3, 1
    s_and_b32 s6, s6, 1
    s_add_u32 s3, s3, s6
    v_lshrrev_b32 v72, 2, v0
    v_and_b32 v73, 3, v0
    v_mul_u32_u24 v74, 7680, v72
    v_lshl_add_u32 v74, v73, 4, v74
    v_lshlrev_b32 v4, 1, v72
    s_cmp_lt_u32 s3, 120
    s_cselect_b32 s7, 4915200, 0
    s_waitcnt lgkmcnt(0)
    s_barrier
    s_mov_b32 s8, s4
    s_mov_b32 s9, s5
    s_mov_b32 s10, 0x2500000
    s_mov_b32 s11, 0x20000
    s_mov_b32 s20, s16
    s_mov_b32 s21, s17
    s_mov_b32 s22, 0x500
    s_mov_b32 s23, 0x20000
    s_mov_b32 s40, s18
    s_mov_b32 s41, s19
    s_mov_b32 s42, s7
    s_mov_b32 s43, 0x20000
    s_lshl_b32 s6, s3, 6
    buffer_load_ushort v10, v4, s[20:23], 0 offen offset:0
    buffer_load_ushort v11, v4, s[20:23], 0 offen offset:128
    buffer_load_ushort v12, v4, s[20:23], 0 offen offset:256
    buffer_load_ushort v13, v4, s[20:23], 0 offen offset:384
    buffer_load_ushort v14, v4, s[20:23], 0 offen offset:512
    buffer_load_ushort v15, v4, s[20:23], 0 offen offset:640
    buffer_load_ushort v16, v4, s[20:23], 0 offen offset:768
    buffer_load_ushort v17, v4, s[20:23], 0 offen offset:896
    buffer_load_ushort v18, v4, s[20:23], 0 offen offset:1024
    buffer_load_ushort v19, v4, s[20:23], 0 offen offset:1152
    buffer_load_dwordx4 v[20:23], v74, s[40:43], s6 offen
    s_add_u32 s6, s6, 491520
    buffer_load_dwordx4 v[24:27], v74, s[40:43], s6 offen
    s_add_u32 s6, s6, 491520
    buffer_load_dwordx4 v[28:31], v74, s[40:43], s6 offen
    s_add_u32 s6, s6, 491520
    buffer_load_dwordx4 v[32:35], v74, s[40:43], s6 offen
    s_add_u32 s6, s6, 491520
    buffer_load_dwordx4 v[36:39], v74, s[40:43], s6 offen
    s_add_u32 s6, s6, 491520
    buffer_load_dwordx4 v[40:43], v74, s[40:43], s6 offen
    s_add_u32 s6, s6, 491520
    buffer_load_dwordx4 v[44:47], v74, s[40:43], s6 offen
    s_add_u32 s6, s6, 491520
    buffer_load_dwordx4 v[48:51], v74, s[40:43], s6 offen
    s_add_u32 s6, s6, 491520
    buffer_load_dwordx4 v[52:55], v74, s[40:43], s6 offen
    s_add_u32 s6, s6, 491520
    buffer_load_dwordx4 v[56:59], v74, s[40:43], s6 offen
    v_mov_b32 v8, 159832
    v_mov_b32 v9, 1
    s_mov_b64 exec, 1
    ds_add_u32 v8, v9
    s_mov_b64 exec, -1
    v_mov_b32 v64, 0
    v_mov_b32 v65, 0
    v_mov_b32 v66, 0
    v_mov_b32 v67, 0
    v_mov_b32 v68, 0
    v_mov_b32 v69, 0
    v_mov_b32 v70, 0
    v_mov_b32 v71, 0
    s_waitcnt vmcnt(10)
    v_lshlrev_b32 v10, 16, v10
    v_mul_f32 v5, 0xbfb8aa3b, v10
    v_exp_f32 v5, v5
    s_nop 0
    v_add_f32 v5, 1.0, v5
    v_rcp_f32 v5, v5
    s_nop 0
    v_mul_f32 v10, v10, v5
    v_cvt_pk_bf16_f32 v5, v10, v10
    v_and_b32 v10, 0xffff0000, v5
    v_lshlrev_b32 v11, 16, v11
    v_mul_f32 v5, 0xbfb8aa3b, v11
    v_exp_f32 v5, v5
    s_nop 0
    v_add_f32 v5, 1.0, v5
    v_rcp_f32 v5, v5
    s_nop 0
    v_mul_f32 v11, v11, v5
    v_cvt_pk_bf16_f32 v5, v11, v11
    v_and_b32 v11, 0xffff0000, v5
    v_lshlrev_b32 v12, 16, v12
    v_mul_f32 v5, 0xbfb8aa3b, v12
    v_exp_f32 v5, v5
    s_nop 0
    v_add_f32 v5, 1.0, v5
    v_rcp_f32 v5, v5
    s_nop 0
    v_mul_f32 v12, v12, v5
    v_cvt_pk_bf16_f32 v5, v12, v12
    v_and_b32 v12, 0xffff0000, v5
    v_lshlrev_b32 v13, 16, v13
    v_mul_f32 v5, 0xbfb8aa3b, v13
    v_exp_f32 v5, v5
    s_nop 0
    v_add_f32 v5, 1.0, v5
    v_rcp_f32 v5, v5
    s_nop 0
    v_mul_f32 v13, v13, v5
    v_cvt_pk_bf16_f32 v5, v13, v13
    v_and_b32 v13, 0xffff0000, v5
    v_lshlrev_b32 v14, 16, v14
    v_mul_f32 v5, 0xbfb8aa3b, v14
    v_exp_f32 v5, v5
    s_nop 0
    v_add_f32 v5, 1.0, v5
    v_rcp_f32 v5, v5
    s_nop 0
    v_mul_f32 v14, v14, v5
    v_cvt_pk_bf16_f32 v5, v14, v14
    v_and_b32 v14, 0xffff0000, v5
    v_lshlrev_b32 v15, 16, v15
    v_mul_f32 v5, 0xbfb8aa3b, v15
    v_exp_f32 v5, v5
    s_nop 0
    v_add_f32 v5, 1.0, v5
    v_rcp_f32 v5, v5
    s_nop 0
    v_mul_f32 v15, v15, v5
    v_cvt_pk_bf16_f32 v5, v15, v15
    v_and_b32 v15, 0xffff0000, v5
    v_lshlrev_b32 v16, 16, v16
    v_mul_f32 v5, 0xbfb8aa3b, v16
    v_exp_f32 v5, v5
    s_nop 0
    v_add_f32 v5, 1.0, v5
    v_rcp_f32 v5, v5
    s_nop 0
    v_mul_f32 v16, v16, v5
    v_cvt_pk_bf16_f32 v5, v16, v16
    v_and_b32 v16, 0xffff0000, v5
    v_lshlrev_b32 v17, 16, v17
    v_mul_f32 v5, 0xbfb8aa3b, v17
    v_exp_f32 v5, v5
    s_nop 0
    v_add_f32 v5, 1.0, v5
    v_rcp_f32 v5, v5
    s_nop 0
    v_mul_f32 v17, v17, v5
    v_cvt_pk_bf16_f32 v5, v17, v17
    v_and_b32 v17, 0xffff0000, v5
    v_lshlrev_b32 v18, 16, v18
    v_mul_f32 v5, 0xbfb8aa3b, v18
    v_exp_f32 v5, v5
    s_nop 0
    v_add_f32 v5, 1.0, v5
    v_rcp_f32 v5, v5
    s_nop 0
    v_mul_f32 v18, v18, v5
    v_cvt_pk_bf16_f32 v5, v18, v18
    v_and_b32 v18, 0xffff0000, v5
    v_lshlrev_b32 v19, 16, v19
    v_mul_f32 v5, 0xbfb8aa3b, v19
    v_exp_f32 v5, v5
    s_nop 0
    v_add_f32 v5, 1.0, v5
    v_rcp_f32 v5, v5
    s_nop 0
    v_mul_f32 v19, v19, v5
    v_cvt_pk_bf16_f32 v5, v19, v19
    v_and_b32 v19, 0xffff0000, v5
    s_waitcnt vmcnt(9)
    v_lshlrev_b32 v5, 16, v20
    v_and_b32 v6, 0xffff0000, v20
    v_fmac_f32 v64, v10, v5
    v_fmac_f32 v65, v10, v6
    v_lshlrev_b32 v5, 16, v21
    v_and_b32 v6, 0xffff0000, v21
    v_fmac_f32 v66, v10, v5
    v_fmac_f32 v67, v10, v6
    v_lshlrev_b32 v5, 16, v22
    v_and_b32 v6, 0xffff0000, v22
    v_fmac_f32 v68, v10, v5
    v_fmac_f32 v69, v10, v6
    v_lshlrev_b32 v5, 16, v23
    v_and_b32 v6, 0xffff0000, v23
    v_fmac_f32 v70, v10, v5
    v_fmac_f32 v71, v10, v6
    s_waitcnt vmcnt(8)
    v_lshlrev_b32 v5, 16, v24
    v_and_b32 v6, 0xffff0000, v24
    v_fmac_f32 v64, v11, v5
    v_fmac_f32 v65, v11, v6
    v_lshlrev_b32 v5, 16, v25
    v_and_b32 v6, 0xffff0000, v25
    v_fmac_f32 v66, v11, v5
    v_fmac_f32 v67, v11, v6
    v_lshlrev_b32 v5, 16, v26
    v_and_b32 v6, 0xffff0000, v26
    v_fmac_f32 v68, v11, v5
    v_fmac_f32 v69, v11, v6
    v_lshlrev_b32 v5, 16, v27
    v_and_b32 v6, 0xffff0000, v27
    v_fmac_f32 v70, v11, v5
    v_fmac_f32 v71, v11, v6
    s_waitcnt vmcnt(7)
    v_lshlrev_b32 v5, 16, v28
    v_and_b32 v6, 0xffff0000, v28
    v_fmac_f32 v64, v12, v5
    v_fmac_f32 v65, v12, v6
    v_lshlrev_b32 v5, 16, v29
    v_and_b32 v6, 0xffff0000, v29
    v_fmac_f32 v66, v12, v5
    v_fmac_f32 v67, v12, v6
    v_lshlrev_b32 v5, 16, v30
    v_and_b32 v6, 0xffff0000, v30
    v_fmac_f32 v68, v12, v5
    v_fmac_f32 v69, v12, v6
    v_lshlrev_b32 v5, 16, v31
    v_and_b32 v6, 0xffff0000, v31
    v_fmac_f32 v70, v12, v5
    v_fmac_f32 v71, v12, v6
    s_waitcnt vmcnt(6)
    v_lshlrev_b32 v5, 16, v32
    v_and_b32 v6, 0xffff0000, v32
    v_fmac_f32 v64, v13, v5
    v_fmac_f32 v65, v13, v6
    v_lshlrev_b32 v5, 16, v33
    v_and_b32 v6, 0xffff0000, v33
    v_fmac_f32 v66, v13, v5
    v_fmac_f32 v67, v13, v6
    v_lshlrev_b32 v5, 16, v34
    v_and_b32 v6, 0xffff0000, v34
    v_fmac_f32 v68, v13, v5
    v_fmac_f32 v69, v13, v6
    v_lshlrev_b32 v5, 16, v35
    v_and_b32 v6, 0xffff0000, v35
    v_fmac_f32 v70, v13, v5
    v_fmac_f32 v71, v13, v6
    s_waitcnt vmcnt(5)
    v_lshlrev_b32 v5, 16, v36
    v_and_b32 v6, 0xffff0000, v36
    v_fmac_f32 v64, v14, v5
    v_fmac_f32 v65, v14, v6
    v_lshlrev_b32 v5, 16, v37
    v_and_b32 v6, 0xffff0000, v37
    v_fmac_f32 v66, v14, v5
    v_fmac_f32 v67, v14, v6
    v_lshlrev_b32 v5, 16, v38
    v_and_b32 v6, 0xffff0000, v38
    v_fmac_f32 v68, v14, v5
    v_fmac_f32 v69, v14, v6
    v_lshlrev_b32 v5, 16, v39
    v_and_b32 v6, 0xffff0000, v39
    v_fmac_f32 v70, v14, v5
    v_fmac_f32 v71, v14, v6
    s_waitcnt vmcnt(4)
    v_lshlrev_b32 v5, 16, v40
    v_and_b32 v6, 0xffff0000, v40
    v_fmac_f32 v64, v15, v5
    v_fmac_f32 v65, v15, v6
    v_lshlrev_b32 v5, 16, v41
    v_and_b32 v6, 0xffff0000, v41
    v_fmac_f32 v66, v15, v5
    v_fmac_f32 v67, v15, v6
    v_lshlrev_b32 v5, 16, v42
    v_and_b32 v6, 0xffff0000, v42
    v_fmac_f32 v68, v15, v5
    v_fmac_f32 v69, v15, v6
    v_lshlrev_b32 v5, 16, v43
    v_and_b32 v6, 0xffff0000, v43
    v_fmac_f32 v70, v15, v5
    v_fmac_f32 v71, v15, v6
    s_waitcnt vmcnt(3)
    v_lshlrev_b32 v5, 16, v44
    v_and_b32 v6, 0xffff0000, v44
    v_fmac_f32 v64, v16, v5
    v_fmac_f32 v65, v16, v6
    v_lshlrev_b32 v5, 16, v45
    v_and_b32 v6, 0xffff0000, v45
    v_fmac_f32 v66, v16, v5
    v_fmac_f32 v67, v16, v6
    v_lshlrev_b32 v5, 16, v46
    v_and_b32 v6, 0xffff0000, v46
    v_fmac_f32 v68, v16, v5
    v_fmac_f32 v69, v16, v6
    v_lshlrev_b32 v5, 16, v47
    v_and_b32 v6, 0xffff0000, v47
    v_fmac_f32 v70, v16, v5
    v_fmac_f32 v71, v16, v6
    s_waitcnt vmcnt(2)
    v_lshlrev_b32 v5, 16, v48
    v_and_b32 v6, 0xffff0000, v48
    v_fmac_f32 v64, v17, v5
    v_fmac_f32 v65, v17, v6
    v_lshlrev_b32 v5, 16, v49
    v_and_b32 v6, 0xffff0000, v49
    v_fmac_f32 v66, v17, v5
    v_fmac_f32 v67, v17, v6
    v_lshlrev_b32 v5, 16, v50
    v_and_b32 v6, 0xffff0000, v50
    v_fmac_f32 v68, v17, v5
    v_fmac_f32 v69, v17, v6
    v_lshlrev_b32 v5, 16, v51
    v_and_b32 v6, 0xffff0000, v51
    v_fmac_f32 v70, v17, v5
    v_fmac_f32 v71, v17, v6
    s_waitcnt vmcnt(1)
    v_lshlrev_b32 v5, 16, v52
    v_and_b32 v6, 0xffff0000, v52
    v_fmac_f32 v64, v18, v5
    v_fmac_f32 v65, v18, v6
    v_lshlrev_b32 v5, 16, v53
    v_and_b32 v6, 0xffff0000, v53
    v_fmac_f32 v66, v18, v5
    v_fmac_f32 v67, v18, v6
    v_lshlrev_b32 v5, 16, v54
    v_and_b32 v6, 0xffff0000, v54
    v_fmac_f32 v68, v18, v5
    v_fmac_f32 v69, v18, v6
    v_lshlrev_b32 v5, 16, v55
    v_and_b32 v6, 0xffff0000, v55
    v_fmac_f32 v70, v18, v5
    v_fmac_f32 v71, v18, v6
    s_waitcnt vmcnt(0)
    v_lshlrev_b32 v5, 16, v56
    v_and_b32 v6, 0xffff0000, v56
    v_fmac_f32 v64, v19, v5
    v_fmac_f32 v65, v19, v6
    v_lshlrev_b32 v5, 16, v57
    v_and_b32 v6, 0xffff0000, v57
    v_fmac_f32 v66, v19, v5
    v_fmac_f32 v67, v19, v6
    v_lshlrev_b32 v5, 16, v58
    v_and_b32 v6, 0xffff0000, v58
    v_fmac_f32 v68, v19, v5
    v_fmac_f32 v69, v19, v6
    v_lshlrev_b32 v5, 16, v59
    v_and_b32 v6, 0xffff0000, v59
    v_fmac_f32 v70, v19, v5
    v_fmac_f32 v71, v19, v6
    v_lshlrev_b32 v5, 7, v72
    v_lshl_add_u32 v5, v73, 5, v5
    v_add_u32 v5, 131072, v5
    ds_write_b128 v5, v[64:67]
    ds_write_b128 v5, v[68:71] offset:16
    v_and_b32 v6, 31, v0
    v_lshrrev_b32 v7, 5, v0
    v_lshlrev_b32 v6, 2, v6
    v_add_u32 v11, 131072, v6
    v_lshl_add_u32 v10, v7, 10, v11
    s_mov_b32 s19, s3
    v_mov_b32 v8, 159820
    v_mov_b32 v9, 1
    s_mov_b64 exec, 1
    s_waitcnt lgkmcnt(0)
    ds_add_u32 v8, v9
    s_mov_b64 exec, -1
    v_mov_b32 v8, 159820
L_k_lw_1:
    ds_read_b32 v9, v8
    s_waitcnt lgkmcnt(0)
    v_readfirstlane_b32 s3, v9
    s_cmp_lt_u32 s3, 4
    s_cbranch_scc1 L_k_lw_1
    ds_read_b32 v20, v10 offset:0
    ds_read_b32 v21, v10 offset:128
    ds_read_b32 v22, v10 offset:256
    ds_read_b32 v23, v10 offset:384
    ds_read_b32 v24, v10 offset:512
    ds_read_b32 v25, v10 offset:640
    ds_read_b32 v26, v10 offset:768
    ds_read_b32 v27, v10 offset:896
    s_waitcnt lgkmcnt(0)
    v_add_f32 v20, v20, v21
    v_add_f32 v20, v20, v22
    v_add_f32 v20, v20, v23
    v_add_f32 v20, v20, v24
    v_add_f32 v20, v20, v25
    v_add_f32 v20, v20, v26
    v_add_f32 v20, v20, v27
    v_lshl_add_u32 v10, v7, 7, v11
    ds_write_b32 v10, v20 offset:8192
    v_mov_b32 v8, 159824
    v_mov_b32 v9, 1
    s_mov_b64 exec, 1
    s_waitcnt lgkmcnt(0)
    ds_add_u32 v8, v9
    s_mov_b64 exec, -1
    v_mov_b32 v8, 159824
L_k_lw_2:
    ds_read_b32 v9, v8
    s_waitcnt lgkmcnt(0)
    v_readfirstlane_b32 s3, v9
    s_cmp_lt_u32 s3, 4
    s_cbranch_scc1 L_k_lw_2
    v_mov_b32 v8, 159996
L_k_lw_3:
    ds_read_b32 v9, v8
    s_waitcnt lgkmcnt(0)
    v_readfirstlane_b32 s3, v9
    s_cmp_lt_u32 s3, 1
    s_cbranch_scc1 L_k_lw_3
    s_mov_b32 s50, s3
    s_mov_b32 s3, s19
    s_lshl_b32 s38, s3, 7
    s_add_u32 s38, s38, 0x40000
    s_cmp_lg_u32 s14, 0
    s_cbranch_scc1 L_k_xf0
    ds_read_b32 v20, v11 offset:8192
    ds_read_b32 v21, v11 offset:8320
    ds_read_b32 v22, v11 offset:8448
    ds_read_b32 v23, v11 offset:8576
    ds_read_b32 v24, v11 offset:8704
    ds_read_b32 v25, v11 offset:8832
    ds_read_b32 v26, v11 offset:8960
    ds_read_b32 v27, v11 offset:9088
    s_waitcnt lgkmcnt(0)
    v_add_f32 v20, v20, v21
    v_add_f32 v20, v20, v22
    v_add_f32 v20, v20, v23
    v_add_f32 v20, v20, v24
    v_add_f32 v20, v20, v25
    v_add_f32 v20, v20, v26
    v_add_f32 v20, v20, v27
    v_cvt_pk_bf16_f32 v5, v20, v20
    v_and_b32 v20, 0xffff0000, v5
    v_add_f32 v21, 1.0, v20
    v_cvt_pk_bf16_f32 v5, v21, v21
    v_and_b32 v21, 0xffff0000, v5
    s_sub_u32 s6, s3, 20
    s_cmp_lt_u32 s6, 20
    s_cselect_b32 s7, 1, 0
    s_sub_u32 s6, s3, 80
    s_cmp_lt_u32 s6, 20
    s_cselect_b32 s6, 1, s7
    s_cmp_eq_u32 s6, 0
    s_cbranch_scc1 L_k_noinc_4
    v_mov_b32 v20, v21
L_k_noinc_4:
    s_lshl_b32 s6, s3, 7
    s_cmp_ge_u32 s3, 120
    s_cbranch_scc1 L_k_xf0
    s_mov_b32 exec_hi, 0
    s_lshr_b32 s7, s50, 16
    s_and_b32 s18, s50, 0xffff
    v_mov_b32 v21, s7
    v_mov_b32 v22, s18
    v_and_b32 v23, 4, v6
    v_cmp_eq_u32 vcc, 0, v23
    s_add_u32 s7, s6, 0x4000
    s_nop 0
    v_cndmask_b32 v21, v21, v22, vcc
    v_or_b32 v21, v21, v20
    buffer_store_dword v21, v6, s[8:11], s7 offen sc1
    buffer_store_dword v20, v6, s[8:11], s6 offen offset:0 sc1
    s_mov_b32 exec_hi, -1
    v_mov_b32 v8, 0
    v_mov_b32 v9, s50
    s_mov_b64 exec, 1
    s_waitcnt vmcnt(0)
    s_cmp_eq_u32 s37, 1
    s_cbranch_scc1 L_k_hs_5
    buffer_store_dword v9, v8, s[8:11], s38 offen sc1
    s_branch L_k_hd_6
L_k_hs_5:
    buffer_store_dword v9, v8, s[8:11], s38 offen
L_k_hd_6:
    s_mov_b64 exec, -1
    s_branch L_k_xf0
L_k_pq:
    s_load_dwordx2 s[16:17], s[0:1], 8
    s_load_dwordx4 s[32:35], s[0:1], 16
    s_lshl_b32 s3, s13, 5
    s_add_u32 s3, s3, s12
    s_and_b32 s19, s3, 7
    s_lshr_b32 s18, s3, 3
    s_lshl_b32 s38, s19, 4
    s_add_u32 s38, s38, s18
    s_lshl_b32 s18, s18, 2
    s_add_u32 s18, s18, s14
    s_lshl_b32 s38, s38, 7
    s_add_u32 s38, s38, 0x44000
    v_and_b32 v4, 15, v2
    v_lshrrev_b32 v5, 4, v2
    v_mul_u32_u24 v5, 20, v5
    v_add_u32 v5, v5, v4
    s_mul_i32 s6, s19, 80
    v_add_u32 v5, s6, v5
    v_lshlrev_b32 v5, 1, v5
    v_mul_u32_u24 v6, 10240, v3
    v_add_u32 v10, v5, v6
    v_add_u32 v11, 80, v10
    v_bfe_u32 v5, v4, 1, 1
    v_lshrrev_b32 v7, 3, v4
    v_lshl_add_u32 v5, v7, 1, v5
    v_mul_u32_u24 v5, 20, v5
    v_bfe_u32 v7, v4, 2, 1
    v_lshl_add_u32 v5, v7, 1, v5
    v_and_b32 v7, 1, v4
    v_add_u32 v5, v5, v7
    v_add_u32 v5, 16, v5
    v_add_u32 v5, s6, v5
    v_lshlrev_b32 v5, 1, v5
    v_add_u32 v12, v5, v6
    v_lshrrev_b32 v5, 2, v4
    v_lshlrev_b32 v5, 1, v5
    v_add_u32 v5, v5, v7
    v_add_u32 v5, 16, v5
    v_and_b32 v8, 10, v4
    v_cmp_eq_u32 vcc, 0, v8
    v_mov_b32 v8, 0x20000000
    s_nop 0
    v_cndmask_b32 v5, v8, v5, vcc
    v_add_u32 v14, 16, v4
    v_cmp_gt_u32 vcc, 4, v4
    s_nop 1
    v_cndmask_b32 v14, v8, v14, vcc
    s_cmp_eq_u32 s19, 3
    s_cselect_b64 vcc, -1, 0
    v_cndmask_b32 v5, v5, v14, vcc
    s_bitcmp1_b32 s19, 0
    s_cselect_b64 vcc, -1, 0
    v_cndmask_b32 v5, v4, v5, vcc
    v_lshlrev_b32 v5, 1, v5
    v_mul_u32_u24 v6, 320, v3
    v_add_u32 v13, v5, v6
    s_waitcnt lgkmcnt(0)
    s_barrier
    s_mov_b32 s8, s4
    s_mov_b32 s9, s5
    s_mov_b32 s10, 0x2500000
    s_mov_b32 s11, 0x20000
    s_mov_b32 s20, s16
    s_mov_b32 s21, s17
    s_mov_b32 s22, 0xc8000
    s_mov_b32 s23, 0x20000
    s_cmp_ge_u32 s3, 80
    s_cbranch_scc1 L_k_pqs_7
    s_cmp_ge_u32 s19, 2
    s_cselect_b32 s32, s34, s32
    s_cselect_b32 s33, s35, s33
    s_cmp_ge_u32 s19, 4
    s_cselect_b32 s7, 0, 25600
    s_mov_b32 s40, s32
    s_mov_b32 s41, s33
    s_mov_b32 s42, s7
    s_mov_b32 s43, 0x20000
    s_mul_i32 s28, s18, 20480
    s_mul_i32 s29, s18, 640
    s_add_u32 s30, s28, 0
    buffer_load_ushort v20, v10, s[20:23], s30 offen
    s_add_u32 s30, s28, 1280
    buffer_load_ushort v44, v10, s[20:23], s30 offen
    s_add_u32 s30, s28, 2560
    buffer_load_ushort v21, v10, s[20:23], s30 offen
    s_add_u32 s30, s28, 3840
    buffer_load_ushort v45, v10, s[20:23], s30 offen
    s_add_u32 s30, s28, 5120
    buffer_load_ushort v22, v10, s[20:23], s30 offen
    s_add_u32 s30, s28, 6400
    buffer_load_ushort v46, v10, s[20:23], s30 offen
    s_add_u32 s30, s28, 7680
    buffer_load_ushort v23, v10, s[20:23], s30 offen
    s_add_u32 s30, s28, 8960
    buffer_load_ushort v47, v10, s[20:23], s30 offen
    s_add_u32 s30, s28, 0
    buffer_load_ushort v24, v11, s[20:23], s30 offen
    s_add_u32 s30, s28, 1280
    buffer_load_ushort v48, v11, s[20:23], s30 offen
    s_add_u32 s30, s28, 2560
    buffer_load_ushort v25, v11, s[20:23], s30 offen
    s_add_u32 s30, s28, 3840
    buffer_load_ushort v49, v11, s[20:23], s30 offen
    s_add_u32 s30, s28, 5120
    buffer_load_ushort v26, v11, s[20:23], s30 offen
    s_add_u32 s30, s28, 6400
    buffer_load_ushort v50, v11, s[20:23], s30 offen
    s_add_u32 s30, s28, 7680
    buffer_load_ushort v27, v11, s[20:23], s30 offen
    s_add_u32 s30, s28, 8960
    buffer_load_ushort v51, v11, s[20:23], s30 offen
    s_mov_b32 exec_lo, 0xffff
    s_mov_b32 exec_hi, 0xffff
    s_add_u32 s30, s28, 0
    buffer_load_ushort v28, v12, s[20:23], s30 offen
    s_add_u32 s30, s28, 1280
    buffer_load_ushort v52, v12, s[20:23], s30 offen
    s_add_u32 s30, s28, 2560
    buffer_load_ushort v29, v12, s[20:23], s30 offen
    s_add_u32 s30, s28, 3840
    buffer_load_ushort v53, v12, s[20:23], s30 offen
    s_add_u32 s30, s28, 5120
    buffer_load_ushort v30, v12, s[20:23], s30 offen
    s_add_u32 s30, s28, 6400
    buffer_load_ushort v54, v12, s[20:23], s30 offen
    s_add_u32 s30, s28, 7680
    buffer_load_ushort v31, v12, s[20:23], s30 offen
    s_add_u32 s30, s28, 8960
    buffer_load_ushort v55, v12, s[20:23], s30 offen
    s_mov_b32 exec_lo, 0xffff0000
    s_mov_b32 exec_hi, 0xffff0000
    s_add_u32 s30, s29, 0
    buffer_load_ushort v28, v13, s[40:43], s30 offen
    s_add_u32 s30, s29, 40
    buffer_load_ushort v52, v13, s[40:43], s30 offen
    s_add_u32 s30, s29, 80
    buffer_load_ushort v29, v13, s[40:43], s30 offen
    s_add_u32 s30, s29, 120
    buffer_load_ushort v53, v13, s[40:43], s30 offen
    s_add_u32 s30, s29, 160
    buffer_load_ushort v30, v13, s[40:43], s30 offen
    s_add_u32 s30, s29, 200
    buffer_load_ushort v54, v13, s[40:43], s30 offen
    s_add_u32 s30, s29, 240
    buffer_load_ushort v31, v13, s[40:43], s30 offen
    s_add_u32 s30, s29, 280
    buffer_load_ushort v55, v13, s[40:43], s30 offen
    s_mov_b64 exec, -1
    s_mul_i32 s6, s19, 122880
    s_lshl_b32 s7, s18, 10
    s_add_u32 s7, s7, s6
    s_add_u32 s7, s7, 0x400000
    s_lshr_b32 s28, s18, 2
    s_lshl_b32 s28, s28, 12
    s_add_u32 s6, s7, s28
    s_add_u32 s6, s6, 40960
    s_add_u32 s28, s6, 4096
    s_waitcnt vmcnt(0)
    v_lshl_or_b32 v20, v44, 16, v20
    v_lshl_or_b32 v21, v45, 16, v21
    v_lshl_or_b32 v22, v46, 16, v22
    v_lshl_or_b32 v23, v47, 16, v23
    v_lshl_or_b32 v24, v48, 16, v24
    v_lshl_or_b32 v25, v49, 16, v25
    v_lshl_or_b32 v26, v50, 16, v26
    v_lshl_or_b32 v27, v51, 16, v27
    v_lshl_or_b32 v28, v52, 16, v28
    v_lshl_or_b32 v29, v53, 16, v29
    v_lshl_or_b32 v30, v54, 16, v30
    v_lshl_or_b32 v31, v55, 16, v31
    buffer_store_dwordx4 v[28:31], v1, s[8:11], s7 offen sc1
    buffer_store_dwordx4 v[20:23], v1, s[8:11], s6 offen sc1
    buffer_store_dwordx4 v[24:27], v1, s[8:11], s28 offen sc1
L_k_pqs_7:
    v_mov_b32 v8, 159996
L_k_lw_8:
    ds_read_b32 v9, v8
    s_waitcnt lgkmcnt(0)
    v_readfirstlane_b32 s3, v9
    s_cmp_lt_u32 s3, 1
    s_cbranch_scc1 L_k_lw_8
    s_mov_b32 s50, s3
    v_mov_b32 v8, 159820
    v_mov_b32 v9, 1
    s_mov_b64 exec, 1
    s_waitcnt vmcnt(0)
    ds_add_rtn_u32 v9, v8, v9
    s_waitcnt lgkmcnt(0)
    v_readfirstlane_b32 s3, v9
    s_cmp_lg_u32 s3, 3
    s_cbranch_scc1 L_k_wf_9
    v_mov_b32 v8, 0
    v_mov_b32 v9, s50
    buffer_store_dword v9, v8, s[8:11], s38 offen sc1
L_k_wf_9:
    s_mov_b64 exec, -1
L_k_xf0:
L_k_xf:
    v_and_b32 v4, 15, v2
    v_mul_u32_u24 v5, 1280, v2
    s_lshl_b32 s3, s14, 3
    s_add_u32 s6, s3, 0
    v_add_u32 v6, s6, v3
    v_xor_b32 v6, v6, v4
    v_lshl_add_u32 v10, v6, 4, v5
    s_add_u32 s6, s3, 2
    v_add_u32 v6, s6, v3
    v_xor_b32 v6, v6, v4
    v_lshl_add_u32 v11, v6, 4, v5
    s_add_u32 s6, s3, 4
    v_add_u32 v6, s6, v3
    v_xor_b32 v6, v6, v4
    v_lshl_add_u32 v12, v6, 4, v5
    s_add_u32 s6, s3, 6
    v_add_u32 v6, s6, v3
    v_xor_b32 v6, v6, v4
    v_lshl_add_u32 v13, v6, 4, v5
    s_lshl_b32 s3, s14, 8
    s_add_u32 s3, s3, 143360
    v_lshlrev_b32 v14, 5, v3
    v_add_u32 v14, s3, v14
    v_lshlrev_b32 v15, 3, v2
    v_add_u32 v15, 148480, v15
    v_mov_b32 v8, 159840
L_k_lw_10:
    ds_read_b32 v9, v8
    s_waitcnt lgkmcnt(0)
    v_readfirstlane_b32 s3, v9
    s_cmp_lt_u32 s3, 4
    s_cbranch_scc1 L_k_lw_10
    ds_read_b64 v[16:17], v15
    ds_read_b64 v[18:19], v15 offset:256
    ds_read_b128 v[24:27], v10 offset:0
    ds_read_b128 v[28:31], v10 offset:40960
    ds_read_b128 v[32:35], v11 offset:0
    ds_read_b128 v[36:39], v11 offset:40960
    ds_read_b128 v[40:43], v12 offset:0
    ds_read_b128 v[44:47], v12 offset:40960
    ds_read_b128 v[48:51], v13 offset:0
    ds_read_b128 v[52:55], v13 offset:40960
    s_waitcnt lgkmcnt(7)
    v_lshlrev_b32 v88, 16, v24
    v_and_b32 v89, 0xffff0000, v24
    v_fma_f32 v88, v88, v16, v17
    v_fma_f32 v89, v89, v16, v17
    v_lshlrev_b32 v90, 16, v25
    v_and_b32 v91, 0xffff0000, v25
    v_fma_f32 v90, v90, v16, v17
    v_fma_f32 v91, v91, v16, v17
    v_lshlrev_b32 v92, 16, v26
    v_and_b32 v93, 0xffff0000, v26
    v_fma_f32 v92, v92, v16, v17
    v_fma_f32 v93, v93, v16, v17
    v_lshlrev_b32 v94, 16, v27
    v_and_b32 v95, 0xffff0000, v27
    v_fma_f32 v94, v94, v16, v17
    v_fma_f32 v95, v95, v16, v17
    s_waitcnt lgkmcnt(6)
    v_lshlrev_b32 v96, 16, v28
    v_and_b32 v97, 0xffff0000, v28
    v_fma_f32 v96, v96, v18, v19
    v_fma_f32 v97, v97, v18, v19
    v_lshlrev_b32 v98, 16, v29
    v_and_b32 v99, 0xffff0000, v29
    v_fma_f32 v98, v98, v18, v19
    v_fma_f32 v99, v99, v18, v19
    v_lshlrev_b32 v100, 16, v30
    v_and_b32 v101, 0xffff0000, v30
    v_fma_f32 v100, v100, v18, v19
    v_fma_f32 v101, v101, v18, v19
    v_lshlrev_b32 v102, 16, v31
    v_and_b32 v103, 0xffff0000, v31
    v_fma_f32 v102, v102, v18, v19
    v_fma_f32 v103, v103, v18, v19
    s_waitcnt lgkmcnt(5)
    v_lshlrev_b32 v104, 16, v32
    v_and_b32 v105, 0xffff0000, v32
    v_fma_f32 v104, v104, v16, v17
    v_fma_f32 v105, v105, v16, v17
    v_lshlrev_b32 v106, 16, v33
    v_and_b32 v107, 0xffff0000, v33
    v_fma_f32 v106, v106, v16, v17
    v_fma_f32 v107, v107, v16, v17
    v_lshlrev_b32 v108, 16, v34
    v_and_b32 v109, 0xffff0000, v34
    v_fma_f32 v108, v108, v16, v17
    v_fma_f32 v109, v109, v16, v17
    v_lshlrev_b32 v110, 16, v35
    v_and_b32 v111, 0xffff0000, v35
    v_fma_f32 v110, v110, v16, v17
    v_fma_f32 v111, v111, v16, v17
    s_waitcnt lgkmcnt(4)
    v_lshlrev_b32 v112, 16, v36
    v_and_b32 v113, 0xffff0000, v36
    v_fma_f32 v112, v112, v18, v19
    v_fma_f32 v113, v113, v18, v19
    v_lshlrev_b32 v114, 16, v37
    v_and_b32 v115, 0xffff0000, v37
    v_fma_f32 v114, v114, v18, v19
    v_fma_f32 v115, v115, v18, v19
    v_lshlrev_b32 v116, 16, v38
    v_and_b32 v117, 0xffff0000, v38
    v_fma_f32 v116, v116, v18, v19
    v_fma_f32 v117, v117, v18, v19
    v_lshlrev_b32 v118, 16, v39
    v_and_b32 v119, 0xffff0000, v39
    v_fma_f32 v118, v118, v18, v19
    v_fma_f32 v119, v119, v18, v19
    s_waitcnt lgkmcnt(3)
    v_lshlrev_b32 v120, 16, v40
    v_and_b32 v121, 0xffff0000, v40
    v_fma_f32 v120, v120, v16, v17
    v_fma_f32 v121, v121, v16, v17
    v_lshlrev_b32 v122, 16, v41
    v_and_b32 v123, 0xffff0000, v41
    v_fma_f32 v122, v122, v16, v17
    v_fma_f32 v123, v123, v16, v17
    v_lshlrev_b32 v124, 16, v42
    v_and_b32 v125, 0xffff0000, v42
    v_fma_f32 v124, v124, v16, v17
    v_fma_f32 v125, v125, v16, v17
    v_lshlrev_b32 v126, 16, v43
    v_and_b32 v127, 0xffff0000, v43
    v_fma_f32 v126, v126, v16, v17
    v_fma_f32 v127, v127, v16, v17
    s_waitcnt lgkmcnt(2)
    v_lshlrev_b32 v128, 16, v44
    v_and_b32 v129, 0xffff0000, v44
    v_fma_f32 v128, v128, v18, v19
    v_fma_f32 v129, v129, v18, v19
    v_lshlrev_b32 v130, 16, v45
    v_and_b32 v131, 0xffff0000, v45
    v_fma_f32 v130, v130, v18, v19
    v_fma_f32 v131, v131, v18, v19
    v_lshlrev_b32 v132, 16, v46
    v_and_b32 v133, 0xffff0000, v46
    v_fma_f32 v132, v132, v18, v19
    v_fma_f32 v133, v133, v18, v19
    v_lshlrev_b32 v134, 16, v47
    v_and_b32 v135, 0xffff0000, v47
    v_fma_f32 v134, v134, v18, v19
    v_fma_f32 v135, v135, v18, v19
    s_waitcnt lgkmcnt(1)
    v_lshlrev_b32 v136, 16, v48
    v_and_b32 v137, 0xffff0000, v48
    v_fma_f32 v136, v136, v16, v17
    v_fma_f32 v137, v137, v16, v17
    v_lshlrev_b32 v138, 16, v49
    v_and_b32 v139, 0xffff0000, v49
    v_fma_f32 v138, v138, v16, v17
    v_fma_f32 v139, v139, v16, v17
    v_lshlrev_b32 v140, 16, v50
    v_and_b32 v141, 0xffff0000, v50
    v_fma_f32 v140, v140, v16, v17
    v_fma_f32 v141, v141, v16, v17
    v_lshlrev_b32 v142, 16, v51
    v_and_b32 v143, 0xffff0000, v51
    v_fma_f32 v142, v142, v16, v17
    v_fma_f32 v143, v143, v16, v17
    s_waitcnt lgkmcnt(0)
    v_lshlrev_b32 v144, 16, v52
    v_and_b32 v145, 0xffff0000, v52
    v_fma_f32 v144, v144, v18, v19
    v_fma_f32 v145, v145, v18, v19
    v_lshlrev_b32 v146, 16, v53
    v_and_b32 v147, 0xffff0000, v53
    v_fma_f32 v146, v146, v18, v19
    v_fma_f32 v147, v147, v18, v19
    v_lshlrev_b32 v148, 16, v54
    v_and_b32 v149, 0xffff0000, v54
    v_fma_f32 v148, v148, v18, v19
    v_fma_f32 v149, v149, v18, v19
    v_lshlrev_b32 v150, 16, v55
    v_and_b32 v151, 0xffff0000, v55
    v_fma_f32 v150, v150, v18, v19
    v_fma_f32 v151, v151, v18, v19
    s_cmp_eq_u32 s14, 4
    s_cbranch_scc1 L_k_par
L_k_xf2:
    s_barrier
    ds_read_b128 v[24:27], v14 offset:0
    ds_read_b128 v[28:31], v14 offset:16
    ds_read_b128 v[32:35], v14 offset:2560
    ds_read_b128 v[36:39], v14 offset:2576
    ds_read_b128 v[40:43], v14 offset:64
    ds_read_b128 v[44:47], v14 offset:80
    ds_read_b128 v[48:51], v14 offset:2624
    ds_read_b128 v[52:55], v14 offset:2640
    ds_read_b128 v[56:59], v14 offset:128
    ds_read_b128 v[60:63], v14 offset:144
    ds_read_b128 v[64:67], v14 offset:2688
    ds_read_b128 v[68:71], v14 offset:2704
    ds_read_b128 v[72:75], v14 offset:192
    ds_read_b128 v[76:79], v14 offset:208
    ds_read_b128 v[80:83], v14 offset:2752
    ds_read_b128 v[84:87], v14 offset:2768
    s_waitcnt lgkmcnt(12)
    v_fma_f32 v88, v88, v32, v24
    v_fma_f32 v89, v89, v33, v25
    v_fma_f32 v90, v90, v34, v26
    v_fma_f32 v91, v91, v35, v27
    v_fma_f32 v92, v92, v36, v28
    v_fma_f32 v93, v93, v37, v29
    v_fma_f32 v94, v94, v38, v30
    v_fma_f32 v95, v95, v39, v31
    v_cvt_pk_bf16_f32 v88, v88, v89
    v_cvt_pk_bf16_f32 v89, v90, v91
    v_cvt_pk_bf16_f32 v90, v92, v93
    v_cvt_pk_bf16_f32 v91, v94, v95
    ds_write_b128 v10, v[88:91] offset:0
    v_fma_f32 v96, v96, v32, v24
    v_fma_f32 v97, v97, v33, v25
    v_fma_f32 v98, v98, v34, v26
    v_fma_f32 v99, v99, v35, v27
    v_fma_f32 v100, v100, v36, v28
    v_fma_f32 v101, v101, v37, v29
    v_fma_f32 v102, v102, v38, v30
    v_fma_f32 v103, v103, v39, v31
    v_cvt_pk_bf16_f32 v96, v96, v97
    v_cvt_pk_bf16_f32 v97, v98, v99
    v_cvt_pk_bf16_f32 v98, v100, v101
    v_cvt_pk_bf16_f32 v99, v102, v103
    ds_write_b128 v10, v[96:99] offset:40960
    s_waitcnt lgkmcnt(10)
    v_fma_f32 v104, v104, v48, v40
    v_fma_f32 v105, v105, v49, v41
    v_fma_f32 v106, v106, v50, v42
    v_fma_f32 v107, v107, v51, v43
    v_fma_f32 v108, v108, v52, v44
    v_fma_f32 v109, v109, v53, v45
    v_fma_f32 v110, v110, v54, v46
    v_fma_f32 v111, v111, v55, v47
    v_cvt_pk_bf16_f32 v104, v104, v105
    v_cvt_pk_bf16_f32 v105, v106, v107
    v_cvt_pk_bf16_f32 v106, v108, v109
    v_cvt_pk_bf16_f32 v107, v110, v111
    ds_write_b128 v11, v[104:107] offset:0
    v_fma_f32 v112, v112, v48, v40
    v_fma_f32 v113, v113, v49, v41
    v_fma_f32 v114, v114, v50, v42
    v_fma_f32 v115, v115, v51, v43
    v_fma_f32 v116, v116, v52, v44
    v_fma_f32 v117, v117, v53, v45
    v_fma_f32 v118, v118, v54, v46
    v_fma_f32 v119, v119, v55, v47
    v_cvt_pk_bf16_f32 v112, v112, v113
    v_cvt_pk_bf16_f32 v113, v114, v115
    v_cvt_pk_bf16_f32 v114, v116, v117
    v_cvt_pk_bf16_f32 v115, v118, v119
    ds_write_b128 v11, v[112:115] offset:40960
    s_waitcnt lgkmcnt(8)
    v_fma_f32 v120, v120, v64, v56
    v_fma_f32 v121, v121, v65, v57
    v_fma_f32 v122, v122, v66, v58
    v_fma_f32 v123, v123, v67, v59
    v_fma_f32 v124, v124, v68, v60
    v_fma_f32 v125, v125, v69, v61
    v_fma_f32 v126, v126, v70, v62
    v_fma_f32 v127, v127, v71, v63
    v_cvt_pk_bf16_f32 v120, v120, v121
    v_cvt_pk_bf16_f32 v121, v122, v123
    v_cvt_pk_bf16_f32 v122, v124, v125
    v_cvt_pk_bf16_f32 v123, v126, v127
    ds_write_b128 v12, v[120:123] offset:0
    v_fma_f32 v128, v128, v64, v56
    v_fma_f32 v129, v129, v65, v57
    v_fma_f32 v130, v130, v66, v58
    v_fma_f32 v131, v131, v67, v59
    v_fma_f32 v132, v132, v68, v60
    v_fma_f32 v133, v133, v69, v61
    v_fma_f32 v134, v134, v70, v62
    v_fma_f32 v135, v135, v71, v63
    v_cvt_pk_bf16_f32 v128, v128, v129
    v_cvt_pk_bf16_f32 v129, v130, v131
    v_cvt_pk_bf16_f32 v130, v132, v133
    v_cvt_pk_bf16_f32 v131, v134, v135
    ds_write_b128 v12, v[128:131] offset:40960
    s_waitcnt lgkmcnt(6)
    v_fma_f32 v136, v136, v80, v72
    v_fma_f32 v137, v137, v81, v73
    v_fma_f32 v138, v138, v82, v74
    v_fma_f32 v139, v139, v83, v75
    v_fma_f32 v140, v140, v84, v76
    v_fma_f32 v141, v141, v85, v77
    v_fma_f32 v142, v142, v86, v78
    v_fma_f32 v143, v143, v87, v79
    v_cvt_pk_bf16_f32 v136, v136, v137
    v_cvt_pk_bf16_f32 v137, v138, v139
    v_cvt_pk_bf16_f32 v138, v140, v141
    v_cvt_pk_bf16_f32 v139, v142, v143
    ds_write_b128 v13, v[136:139] offset:0
    v_fma_f32 v144, v144, v80, v72
    v_fma_f32 v145, v145, v81, v73
    v_fma_f32 v146, v146, v82, v74
    v_fma_f32 v147, v147, v83, v75
    v_fma_f32 v148, v148, v84, v76
    v_fma_f32 v149, v149, v85, v77
    v_fma_f32 v150, v150, v86, v78
    v_fma_f32 v151, v151, v87, v79
    v_cvt_pk_bf16_f32 v144, v144, v145
    v_cvt_pk_bf16_f32 v145, v146, v147
    v_cvt_pk_bf16_f32 v146, v148, v149
    v_cvt_pk_bf16_f32 v147, v150, v151
    ds_write_b128 v13, v[144:147] offset:40960
    s_cmp_ge_u32 s14, 6
    s_cbranch_scc1 L_k_p1load
    s_and_b32 s17, s14, 1
    s_lshr_b32 s15, s14, 1
    s_lshl_b32 s16, s12, 1
    s_add_u32 s16, s16, s17
    s_mul_i32 s3, s17, 40960
    v_add_u32 v5, s3, v5
    v_add_u32 v6, 0, v3
    v_xor_b32 v6, v6, v4
    v_lshl_add_u32 v100, v6, 4, v5
    v_add_u32 v6, 2, v3
    v_xor_b32 v6, v6, v4
    v_lshl_add_u32 v101, v6, 4, v5
    v_add_u32 v6, 4, v3
    v_xor_b32 v6, v6, v4
    v_lshl_add_u32 v102, v6, 4, v5
    v_add_u32 v6, 6, v3
    v_xor_b32 v6, v6, v4
    v_lshl_add_u32 v103, v6, 4, v5
    v_add_u32 v6, 8, v3
    v_xor_b32 v6, v6, v4
    v_lshl_add_u32 v104, v6, 4, v5
    v_add_u32 v6, 10, v3
    v_xor_b32 v6, v6, v4
    v_lshl_add_u32 v105, v6, 4, v5
    v_add_u32 v6, 12, v3
    v_xor_b32 v6, v6, v4
    v_lshl_add_u32 v106, v6, 4, v5
    v_add_u32 v6, 14, v3
    v_xor_b32 v6, v6, v4
    v_lshl_add_u32 v107, v6, 4, v5
    v_add_u32 v108, 81920, v1
    s_lshl_b32 s3, s15, 12
    v_add_u32 v109, s3, v108
    s_mul_i32 s3, s15, 0xffff2000
    v_add_u32 v110, s3, v108
    s_waitcnt lgkmcnt(0)
    s_barrier
    s_cmp_eq_u32 s15, 2
    s_cbranch_scc1 L_k_kph
    ds_read_b128 v[24:27], v100 offset:0
    ds_read_b128 v[28:31], v109 offset:40960
    ds_read_b128 v[32:35], v101 offset:0
    ds_read_b128 v[36:39], v109 offset:41984
    ds_read_b128 v[40:43], v102 offset:0
    ds_read_b128 v[44:47], v109 offset:43008
    ds_read_b128 v[48:51], v103 offset:0
    ds_read_b128 v[52:55], v109 offset:44032
    s_barrier
    s_waitcnt lgkmcnt(6)
    v_mfma_f32_32x32x16_bf16 v[8:23], v[28:31], v[24:27], 0
    ds_read_b128 v[56:59], v104 offset:0
    ds_read_b128 v[60:63], v109 offset:49152
    s_waitcnt lgkmcnt(6)
    v_mfma_f32_32x32x16_bf16 v[8:23], v[36:39], v[32:35], v[8:23]
    ds_read_b128 v[64:67], v105 offset:0
    ds_read_b128 v[68:71], v109 offset:50176
    s_waitcnt lgkmcnt(6)
    v_mfma_f32_32x32x16_bf16 v[8:23], v[44:47], v[40:43], v[8:23]
    ds_read_b128 v[72:75], v106 offset:0
    ds_read_b128 v[76:79], v109 offset:51200
    s_waitcnt lgkmcnt(6)
    v_mfma_f32_32x32x16_bf16 v[8:23], v[52:55], v[48:51], v[8:23]
    ds_read_b128 v[80:83], v107 offset:0
    ds_read_b128 v[84:87], v109 offset:52224
    s_barrier
    s_waitcnt lgkmcnt(6)
    v_mfma_f32_32x32x16_bf16 v[8:23], v[60:63], v[56:59], v[8:23]
    ds_read_b128 v[24:27], v100 offset:256
    ds_read_b128 v[28:31], v110 offset:57344
    s_waitcnt lgkmcnt(6)
    v_mfma_f32_32x32x16_bf16 v[8:23], v[68:71], v[64:67], v[8:23]
    ds_read_b128 v[32:35], v101 offset:256
    ds_read_b128 v[36:39], v110 offset:58368
    s_waitcnt lgkmcnt(6)
    v_mfma_f32_32x32x16_bf16 v[8:23], v[76:79], v[72:75], v[8:23]
    ds_read_b128 v[40:43], v102 offset:256
    ds_read_b128 v[44:47], v110 offset:59392
    s_waitcnt lgkmcnt(6)
    v_mfma_f32_32x32x16_bf16 v[8:23], v[84:87], v[80:83], v[8:23]
    ds_read_b128 v[48:51], v103 offset:256
    ds_read_b128 v[52:55], v110 offset:60416
    s_barrier
    s_waitcnt lgkmcnt(6)
    v_mfma_f32_32x32x16_bf16 v[8:23], v[28:31], v[24:27], v[8:23]
    ds_read_b128 v[56:59], v104 offset:256
    ds_read_b128 v[60:63], v109 offset:4096
    s_waitcnt lgkmcnt(6)
    v_mfma_f32_32x32x16_bf16 v[8:23], v[36:39], v[32:35], v[8:23]
    ds_read_b128 v[64:67], v105 offset:256
    ds_read_b128 v[68:71], v109 offset:5120
    s_waitcnt lgkmcnt(6)
    v_mfma_f32_32x32x16_bf16 v[8:23], v[44:47], v[40:43], v[8:23]
    ds_read_b128 v[72:75], v106 offset:256
    ds_read_b128 v[76:79], v109 offset:6144
    s_waitcnt lgkmcnt(6)
    v_mfma_f32_32x32x16_bf16 v[8:23], v[52:55], v[48:51], v[8:23]
    ds_read_b128 v[80:83], v107 offset:256
    ds_read_b128 v[84:87], v109 offset:7168
    s_barrier
    s_waitcnt lgkmcnt(6)
    v_mfma_f32_32x32x16_bf16 v[8:23], v[60:63], v[56:59], v[8:23]
    ds_read_b128 v[24:27], v100 offset:512
    ds_read_b128 v[28:31], v109 offset:12288
    s_waitcnt lgkmcnt(6)
    v_mfma_f32_32x32x16_bf16 v[8:23], v[68:71], v[64:67], v[8:23]
    ds_read_b128 v[32:35], v101 offset:512
    ds_read_b128 v[36:39], v109 offset:13312
    s_waitcnt lgkmcnt(6)
    v_mfma_f32_32x32x16_bf16 v[8:23], v[76:79], v[72:75], v[8:23]
    ds_read_b128 v[40:43], v102 offset:512
    ds_read_b128 v[44:47], v109 offset:14336
    s_waitcnt lgkmcnt(6)
    v_mfma_f32_32x32x16_bf16 v[8:23], v[84:87], v[80:83], v[8:23]
    ds_read_b128 v[48:51], v103 offset:512
    ds_read_b128 v[52:55], v109 offset:15360
    s_barrier
    s_waitcnt lgkmcnt(6)
    v_mfma_f32_32x32x16_bf16 v[8:23], v[28:31], v[24:27], v[8:23]
    ds_read_b128 v[56:59], v104 offset:512
    ds_read_b128 v[60:63], v109 offset:20480
    s_waitcnt lgkmcnt(6)
    v_mfma_f32_32x32x16_bf16 v[8:23], v[36:39], v[32:35], v[8:23]
    ds_read_b128 v[64:67], v105 offset:512
    ds_read_b128 v[68:71], v109 offset:21504
    s_waitcnt lgkmcnt(6)
    v_mfma_f32_32x32x16_bf16 v[8:23], v[44:47], v[40:43], v[8:23]
    ds_read_b128 v[72:75], v106 offset:512
    ds_read_b128 v[76:79], v109 offset:22528
    s_waitcnt lgkmcnt(6)
    v_mfma_f32_32x32x16_bf16 v[8:23], v[52:55], v[48:51], v[8:23]
    ds_read_b128 v[80:83], v107 offset:512
    ds_read_b128 v[84:87], v109 offset:23552
    s_barrier
    s_waitcnt lgkmcnt(6)
    v_mfma_f32_32x32x16_bf16 v[8:23], v[60:63], v[56:59], v[8:23]
    ds_read_b128 v[24:27], v100 offset:768
    ds_read_b128 v[28:31], v109 offset:28672
    s_waitcnt lgkmcnt(6)
    v_mfma_f32_32x32x16_bf16 v[8:23], v[68:71], v[64:67], v[8:23]
    ds_read_b128 v[32:35], v101 offset:768
    ds_read_b128 v[36:39], v109 offset:29696
    s_waitcnt lgkmcnt(6)
    v_mfma_f32_32x32x16_bf16 v[8:23], v[76:79], v[72:75], v[8:23]
    ds_read_b128 v[40:43], v102 offset:768
    ds_read_b128 v[44:47], v109 offset:30720
    s_waitcnt lgkmcnt(6)
    v_mfma_f32_32x32x16_bf16 v[8:23], v[84:87], v[80:83], v[8:23]
    ds_read_b128 v[48:51], v103 offset:768
    ds_read_b128 v[52:55], v109 offset:31744
    s_barrier
    s_waitcnt lgkmcnt(6)
    v_mfma_f32_32x32x16_bf16 v[8:23], v[28:31], v[24:27], v[8:23]
    ds_read_b128 v[56:59], v104 offset:768
    ds_read_b128 v[60:63], v109 offset:36864
    s_waitcnt lgkmcnt(6)
    v_mfma_f32_32x32x16_bf16 v[8:23], v[36:39], v[32:35], v[8:23]
    ds_read_b128 v[64:67], v105 offset:768
    ds_read_b128 v[68:71], v109 offset:37888
    s_waitcnt lgkmcnt(6)
    v_mfma_f32_32x32x16_bf16 v[8:23], v[44:47], v[40:43], v[8:23]
    ds_read_b128 v[72:75], v106 offset:768
    ds_read_b128 v[76:79], v109 offset:38912
    s_waitcnt lgkmcnt(6)
    v_mfma_f32_32x32x16_bf16 v[8:23], v[52:55], v[48:51], v[8:23]
    ds_read_b128 v[80:83], v107 offset:768
    ds_read_b128 v[84:87], v109 offset:39936
    s_barrier
    s_waitcnt lgkmcnt(6)
    v_mfma_f32_32x32x16_bf16 v[8:23], v[60:63], v[56:59], v[8:23]
    ds_read_b128 v[24:27], v100 offset:1024
    ds_read_b128 v[28:31], v109 offset:45056
    s_waitcnt lgkmcnt(6)
    v_mfma_f32_32x32x16_bf16 v[8:23], v[68:71], v[64:67], v[8:23]
    ds_read_b128 v[32:35], v101 offset:1024
    ds_read_b128 v[36:39], v109 offset:46080
    s_waitcnt lgkmcnt(6)
    v_mfma_f32_32x32x16_bf16 v[8:23], v[76:79], v[72:75], v[8:23]
    ds_read_b128 v[40:43], v102 offset:1024
    ds_read_b128 v[44:47], v109 offset:47104
    s_waitcnt lgkmcnt(6)
    v_mfma_f32_32x32x16_bf16 v[8:23], v[84:87], v[80:83], v[8:23]
    ds_read_b128 v[48:51], v103 offset:1024
    ds_read_b128 v[52:55], v109 offset:48128
    s_barrier
    s_waitcnt lgkmcnt(6)
    v_mfma_f32_32x32x16_bf16 v[8:23], v[28:31], v[24:27], v[8:23]
    ds_read_b128 v[56:59], v104 offset:1024
    ds_read_b128 v[60:63], v109 offset:53248
    s_waitcnt lgkmcnt(6)
    v_mfma_f32_32x32x16_bf16 v[8:23], v[36:39], v[32:35], v[8:23]
    ds_read_b128 v[64:67], v105 offset:1024
    ds_read_b128 v[68:71], v109 offset:54272
    s_waitcnt lgkmcnt(6)
    v_mfma_f32_32x32x16_bf16 v[8:23], v[44:47], v[40:43], v[8:23]
    ds_read_b128 v[72:75], v106 offset:1024
    ds_read_b128 v[76:79], v109 offset:55296
    s_waitcnt lgkmcnt(6)
    v_mfma_f32_32x32x16_bf16 v[8:23], v[52:55], v[48:51], v[8:23]
    ds_read_b128 v[80:83], v107 offset:1024
    ds_read_b128 v[84:87], v109 offset:56320
    s_waitcnt lgkmcnt(6)
    v_mfma_f32_32x32x16_bf16 v[8:23], v[60:63], v[56:59], v[8:23]
    s_waitcnt lgkmcnt(4)
    v_mfma_f32_32x32x16_bf16 v[8:23], v[68:71], v[64:67], v[8:23]
    s_waitcnt lgkmcnt(2)
    v_mfma_f32_32x32x16_bf16 v[8:23], v[76:79], v[72:75], v[8:23]
    s_waitcnt lgkmcnt(0)
    v_mfma_f32_32x32x16_bf16 v[8:23], v[84:87], v[80:83], v[8:23]
    s_branch L_k_p1epi
L_k_kph:
    ds_read_b128 v[24:27], v100 offset:0
    ds_read_b128 v[28:31], v108 offset:0
    ds_read_b128 v[32:35], v101 offset:0
    ds_read_b128 v[36:39], v108 offset:1024
    ds_read_b128 v[40:43], v102 offset:0
    ds_read_b128 v[44:47], v108 offset:2048
    ds_read_b128 v[48:51], v103 offset:0
    ds_read_b128 v[52:55], v108 offset:3072
    s_waitcnt lgkmcnt(6)
    v_mfma_f32_32x32x16_bf16 v[8:23], v[28:31], v[24:27], 0
    ds_read_b128 v[56:59], v104 offset:0
    ds_read_b128 v[60:63], v108 offset:4096
    s_waitcnt lgkmcnt(6)
    v_mfma_f32_32x32x16_bf16 v[8:23], v[36:39], v[32:35], v[8:23]
    ds_read_b128 v[64:67], v105 offset:0
    ds_read_b128 v[68:71], v108 offset:5120
    s_waitcnt lgkmcnt(6)
    v_mfma_f32_32x32x16_bf16 v[8:23], v[44:47], v[40:43], v[8:23]
    ds_read_b128 v[72:75], v106 offset:0
    ds_read_b128 v[76:79], v108 offset:6144
    s_waitcnt lgkmcnt(6)
    v_mfma_f32_32x32x16_bf16 v[8:23], v[52:55], v[48:51], v[8:23]
    ds_read_b128 v[80:83], v107 offset:0
    ds_read_b128 v[84:87], v108 offset:7168
    s_waitcnt lgkmcnt(6)
    v_mfma_f32_32x32x16_bf16 v[8:23], v[60:63], v[56:59], v[8:23]
    ds_read_b128 v[24:27], v100 offset:256
    ds_read_b128 v[28:31], v108 offset:8192
    s_waitcnt lgkmcnt(6)
    v_mfma_f32_32x32x16_bf16 v[8:23], v[68:71], v[64:67], v[8:23]
    ds_read_b128 v[32:35], v101 offset:256
    ds_read_b128 v[36:39], v108 offset:9216
    s_waitcnt lgkmcnt(6)
    v_mfma_f32_32x32x16_bf16 v[8:23], v[76:79], v[72:75], v[8:23]
    ds_read_b128 v[40:43], v102 offset:256
    ds_read_b128 v[44:47], v108 offset:10240
    s_waitcnt lgkmcnt(6)
    v_mfma_f32_32x32x16_bf16 v[8:23], v[84:87], v[80:83], v[8:23]
    ds_read_b128 v[48:51], v103 offset:256
    ds_read_b128 v[52:55], v108 offset:11264
    s_waitcnt lgkmcnt(6)
    v_mfma_f32_32x32x16_bf16 v[8:23], v[28:31], v[24:27], v[8:23]
    ds_read_b128 v[56:59], v104 offset:256
    ds_read_b128 v[60:63], v108 offset:12288
    s_waitcnt lgkmcnt(6)
    v_mfma_f32_32x32x16_bf16 v[8:23], v[36:39], v[32:35], v[8:23]
    ds_read_b128 v[64:67], v105 offset:256
    ds_read_b128 v[68:71], v108 offset:13312
    s_waitcnt lgkmcnt(6)
    v_mfma_f32_32x32x16_bf16 v[8:23], v[44:47], v[40:43], v[8:23]
    ds_read_b128 v[72:75], v106 offset:256
    ds_read_b128 v[76:79], v108 offset:14336
    s_waitcnt lgkmcnt(6)
    v_mfma_f32_32x32x16_bf16 v[8:23], v[52:55], v[48:51], v[8:23]
    ds_read_b128 v[80:83], v107 offset:256
    ds_read_b128 v[84:87], v108 offset:15360
    s_waitcnt lgkmcnt(6)
    v_mfma_f32_32x32x16_bf16 v[8:23], v[60:63], v[56:59], v[8:23]
    ds_read_b128 v[24:27], v100 offset:512
    ds_read_b128 v[28:31], v108 offset:16384
    s_waitcnt lgkmcnt(6)
    v_mfma_f32_32x32x16_bf16 v[8:23], v[68:71], v[64:67], v[8:23]
    ds_read_b128 v[32:35], v101 offset:512
    ds_read_b128 v[36:39], v108 offset:17408
    s_waitcnt lgkmcnt(6)
    v_mfma_f32_32x32x16_bf16 v[8:23], v[76:79], v[72:75], v[8:23]
    ds_read_b128 v[40:43], v102 offset:512
    ds_read_b128 v[44:47], v108 offset:18432
    s_waitcnt lgkmcnt(6)
    v_mfma_f32_32x32x16_bf16 v[8:23], v[84:87], v[80:83], v[8:23]
    ds_read_b128 v[48:51], v103 offset:512
    ds_read_b128 v[52:55], v108 offset:19456
    s_waitcnt lgkmcnt(6)
    v_mfma_f32_32x32x16_bf16 v[8:23], v[28:31], v[24:27], v[8:23]
    ds_read_b128 v[56:59], v104 offset:512
    ds_read_b128 v[60:63], v108 offset:20480
    s_waitcnt lgkmcnt(6)
    v_mfma_f32_32x32x16_bf16 v[8:23], v[36:39], v[32:35], v[8:23]
    ds_read_b128 v[64:67], v105 offset:512
    ds_read_b128 v[68:71], v108 offset:21504
    s_waitcnt lgkmcnt(6)
    v_mfma_f32_32x32x16_bf16 v[8:23], v[44:47], v[40:43], v[8:23]
    ds_read_b128 v[72:75], v106 offset:512
    ds_read_b128 v[76:79], v108 offset:22528
    s_waitcnt lgkmcnt(6)
    v_mfma_f32_32x32x16_bf16 v[8:23], v[52:55], v[48:51], v[8:23]
    ds_read_b128 v[80:83], v107 offset:512
    ds_read_b128 v[84:87], v108 offset:23552
    s_barrier
    s_waitcnt lgkmcnt(6)
    v_mfma_f32_32x32x16_bf16 v[8:23], v[60:63], v[56:59], v[8:23]
    ds_read_b128 v[24:27], v100 offset:768
    ds_read_b128 v[28:31], v108 offset:24576
    s_waitcnt lgkmcnt(6)
    v_mfma_f32_32x32x16_bf16 v[8:23], v[68:71], v[64:67], v[8:23]
    ds_read_b128 v[32:35], v101 offset:768
    ds_read_b128 v[36:39], v108 offset:25600
    s_waitcnt lgkmcnt(6)
    v_mfma_f32_32x32x16_bf16 v[8:23], v[76:79], v[72:75], v[8:23]
    ds_read_b128 v[40:43], v102 offset:768
    ds_read_b128 v[44:47], v108 offset:26624
    s_waitcnt lgkmcnt(6)
    v_mfma_f32_32x32x16_bf16 v[8:23], v[84:87], v[80:83], v[8:23]
    ds_read_b128 v[48:51], v103 offset:768
    ds_read_b128 v[52:55], v108 offset:27648
    s_waitcnt lgkmcnt(6)
    v_mfma_f32_32x32x16_bf16 v[8:23], v[28:31], v[24:27], v[8:23]
    ds_read_b128 v[56:59], v104 offset:768
    ds_read_b128 v[60:63], v108 offset:28672
    s_waitcnt lgkmcnt(6)
    v_mfma_f32_32x32x16_bf16 v[8:23], v[36:39], v[32:35], v[8:23]
    ds_read_b128 v[64:67], v105 offset:768
    ds_read_b128 v[68:71], v108 offset:29696
    s_waitcnt lgkmcnt(6)
    v_mfma_f32_32x32x16_bf16 v[8:23], v[44:47], v[40:43], v[8:23]
    ds_read_b128 v[72:75], v106 offset:768
    ds_read_b128 v[76:79], v108 offset:30720
    s_waitcnt lgkmcnt(6)
    v_mfma_f32_32x32x16_bf16 v[8:23], v[52:55], v[48:51], v[8:23]
    ds_read_b128 v[80:83], v107 offset:768
    ds_read_b128 v[84:87], v108 offset:31744
    s_waitcnt lgkmcnt(6)
    v_mfma_f32_32x32x16_bf16 v[8:23], v[60:63], v[56:59], v[8:23]
    ds_read_b128 v[24:27], v100 offset:1024
    ds_read_b128 v[28:31], v108 offset:32768
    s_waitcnt lgkmcnt(6)
    v_mfma_f32_32x32x16_bf16 v[8:23], v[68:71], v[64:67], v[8:23]
    ds_read_b128 v[32:35], v101 offset:1024
    ds_read_b128 v[36:39], v108 offset:33792
    s_waitcnt lgkmcnt(6)
    v_mfma_f32_32x32x16_bf16 v[8:23], v[76:79], v[72:75], v[8:23]
    ds_read_b128 v[40:43], v102 offset:1024
    ds_read_b128 v[44:47], v108 offset:34816
    s_waitcnt lgkmcnt(6)
    v_mfma_f32_32x32x16_bf16 v[8:23], v[84:87], v[80:83], v[8:23]
    ds_read_b128 v[48:51], v103 offset:1024
    ds_read_b128 v[52:55], v108 offset:35840
    s_waitcnt lgkmcnt(6)
    v_mfma_f32_32x32x16_bf16 v[8:23], v[28:31], v[24:27], v[8:23]
    ds_read_b128 v[56:59], v104 offset:1024
    ds_read_b128 v[60:63], v108 offset:36864
    s_waitcnt lgkmcnt(6)
    v_mfma_f32_32x32x16_bf16 v[8:23], v[36:39], v[32:35], v[8:23]
    ds_read_b128 v[64:67], v105 offset:1024
    ds_read_b128 v[68:71], v108 offset:37888
    s_waitcnt lgkmcnt(6)
    v_mfma_f32_32x32x16_bf16 v[8:23], v[44:47], v[40:43], v[8:23]
    ds_read_b128 v[72:75], v106 offset:1024
    ds_read_b128 v[76:79], v108 offset:38912
    s_waitcnt lgkmcnt(6)
    v_mfma_f32_32x32x16_bf16 v[8:23], v[52:55], v[48:51], v[8:23]
    ds_read_b128 v[80:83], v107 offset:1024
    ds_read_b128 v[84:87], v108 offset:39936
    s_barrier
    s_waitcnt lgkmcnt(6)
    v_mfma_f32_32x32x16_bf16 v[8:23], v[60:63], v[56:59], v[8:23]
    s_waitcnt lgkmcnt(4)
    v_mfma_f32_32x32x16_bf16 v[8:23], v[68:71], v[64:67], v[8:23]
    s_waitcnt lgkmcnt(2)
    v_mfma_f32_32x32x16_bf16 v[8:23], v[76:79], v[72:75], v[8:23]
    s_waitcnt lgkmcnt(0)
    v_mfma_f32_32x32x16_bf16 v[8:23], v[84:87], v[80:83], v[8:23]
L_k_p1epi:
    s_mul_i32 s3, s17, 5
    s_lshl_b32 s6, s15, 1
    s_add_u32 s3, s3, s6
    s_lshl_b32 s3, s3, 10
    s_add_u32 s3, s3, 81920
    v_add_u32 v7, s3, v1
    s_mov_b32 s7, 0x3ea52b5c
    s_nop 5
    s_cmp_lg_u32 s15, 2
    s_cbranch_scc1 L_k_q_11
    s_cmp_ge_u32 s13, 4
    s_cbranch_scc1 L_k_nokv_12
    s_and_b32 s6, s12, 7
    s_mul_i32 s19, s6, 26624
    s_add_u32 s19, s19, 0xd00000
    s_lshr_b32 s18, s12, 3
    s_lshl_b32 s18, s18, 1
    s_add_u32 s18, s18, s17
    s_cmp_eq_u32 s13, 3
    s_cbranch_scc0 L_k_k2_13
    v_mov_b32 v20, 1.0
    s_mov_b32 exec_lo, 0
    v_mov_b32 v16, 1.0
    s_mov_b32 exec_lo, -1
L_k_k2_13:
    v_cvt_pk_bf16_f32 v48, v16, v17
    v_cvt_pk_bf16_f32 v49, v18, v19
    v_cvt_pk_bf16_f32 v50, v20, v21
    v_cvt_pk_bf16_f32 v51, v22, v23
    s_cmp_ge_u32 s13, 2
    s_cbranch_scc1 L_k_v_14
    s_cmp_eq_u32 s13, 1
    s_cbranch_scc1 L_k_k2b_15
    s_lshl_b32 s18, s18, 10
    s_add_u32 s19, s19, s18
    buffer_store_dwordx4 v[48:51], v1, s[8:11], s19 offen sc1
    s_branch L_k_kd_16
L_k_k2b_15:
    s_lshl_b32 s18, s18, 8
    s_add_u32 s19, s19, s18
    s_add_u32 s19, s19, 24576
    v_lshrrev_b32 v4, 2, v1
    buffer_store_dword v48, v4, s[8:11], s19 offen sc1
    s_branch L_k_kd_16
L_k_v_14:
    s_lshl_b32 s3, s14, 10
    s_add_u32 s3, s3, 145408
    v_lshlrev_b32 v4, 5, v2
    v_lshl_add_u32 v4, v3, 3, v4
    v_add_u32 v4, s3, v4
    ds_write_b64 v4, v[48:49]
    ds_write_b64 v4, v[50:51] offset:16
    v_lshrrev_b32 v4, 4, v1
    v_and_b32 v5, 15, v4
    v_lshrrev_b32 v4, 4, v4
    v_and_b32 v6, 1, v4
    v_lshlrev_b32 v6, 4, v6
    v_lshl_add_u32 v6, v3, 2, v6
    v_lshrrev_b32 v56, 2, v5
    v_add_u32 v6, v6, v56
    v_lshlrev_b32 v6, 5, v6
    v_and_b32 v56, 3, v5
    v_lshl_add_u32 v6, v56, 3, v6
    v_add_u32 v6, s3, v6
    s_waitcnt lgkmcnt(0)
    ds_read_b64_tr_b16 v[52:53], v6
    ds_read_b64_tr_b16 v[54:55], v6 offset:256
    v_and_b32 v6, 1, v4
    v_lshlrev_b32 v6, 10, v6
    v_lshl_add_u32 v6, v3, 9, v6
    v_lshl_add_u32 v6, v5, 4, v6
    s_lshl_b32 s18, s18, 11
    s_add_u32 s19, s19, s18
    s_add_u32 s19, s19, 8192
    s_cmp_eq_u32 s13, 2
    s_cselect_b32 s6, 256, 0
    s_add_u32 s19, s19, s6
    s_waitcnt lgkmcnt(0)
    buffer_store_dwordx4 v[52:55], v6, s[8:11], s19 offen sc1
L_k_kd_16:
    s_barrier
    s_barrier
    s_barrier
    s_barrier
    s_and_b32 s6, s12, 7
    s_lshl_b32 s6, s6, 4
    s_lshr_b32 s3, s12, 3
    s_lshl_b32 s3, s3, 2
    s_add_u32 s6, s6, s3
    s_add_u32 s6, s6, s13
    s_lshl_b32 s6, s6, 7
    s_add_u32 s6, s6, 0x48000
    v_mov_b32 v60, 159808
    v_mov_b32 v61, 1
    s_mov_b64 exec, 1
    s_waitcnt vmcnt(0)
    ds_add_rtn_u32 v61, v60, v61
    s_waitcnt lgkmcnt(0)
    v_readfirstlane_b32 s3, v61
    s_cmp_lg_u32 s3, 1
    s_cbranch_scc1 L_k_wf_17
    v_mov_b32 v60, 0
    v_mov_b32 v61, s50
    buffer_store_dword v61, v60, s[8:11], s6 offen sc1
L_k_wf_17:
    s_mov_b64 exec, -1
    s_branch L_k_nokv_122
L_k_nokv_12:
    s_barrier
    s_barrier
    s_barrier
    s_barrier
L_k_nokv_122:
    s_barrier
    s_barrier
    s_barrier
    s_branch L_k_q_110
L_k_q_11:
    v_mul_f32 v24, s7, v16
    v_mul_f32 v25, s7, v17
    v_mul_f32 v26, s7, v18
    v_mul_f32 v27, s7, v19
    v_mul_f32 v28, s7, v20
    v_mul_f32 v29, s7, v21
    v_mul_f32 v30, s7, v22
    v_mul_f32 v31, s7, v23
    v_cvt_pk_bf16_f32 v36, v24, v25
    v_cvt_pk_bf16_f32 v37, v26, v27
    v_cvt_pk_bf16_f32 v38, v28, v29
    v_cvt_pk_bf16_f32 v39, v30, v31
    ds_write_b128 v7, v[36:39] offset:1024
L_k_q_110:
    v_mul_f32 v24, s7, v8
    v_mul_f32 v25, s7, v9
    v_mul_f32 v26, s7, v10
    v_mul_f32 v27, s7, v11
    v_mul_f32 v28, s7, v12
    v_mul_f32 v29, s7, v13
    v_mul_f32 v30, s7, v14
    v_mul_f32 v31, s7, v15
    v_cvt_pk_bf16_f32 v32, v24, v25
    v_cvt_pk_bf16_f32 v33, v26, v27
    v_cvt_pk_bf16_f32 v34, v28, v29
    v_cvt_pk_bf16_f32 v35, v30, v31
    ds_write_b128 v7, v[32:35] offset:0
    s_waitcnt lgkmcnt(0)
    s_barrier
L_k_qnext:
    s_cmp_ge_u32 s14, 4
    s_cbranch_scc1 L_k_idle
    s_branch L_k_att
L_k_p0other:
    s_load_dwordx2 s[16:17], s[0:1], 104
    s_cmp_lg_u32 s14, 4
    s_cbranch_scc1 L_k_nz_18
    v_lshrrev_b32 v8, 2, v1
    v_add_u32 v8, 159744, v8
    v_mov_b32 v9, 0
    ds_write_b32 v8, v9 offset:0
    s_lshr_b32 s3, s2, 3
    s_cmp_ge_u32 s3, 8
    s_cbranch_scc1 L_k_nz_18
    s_getpc_b64 s[40:41]
L_k_nc_21:
    s_sub_u32 s40, s40, L_k_nc_21-adaLN_cond__grouped_kv_mqa__mixer_gmlp__prompt_kernel
    s_subb_u32 s41, s41, 0
    s_lshl_b32 s3, s3, 13
    v_lshlrev_b32 v8, 3, v1
    v_add_u32 v8, s3, v8
    v_min_u32 v8, L_k_textend-adaLN_cond__grouped_kv_mqa__mixer_gmlp__prompt_kernel-4, v8
    global_load_dword v20, v8, s[40:41]
L_k_nz_18:
    s_waitcnt lgkmcnt(0)
    s_barrier
    s_mov_b32 s8, s4
    s_mov_b32 s9, s5
    s_mov_b32 s10, 0x2500000
    s_mov_b32 s11, 0x20000
    s_cmp_lg_u32 s14, 5
    s_cbranch_scc1 L_k_n6_19
    s_mov_b32 s20, s16
    s_mov_b32 s21, s17
    s_mov_b32 s22, 0x100
    s_mov_b32 s23, 0x20000
    v_mov_b32 v8, 0
    s_cmp_lg_u32 s2, 0
    s_cbranch_scc1 L_k_np_20
    s_memrealtime s[18:19]
    s_waitcnt lgkmcnt(0)
    s_lshl_b32 s18, s18, 5
    s_or_b32 s18, s18, 16
    v_mov_b32 v10, s18
    v_mov_b32 v11, 0
    s_mov_b64 exec, 1
    buffer_atomic_cmpswap v[10:11], v8, s[20:23], 0 offen
    s_mov_b64 exec, -1
L_k_np_20:
    s_mov_b32 s29, 0x8000
L_k_np_20l:
    buffer_load_dword v9, v8, s[20:23], 0 offen sc1
    s_waitcnt vmcnt(0)
    v_readfirstlane_b32 s50, v9
    s_sub_u32 s29, s29, 1
    s_cbranch_scc1 L_k_np_20x
    s_cmp_eq_u32 s50, 0
    s_cbranch_scc1 L_k_np_20l
L_k_np_20x:
    v_mov_b32 v10, 159996
    v_mov_b32 v11, s50
    ds_write_b32 v10, v11
    s_lshl_b32 s3, s12, 8
    s_lshl_b32 s6, s13, 2
    s_add_u32 s3, s3, s6
    s_add_u32 s3, s3, 0x10000
    s_getreg_b32 s7, hwreg(HW_REG_XCC_ID, 0, 4)
    s_add_u32 s7, s7, s50
    v_mov_b32 v8, 0
    v_mov_b32 v9, s7
    s_mov_b64 exec, 1
    buffer_store_dword v9, v8, s[8:11], s3 offen sc1
    s_mov_b64 exec, -1
L_k_xid_22:
    s_waitcnt lgkmcnt(0)
L_k_n6_19:
    s_cmp_lg_u32 s14, 5
    s_cbranch_scc1 L_k_n5_23
    s_lshr_b32 s3, s2, 3
    s_mul_i32 s3, s3, 6656
    s_add_u32 s3, s3, 0x40000
    v_lshlrev_b32 v8, 3, v1
    s_mov_b32 exec_hi, 0xfffff
    buffer_load_dword v20, v8, s[8:11], s3 offen sc1
    s_mov_b64 exec, -1
L_k_n5_23:
    s_cmp_lt_u32 s14, 6
    s_cbranch_scc1 L_k_xd_24
    s_sub_u32 s15, s14, 6
    s_mov_b32 s40, s60
    s_mov_b32 s41, s61
    s_mov_b32 s42, 0x280000
    s_mov_b32 s43, 0x20000
    s_cmp_lt_u32 s13, 4
    s_cbranch_scc1 L_k_jf_25
    s_cmp_ge_u32 s13, 6
    s_cbranch_scc1 L_k_jf_25
    s_cmp_ge_u32 s12, 20
    s_cbranch_scc1 L_k_jf_25
    v_mov_b32 v8, 159820
L_k_lw_26:
    s_sleep 4
    ds_read_b32 v9, v8
    s_waitcnt lgkmcnt(0)
    v_readfirstlane_b32 s3, v9
    s_cmp_lt_u32 s3, 4
    s_cbranch_scc1 L_k_lw_26
L_k_jf_25:
    v_lshrrev_b32 v10, 4, v1
    s_mul_i32 s22, s15, 20480
    s_lshl_b32 s6, s12, 2
    s_add_u32 s6, s6, s15
    s_mul_i32 s6, s6, 20480
    s_mul_i32 s23, s13, 5
    s_lshr_b32 s23, s23, 1
    s_lshl_b32 s3, s23, 6
    v_add_u32 v11, s3, v10
    s_lshl_b32 s3, s23, 10
    s_add_u32 m0, s3, s22
    v_mul_u32_u24 v12, 52429, v11
    v_lshrrev_b32 v12, 22, v12
    v_mul_u32_u24 v13, 80, v12
    v_sub_u32 v13, v11, v13
    v_xor_b32 v13, v13, v12
    v_mul_u32_u24 v12, 1280, v12
    v_lshl_add_u32 v13, v13, 4, v12
    buffer_load_dwordx4 v13, s[40:43], s6 offen lds
    s_add_u32 s23, s23, 1
    s_cmp_eq_u32 s23, 20
    s_cselect_b32 s23, 0, s23
    s_lshl_b32 s3, s23, 6
    v_add_u32 v11, s3, v10
    s_lshl_b32 s3, s23, 10
    s_add_u32 m0, s3, s22
    v_mul_u32_u24 v12, 52429, v11
    v_lshrrev_b32 v12, 22, v12
    v_mul_u32_u24 v13, 80, v12
    v_sub_u32 v13, v11, v13
    v_xor_b32 v13, v13, v12
    v_mul_u32_u24 v12, 1280, v12
    v_lshl_add_u32 v13, v13, 4, v12
    buffer_load_dwordx4 v13, s[40:43], s6 offen lds
    s_add_u32 s23, s23, 1
    s_cmp_eq_u32 s23, 20
    s_cselect_b32 s23, 0, s23
    s_lshl_b32 s3, s23, 6
    v_add_u32 v11, s3, v10
    s_lshl_b32 s3, s23, 10
    s_add_u32 m0, s3, s22
    v_mul_u32_u24 v12, 52429, v11
    v_lshrrev_b32 v12, 22, v12
    v_mul_u32_u24 v13, 80, v12
    v_sub_u32 v13, v11, v13
    v_xor_b32 v13, v13, v12
    v_mul_u32_u24 v12, 1280, v12
    v_lshl_add_u32 v13, v13, 4, v12
    buffer_load_dwordx4 v13, s[40:43], s6 offen lds
    s_add_u32 s23, s23, 1
    s_cmp_eq_u32 s23, 20
    s_cselect_b32 s23, 0, s23
    s_lshl_b32 s3, s23, 6
    v_add_u32 v11, s3, v10
    s_lshl_b32 s3, s23, 10
    s_add_u32 m0, s3, s22
    v_mul_u32_u24 v12, 52429, v11
    v_lshrrev_b32 v12, 22, v12
    v_mul_u32_u24 v13, 80, v12
    v_sub_u32 v13, v11, v13
    v_xor_b32 v13, v13, v12
    v_mul_u32_u24 v12, 1280, v12
    v_lshl_add_u32 v13, v13, 4, v12
    buffer_load_dwordx4 v13, s[40:43], s6 offen lds
    s_add_u32 s23, s23, 1
    s_cmp_eq_u32 s23, 20
    s_cselect_b32 s23, 0, s23
    s_lshl_b32 s3, s23, 6
    v_add_u32 v11, s3, v10
    s_lshl_b32 s3, s23, 10
    s_add_u32 m0, s3, s22
    v_mul_u32_u24 v12, 52429, v11
    v_lshrrev_b32 v12, 22, v12
    v_mul_u32_u24 v13, 80, v12
    v_sub_u32 v13, v11, v13
    v_xor_b32 v13, v13, v12
    v_mul_u32_u24 v12, 1280, v12
    v_lshl_add_u32 v13, v13, 4, v12
    buffer_load_dwordx4 v13, s[40:43], s6 offen lds
    s_add_u32 s23, s23, 1
    s_cmp_eq_u32 s23, 20
    s_cselect_b32 s23, 0, s23
    s_lshl_b32 s3, s23, 6
    v_add_u32 v11, s3, v10
    s_lshl_b32 s3, s23, 10
    s_add_u32 m0, s3, s22
    v_mul_u32_u24 v12, 52429, v11
    v_lshrrev_b32 v12, 22, v12
    v_mul_u32_u24 v13, 80, v12
    v_sub_u32 v13, v11, v13
    v_xor_b32 v13, v13, v12
    v_mul_u32_u24 v12, 1280, v12
    v_lshl_add_u32 v13, v13, 4, v12
    buffer_load_dwordx4 v13, s[40:43], s6 offen lds
    s_add_u32 s23, s23, 1
    s_cmp_eq_u32 s23, 20
    s_cselect_b32 s23, 0, s23
    s_lshl_b32 s3, s23, 6
    v_add_u32 v11, s3, v10
    s_lshl_b32 s3, s23, 10
    s_add_u32 m0, s3, s22
    v_mul_u32_u24 v12, 52429, v11
    v_lshrrev_b32 v12, 22, v12
    v_mul_u32_u24 v13, 80, v12
    v_sub_u32 v13, v11, v13
    v_xor_b32 v13, v13, v12
    v_mul_u32_u24 v12, 1280, v12
    v_lshl_add_u32 v13, v13, 4, v12
    buffer_load_dwordx4 v13, s[40:43], s6 offen lds
    s_add_u32 s23, s23, 1
    s_cmp_eq_u32 s23, 20
    s_cselect_b32 s23, 0, s23
    s_lshl_b32 s3, s23, 6
    v_add_u32 v11, s3, v10
    s_lshl_b32 s3, s23, 10
    s_add_u32 m0, s3, s22
    v_mul_u32_u24 v12, 52429, v11
    v_lshrrev_b32 v12, 22, v12
    v_mul_u32_u24 v13, 80, v12
    v_sub_u32 v13, v11, v13
    v_xor_b32 v13, v13, v12
    v_mul_u32_u24 v12, 1280, v12
    v_lshl_add_u32 v13, v13, 4, v12
    buffer_load_dwordx4 v13, s[40:43], s6 offen lds
    s_add_u32 s23, s23, 1
    s_cmp_eq_u32 s23, 20
    s_cselect_b32 s23, 0, s23
    s_lshl_b32 s3, s23, 6
    v_add_u32 v11, s3, v10
    s_lshl_b32 s3, s23, 10
    s_add_u32 m0, s3, s22
    v_mul_u32_u24 v12, 52429, v11
    v_lshrrev_b32 v12, 22, v12
    v_mul_u32_u24 v13, 80, v12
    v_sub_u32 v13, v11, v13
    v_xor_b32 v13, v13, v12
    v_mul_u32_u24 v12, 1280, v12
    v_lshl_add_u32 v13, v13, 4, v12
    buffer_load_dwordx4 v13, s[40:43], s6 offen lds
    s_add_u32 s23, s23, 1
    s_cmp_eq_u32 s23, 20
    s_cselect_b32 s23, 0, s23
    s_lshl_b32 s3, s23, 6
    v_add_u32 v11, s3, v10
    s_lshl_b32 s3, s23, 10
    s_add_u32 m0, s3, s22
    v_mul_u32_u24 v12, 52429, v11
    v_lshrrev_b32 v12, 22, v12
    v_mul_u32_u24 v13, 80, v12
    v_sub_u32 v13, v11, v13
    v_xor_b32 v13, v13, v12
    v_mul_u32_u24 v12, 1280, v12
    v_lshl_add_u32 v13, v13, 4, v12
    buffer_load_dwordx4 v13, s[40:43], s6 offen lds
    s_add_u32 s23, s23, 1
    s_cmp_eq_u32 s23, 20
    s_cselect_b32 s23, 0, s23
    s_lshl_b32 s3, s23, 6
    v_add_u32 v11, s3, v10
    s_lshl_b32 s3, s23, 10
    s_add_u32 m0, s3, s22
    v_mul_u32_u24 v12, 52429, v11
    v_lshrrev_b32 v12, 22, v12
    v_mul_u32_u24 v13, 80, v12
    v_sub_u32 v13, v11, v13
    v_xor_b32 v13, v13, v12
    v_mul_u32_u24 v12, 1280, v12
    v_lshl_add_u32 v13, v13, 4, v12
    buffer_load_dwordx4 v13, s[40:43], s6 offen lds
    s_add_u32 s23, s23, 1
    s_cmp_eq_u32 s23, 20
    s_cselect_b32 s23, 0, s23
    s_lshl_b32 s3, s23, 6
    v_add_u32 v11, s3, v10
    s_lshl_b32 s3, s23, 10
    s_add_u32 m0, s3, s22
    v_mul_u32_u24 v12, 52429, v11
    v_lshrrev_b32 v12, 22, v12
    v_mul_u32_u24 v13, 80, v12
    v_sub_u32 v13, v11, v13
    v_xor_b32 v13, v13, v12
    v_mul_u32_u24 v12, 1280, v12
    v_lshl_add_u32 v13, v13, 4, v12
    buffer_load_dwordx4 v13, s[40:43], s6 offen lds
    s_add_u32 s23, s23, 1
    s_cmp_eq_u32 s23, 20
    s_cselect_b32 s23, 0, s23
    s_lshl_b32 s3, s23, 6
    v_add_u32 v11, s3, v10
    s_lshl_b32 s3, s23, 10
    s_add_u32 m0, s3, s22
    v_mul_u32_u24 v12, 52429, v11
    v_lshrrev_b32 v12, 22, v12
    v_mul_u32_u24 v13, 80, v12
    v_sub_u32 v13, v11, v13
    v_xor_b32 v13, v13, v12
    v_mul_u32_u24 v12, 1280, v12
    v_lshl_add_u32 v13, v13, 4, v12
    buffer_load_dwordx4 v13, s[40:43], s6 offen lds
    s_add_u32 s23, s23, 1
    s_cmp_eq_u32 s23, 20
    s_cselect_b32 s23, 0, s23
    s_lshl_b32 s3, s23, 6
    v_add_u32 v11, s3, v10
    s_lshl_b32 s3, s23, 10
    s_add_u32 m0, s3, s22
    v_mul_u32_u24 v12, 52429, v11
    v_lshrrev_b32 v12, 22, v12
    v_mul_u32_u24 v13, 80, v12
    v_sub_u32 v13, v11, v13
    v_xor_b32 v13, v13, v12
    v_mul_u32_u24 v12, 1280, v12
    v_lshl_add_u32 v13, v13, 4, v12
    buffer_load_dwordx4 v13, s[40:43], s6 offen lds
    s_add_u32 s23, s23, 1
    s_cmp_eq_u32 s23, 20
    s_cselect_b32 s23, 0, s23
    s_lshl_b32 s3, s23, 6
    v_add_u32 v11, s3, v10
    s_lshl_b32 s3, s23, 10
    s_add_u32 m0, s3, s22
    v_mul_u32_u24 v12, 52429, v11
    v_lshrrev_b32 v12, 22, v12
    v_mul_u32_u24 v13, 80, v12
    v_sub_u32 v13, v11, v13
    v_xor_b32 v13, v13, v12
    v_mul_u32_u24 v12, 1280, v12
    v_lshl_add_u32 v13, v13, 4, v12
    buffer_load_dwordx4 v13, s[40:43], s6 offen lds
    s_add_u32 s23, s23, 1
    s_cmp_eq_u32 s23, 20
    s_cselect_b32 s23, 0, s23
    s_lshl_b32 s3, s23, 6
    v_add_u32 v11, s3, v10
    s_lshl_b32 s3, s23, 10
    s_add_u32 m0, s3, s22
    v_mul_u32_u24 v12, 52429, v11
    v_lshrrev_b32 v12, 22, v12
    v_mul_u32_u24 v13, 80, v12
    v_sub_u32 v13, v11, v13
    v_xor_b32 v13, v13, v12
    v_mul_u32_u24 v12, 1280, v12
    v_lshl_add_u32 v13, v13, 4, v12
    buffer_load_dwordx4 v13, s[40:43], s6 offen lds
    s_add_u32 s23, s23, 1
    s_cmp_eq_u32 s23, 20
    s_cselect_b32 s23, 0, s23
    s_lshl_b32 s3, s23, 6
    v_add_u32 v11, s3, v10
    s_lshl_b32 s3, s23, 10
    s_add_u32 m0, s3, s22
    v_mul_u32_u24 v12, 52429, v11
    v_lshrrev_b32 v12, 22, v12
    v_mul_u32_u24 v13, 80, v12
    v_sub_u32 v13, v11, v13
    v_xor_b32 v13, v13, v12
    v_mul_u32_u24 v12, 1280, v12
    v_lshl_add_u32 v13, v13, 4, v12
    buffer_load_dwordx4 v13, s[40:43], s6 offen lds
    s_add_u32 s23, s23, 1
    s_cmp_eq_u32 s23, 20
    s_cselect_b32 s23, 0, s23
    s_lshl_b32 s3, s23, 6
    v_add_u32 v11, s3, v10
    s_lshl_b32 s3, s23, 10
    s_add_u32 m0, s3, s22
    v_mul_u32_u24 v12, 52429, v11
    v_lshrrev_b32 v12, 22, v12
    v_mul_u32_u24 v13, 80, v12
    v_sub_u32 v13, v11, v13
    v_xor_b32 v13, v13, v12
    v_mul_u32_u24 v12, 1280, v12
    v_lshl_add_u32 v13, v13, 4, v12
    buffer_load_dwordx4 v13, s[40:43], s6 offen lds
    s_add_u32 s23, s23, 1
    s_cmp_eq_u32 s23, 20
    s_cselect_b32 s23, 0, s23
    s_lshl_b32 s3, s23, 6
    v_add_u32 v11, s3, v10
    s_lshl_b32 s3, s23, 10
    s_add_u32 m0, s3, s22
    v_mul_u32_u24 v12, 52429, v11
    v_lshrrev_b32 v12, 22, v12
    v_mul_u32_u24 v13, 80, v12
    v_sub_u32 v13, v11, v13
    v_xor_b32 v13, v13, v12
    v_mul_u32_u24 v12, 1280, v12
    v_lshl_add_u32 v13, v13, 4, v12
    buffer_load_dwordx4 v13, s[40:43], s6 offen lds
    s_add_u32 s23, s23, 1
    s_cmp_eq_u32 s23, 20
    s_cselect_b32 s23, 0, s23
    s_lshl_b32 s3, s23, 6
    v_add_u32 v11, s3, v10
    s_lshl_b32 s3, s23, 10
    s_add_u32 m0, s3, s22
    v_mul_u32_u24 v12, 52429, v11
    v_lshrrev_b32 v12, 22, v12
    v_mul_u32_u24 v13, 80, v12
    v_sub_u32 v13, v11, v13
    v_xor_b32 v13, v13, v12
    v_mul_u32_u24 v12, 1280, v12
    v_lshl_add_u32 v13, v13, 4, v12
    buffer_load_dwordx4 v13, s[40:43], s6 offen lds
    s_add_u32 s23, s23, 1
    s_cmp_eq_u32 s23, 20
    s_cselect_b32 s23, 0, s23
L_k_xd_24:
    v_mov_b32 v8, 159996
L_k_lw_27:
    ds_read_b32 v9, v8
    s_waitcnt lgkmcnt(0)
    v_readfirstlane_b32 s3, v9
    s_cmp_lt_u32 s3, 1
    s_cbranch_scc1 L_k_lw_27
    s_mov_b32 s50, s3
    s_waitcnt vmcnt(0)
    s_cmp_lt_u32 s14, 6
    s_cbranch_scc1 L_k_xf
    s_branch L_k_w4_28
L_k_par:
    s_lshr_b32 s7, s50, 16
    s_and_b32 s18, s50, 0xffff
    s_mov_b32 s30, 0x4000
    s_add_u32 s31, s30, 4096
    s_mov_b32 s29, 0x8000
    v_add_u32 v152, 143360, v1
L_k_p4_29:
    buffer_load_dwordx4 v[24:27], v1, s[8:11], s30 offen offset:0 sc1
    buffer_load_dwordx4 v[28:31], v1, s[8:11], s30 offen offset:1024 sc1
    buffer_load_dwordx4 v[32:35], v1, s[8:11], s30 offen offset:2048 sc1
    buffer_load_dwordx4 v[36:39], v1, s[8:11], s30 offen offset:3072 sc1
    buffer_load_dwordx4 v[40:43], v1, s[8:11], s31 offen offset:0 sc1
    s_waitcnt vmcnt(0)
    v_xor_b32 v44, s18, v24
    v_xor_b32 v45, s7, v25
    v_xor_b32 v46, s18, v26
    v_xor_b32 v47, s7, v27
    v_xor_b32 v48, s18, v28
    v_xor_b32 v49, s7, v29
    v_xor_b32 v50, s18, v30
    v_xor_b32 v51, s7, v31
    v_xor_b32 v52, s18, v32
    v_xor_b32 v53, s7, v33
    v_xor_b32 v54, s18, v34
    v_xor_b32 v55, s7, v35
    v_xor_b32 v56, s18, v36
    v_xor_b32 v57, s7, v37
    v_xor_b32 v58, s18, v38
    v_xor_b32 v59, s7, v39
    v_xor_b32 v60, s18, v40
    v_xor_b32 v61, s7, v41
    v_xor_b32 v62, s18, v42
    v_xor_b32 v63, s7, v43
    v_or3_b32 v44, v44, v45, v46
    v_or3_b32 v44, v44, v47, v48
    v_or3_b32 v44, v44, v49, v50
    v_or3_b32 v44, v44, v51, v52
    v_or3_b32 v44, v44, v53, v54
    v_or3_b32 v44, v44, v55, v56
    v_or3_b32 v44, v44, v57, v58
    v_or3_b32 v44, v44, v59, v60
    v_or3_b32 v44, v44, v61, v62
    v_or_b32 v44, v44, v63
    v_and_b32 v44, 0xffff, v44
    v_cmp_ne_u32 vcc, 0, v44
    s_sub_u32 s29, s29, 1
    s_cbranch_scc1 L_k_p4_29x
    s_cbranch_vccz L_k_p4_29x
    s_sleep 2
    s_branch L_k_p4_29
L_k_p4_29x:
    v_and_b32 v24, 0xffff0000, v24
    v_and_b32 v25, 0xffff0000, v25
    v_and_b32 v26, 0xffff0000, v26
    v_and_b32 v27, 0xffff0000, v27
    v_and_b32 v28, 0xffff0000, v28
    v_and_b32 v29, 0xffff0000, v29
    v_and_b32 v30, 0xffff0000, v30
    v_and_b32 v31, 0xffff0000, v31
    v_and_b32 v32, 0xffff0000, v32
    v_and_b32 v33, 0xffff0000, v33
    v_and_b32 v34, 0xffff0000, v34
    v_and_b32 v35, 0xffff0000, v35
    v_and_b32 v36, 0xffff0000, v36
    v_and_b32 v37, 0xffff0000, v37
    v_and_b32 v38, 0xffff0000, v38
    v_and_b32 v39, 0xffff0000, v39
    v_and_b32 v40, 0xffff0000, v40
    v_and_b32 v41, 0xffff0000, v41
    v_and_b32 v42, 0xffff0000, v42
    v_and_b32 v43, 0xffff0000, v43
    ds_write_b128 v152, v[24:27] offset:0
    ds_write_b128 v152, v[28:31] offset:1024
    ds_write_b128 v152, v[32:35] offset:2048
    ds_write_b128 v152, v[36:39] offset:3072
    ds_write_b128 v152, v[40:43] offset:4096
    s_waitcnt lgkmcnt(0)
    s_branch L_k_xf2
L_k_w4_28:
    s_lshl_b32 s20, s15, 10
    s_mul_i32 s19, s13, 122880
    s_add_u32 s19, s19, s20
    s_add_u32 s19, s19, 0x400000
    s_add_u32 s20, s20, 81920
    v_lshrrev_b32 v4, 4, v1
    v_min_u32 v4, 9, v4
    v_lshlrev_b32 v4, 7, v4
    s_lshl_b32 s30, s13, 11
    s_add_u32 s30, s30, 0x44000
    v_lshrrev_b32 v14, 6, v1
    v_mul_u32_u24 v14, 1280, v14
    v_and_b32 v5, 48, v1
    v_add_u32 v14, v14, v5
    s_mul_i32 s3, s15, 20480
    v_add_u32 v14, s3, v14
    v_mov_b32 v6, 0
    v_mov_b32 v7, 0
    v_mov_b32 v20, 0x3f803f80
    s_waitcnt vmcnt(0)
    ds_read_b128 v[24:27], v14 offset:0
    ds_read_b128 v[28:31], v14 offset:64
    ds_read_b128 v[32:35], v14 offset:128
    ds_read_b128 v[36:39], v14 offset:192
    ds_read_b128 v[40:43], v14 offset:256
    ds_read_b128 v[44:47], v14 offset:320
    ds_read_b128 v[48:51], v14 offset:384
    ds_read_b128 v[52:55], v14 offset:448
    ds_read_b128 v[56:59], v14 offset:512
    ds_read_b128 v[60:63], v14 offset:576
    ds_read_b128 v[64:67], v14 offset:640
    ds_read_b128 v[68:71], v14 offset:704
    ds_read_b128 v[72:75], v14 offset:768
    ds_read_b128 v[76:79], v14 offset:832
    ds_read_b128 v[80:83], v14 offset:896
    ds_read_b128 v[84:87], v14 offset:960
    ds_read_b128 v[88:91], v14 offset:1024
    ds_read_b128 v[92:95], v14 offset:1088
    ds_read_b128 v[96:99], v14 offset:1152
    ds_read_b128 v[100:103], v14 offset:1216
    s_waitcnt lgkmcnt(15)
    v_dot2c_f32_bf16 v6, v24, v20
    v_dot2c_f32_bf16 v7, v24, v24
    v_dot2c_f32_bf16 v6, v25, v20
    v_dot2c_f32_bf16 v7, v25, v25
    v_dot2c_f32_bf16 v6, v26, v20
    v_dot2c_f32_bf16 v7, v26, v26
    v_dot2c_f32_bf16 v6, v27, v20
    v_dot2c_f32_bf16 v7, v27, v27
    s_waitcnt lgkmcnt(15)
    v_dot2c_f32_bf16 v6, v28, v20
    v_dot2c_f32_bf16 v7, v28, v28
    v_dot2c_f32_bf16 v6, v29, v20
    v_dot2c_f32_bf16 v7, v29, v29
    v_dot2c_f32_bf16 v6, v30, v20
    v_dot2c_f32_bf16 v7, v30, v30
    v_dot2c_f32_bf16 v6, v31, v20
    v_dot2c_f32_bf16 v7, v31, v31
    s_waitcnt lgkmcnt(15)
    v_dot2c_f32_bf16 v6, v32, v20
    v_dot2c_f32_bf16 v7, v32, v32
    v_dot2c_f32_bf16 v6, v33, v20
    v_dot2c_f32_bf16 v7, v33, v33
    v_dot2c_f32_bf16 v6, v34, v20
    v_dot2c_f32_bf16 v7, v34, v34
    v_dot2c_f32_bf16 v6, v35, v20
    v_dot2c_f32_bf16 v7, v35, v35
    s_waitcnt lgkmcnt(15)
    v_dot2c_f32_bf16 v6, v36, v20
    v_dot2c_f32_bf16 v7, v36, v36
    v_dot2c_f32_bf16 v6, v37, v20
    v_dot2c_f32_bf16 v7, v37, v37
    v_dot2c_f32_bf16 v6, v38, v20
    v_dot2c_f32_bf16 v7, v38, v38
    v_dot2c_f32_bf16 v6, v39, v20
    v_dot2c_f32_bf16 v7, v39, v39
    s_waitcnt lgkmcnt(15)
    v_dot2c_f32_bf16 v6, v40, v20
    v_dot2c_f32_bf16 v7, v40, v40
    v_dot2c_f32_bf16 v6, v41, v20
    v_dot2c_f32_bf16 v7, v41, v41
    v_dot2c_f32_bf16 v6, v42, v20
    v_dot2c_f32_bf16 v7, v42, v42
    v_dot2c_f32_bf16 v6, v43, v20
    v_dot2c_f32_bf16 v7, v43, v43
    s_waitcnt lgkmcnt(14)
    v_dot2c_f32_bf16 v6, v44, v20
    v_dot2c_f32_bf16 v7, v44, v44
    v_dot2c_f32_bf16 v6, v45, v20
    v_dot2c_f32_bf16 v7, v45, v45
    v_dot2c_f32_bf16 v6, v46, v20
    v_dot2c_f32_bf16 v7, v46, v46
    v_dot2c_f32_bf16 v6, v47, v20
    v_dot2c_f32_bf16 v7, v47, v47
    s_waitcnt lgkmcnt(13)
    v_dot2c_f32_bf16 v6, v48, v20
    v_dot2c_f32_bf16 v7, v48, v48
    v_dot2c_f32_bf16 v6, v49, v20
    v_dot2c_f32_bf16 v7, v49, v49
    v_dot2c_f32_bf16 v6, v50, v20
    v_dot2c_f32_bf16 v7, v50, v50
    v_dot2c_f32_bf16 v6, v51, v20
    v_dot2c_f32_bf16 v7, v51, v51
    s_waitcnt lgkmcnt(12)
    v_dot2c_f32_bf16 v6, v52, v20
    v_dot2c_f32_bf16 v7, v52, v52
    v_dot2c_f32_bf16 v6, v53, v20
    v_dot2c_f32_bf16 v7, v53, v53
    v_dot2c_f32_bf16 v6, v54, v20
    v_dot2c_f32_bf16 v7, v54, v54
    v_dot2c_f32_bf16 v6, v55, v20
    v_dot2c_f32_bf16 v7, v55, v55
    s_waitcnt lgkmcnt(11)
    v_dot2c_f32_bf16 v6, v56, v20
    v_dot2c_f32_bf16 v7, v56, v56
    v_dot2c_f32_bf16 v6, v57, v20
    v_dot2c_f32_bf16 v7, v57, v57
    v_dot2c_f32_bf16 v6, v58, v20
    v_dot2c_f32_bf16 v7, v58, v58
    v_dot2c_f32_bf16 v6, v59, v20
    v_dot2c_f32_bf16 v7, v59, v59
    s_waitcnt lgkmcnt(10)
    v_dot2c_f32_bf16 v6, v60, v20
    v_dot2c_f32_bf16 v7, v60, v60
    v_dot2c_f32_bf16 v6, v61, v20
    v_dot2c_f32_bf16 v7, v61, v61
    v_dot2c_f32_bf16 v6, v62, v20
    v_dot2c_f32_bf16 v7, v62, v62
    v_dot2c_f32_bf16 v6, v63, v20
    v_dot2c_f32_bf16 v7, v63, v63
    s_waitcnt lgkmcnt(9)
    v_dot2c_f32_bf16 v6, v64, v20
    v_dot2c_f32_bf16 v7, v64, v64
    v_dot2c_f32_bf16 v6, v65, v20
    v_dot2c_f32_bf16 v7, v65, v65
    v_dot2c_f32_bf16 v6, v66, v20
    v_dot2c_f32_bf16 v7, v66, v66
    v_dot2c_f32_bf16 v6, v67, v20
    v_dot2c_f32_bf16 v7, v67, v67
    s_waitcnt lgkmcnt(8)
    v_dot2c_f32_bf16 v6, v68, v20
    v_dot2c_f32_bf16 v7, v68, v68
    v_dot2c_f32_bf16 v6, v69, v20
    v_dot2c_f32_bf16 v7, v69, v69
    v_dot2c_f32_bf16 v6, v70, v20
    v_dot2c_f32_bf16 v7, v70, v70
    v_dot2c_f32_bf16 v6, v71, v20
    v_dot2c_f32_bf16 v7, v71, v71
    s_waitcnt lgkmcnt(7)
    v_dot2c_f32_bf16 v6, v72, v20
    v_dot2c_f32_bf16 v7, v72, v72
    v_dot2c_f32_bf16 v6, v73, v20
    v_dot2c_f32_bf16 v7, v73, v73
    v_dot2c_f32_bf16 v6, v74, v20
    v_dot2c_f32_bf16 v7, v74, v74
    v_dot2c_f32_bf16 v6, v75, v20
    v_dot2c_f32_bf16 v7, v75, v75
    s_waitcnt lgkmcnt(6)
    v_dot2c_f32_bf16 v6, v76, v20
    v_dot2c_f32_bf16 v7, v76, v76
    v_dot2c_f32_bf16 v6, v77, v20
    v_dot2c_f32_bf16 v7, v77, v77
    v_dot2c_f32_bf16 v6, v78, v20
    v_dot2c_f32_bf16 v7, v78, v78
    v_dot2c_f32_bf16 v6, v79, v20
    v_dot2c_f32_bf16 v7, v79, v79
    s_waitcnt lgkmcnt(5)
    v_dot2c_f32_bf16 v6, v80, v20
    v_dot2c_f32_bf16 v7, v80, v80
    v_dot2c_f32_bf16 v6, v81, v20
    v_dot2c_f32_bf16 v7, v81, v81
    v_dot2c_f32_bf16 v6, v82, v20
    v_dot2c_f32_bf16 v7, v82, v82
    v_dot2c_f32_bf16 v6, v83, v20
    v_dot2c_f32_bf16 v7, v83, v83
    s_waitcnt lgkmcnt(4)
    v_dot2c_f32_bf16 v6, v84, v20
    v_dot2c_f32_bf16 v7, v84, v84
    v_dot2c_f32_bf16 v6, v85, v20
    v_dot2c_f32_bf16 v7, v85, v85
    v_dot2c_f32_bf16 v6, v86, v20
    v_dot2c_f32_bf16 v7, v86, v86
    v_dot2c_f32_bf16 v6, v87, v20
    v_dot2c_f32_bf16 v7, v87, v87
    s_waitcnt lgkmcnt(3)
    v_dot2c_f32_bf16 v6, v88, v20
    v_dot2c_f32_bf16 v7, v88, v88
    v_dot2c_f32_bf16 v6, v89, v20
    v_dot2c_f32_bf16 v7, v89, v89
    v_dot2c_f32_bf16 v6, v90, v20
    v_dot2c_f32_bf16 v7, v90, v90
    v_dot2c_f32_bf16 v6, v91, v20
    v_dot2c_f32_bf16 v7, v91, v91
    s_waitcnt lgkmcnt(2)
    v_dot2c_f32_bf16 v6, v92, v20
    v_dot2c_f32_bf16 v7, v92, v92
    v_dot2c_f32_bf16 v6, v93, v20
    v_dot2c_f32_bf16 v7, v93, v93
    v_dot2c_f32_bf16 v6, v94, v20
    v_dot2c_f32_bf16 v7, v94, v94
    v_dot2c_f32_bf16 v6, v95, v20
    v_dot2c_f32_bf16 v7, v95, v95
    s_waitcnt lgkmcnt(1)
    v_dot2c_f32_bf16 v6, v96, v20
    v_dot2c_f32_bf16 v7, v96, v96
    v_dot2c_f32_bf16 v6, v97, v20
    v_dot2c_f32_bf16 v7, v97, v97
    v_dot2c_f32_bf16 v6, v98, v20
    v_dot2c_f32_bf16 v7, v98, v98
    v_dot2c_f32_bf16 v6, v99, v20
    v_dot2c_f32_bf16 v7, v99, v99
    s_waitcnt lgkmcnt(0)
    v_dot2c_f32_bf16 v6, v100, v20
    v_dot2c_f32_bf16 v7, v100, v100
    v_dot2c_f32_bf16 v6, v101, v20
    v_dot2c_f32_bf16 v7, v101, v101
    v_dot2c_f32_bf16 v6, v102, v20
    v_dot2c_f32_bf16 v7, v102, v102
    v_dot2c_f32_bf16 v6, v103, v20
    v_dot2c_f32_bf16 v7, v103, v103
    s_nop 2
    s_nop 1
    v_add_f32_dpp v6, v6, v6 quad_perm:[1,0,3,2] row_mask:0xf bank_mask:0xf
    v_add_f32_dpp v7, v7, v7 quad_perm:[1,0,3,2] row_mask:0xf bank_mask:0xf
    s_nop 1
    v_add_f32_dpp v6, v6, v6 quad_perm:[2,3,0,1] row_mask:0xf bank_mask:0xf
    v_add_f32_dpp v7, v7, v7 quad_perm:[2,3,0,1] row_mask:0xf bank_mask:0xf
    v_mul_f32 v6, 0x3acccccd, v6
    v_mul_f32 v7, 0x3acccccd, v7
    v_fma_f32 v7, -v6, v6, v7
    v_max_f32 v7, 0, v7
    v_add_f32 v7, 0x3727c5ac, v7
    v_rsq_f32 v10, v7
    s_nop 0
    v_mul_f32 v6, v6, v10
    v_sub_f32 v11, 0, v6
    v_lshrrev_b32 v14, 6, v1
    v_lshlrev_b32 v14, 3, v14
    s_lshl_b32 s3, s15, 7
    s_add_u32 s3, s3, 148480
    v_add_u32 v14, s3, v14
    ds_write_b64 v14, v[10:11]
    v_mov_b32 v8, 159840
    v_mov_b32 v9, 1
    s_mov_b64 exec, 1
    s_waitcnt lgkmcnt(0)
    ds_add_u32 v8, v9
    s_mov_b64 exec, -1
    v_mov_b32 v12, 159828
    s_cmp_lg_u32 s15, 0
    s_cbranch_scc1 L_k_gw_32
    s_mov_b32 s29, 0x8000
L_k_gp_30:
    buffer_load_dword v6, v4, s[8:11], s30 offen sc1
    s_waitcnt vmcnt(0)
    v_xor_b32 v6, s50, v6
    v_cmp_ne_u32 vcc, 0, v6
    s_sub_u32 s29, s29, 1
    s_cbranch_scc1 L_k_go_31
    s_cbranch_vccz L_k_go_31
    s_sleep 2
    s_branch L_k_gp_30
L_k_go_31:
    v_mov_b32 v13, 1
    ds_write_b32 v12, v13
    s_waitcnt lgkmcnt(0)
    s_branch L_k_gd_33
L_k_gw_32:
    ds_read_b32 v13, v12
    s_waitcnt lgkmcnt(0)
    v_readfirstlane_b32 s3, v13
    s_cmp_eq_u32 s3, 1
    s_cbranch_scc1 L_k_gd_33
    s_sleep 1
    s_branch L_k_gw_32
L_k_gd_33:
    s_waitcnt vmcnt(0)
    s_add_u32 m0, s20, 0
    s_nop 0
    buffer_load_dwordx4 v1, s[8:11], s19 offen sc1 lds
    s_add_u32 s19, s19, 4096
    s_add_u32 m0, s20, 4096
    s_nop 0
    buffer_load_dwordx4 v1, s[8:11], s19 offen sc1 lds
    s_add_u32 s19, s19, 4096
    s_add_u32 m0, s20, 8192
    s_nop 0
    buffer_load_dwordx4 v1, s[8:11], s19 offen sc1 lds
    s_add_u32 s19, s19, 4096
    s_add_u32 m0, s20, 12288
    s_nop 0
    buffer_load_dwordx4 v1, s[8:11], s19 offen sc1 lds
    s_add_u32 s19, s19, 4096
    s_add_u32 m0, s20, 16384
    s_nop 0
    buffer_load_dwordx4 v1, s[8:11], s19 offen sc1 lds
    s_add_u32 s19, s19, 4096
    s_add_u32 m0, s20, 20480
    s_nop 0
    buffer_load_dwordx4 v1, s[8:11], s19 offen sc1 lds
    s_add_u32 s19, s19, 4096
    s_add_u32 m0, s20, 24576
    s_nop 0
    buffer_load_dwordx4 v1, s[8:11], s19 offen sc1 lds
    s_add_u32 s19, s19, 4096
    s_add_u32 m0, s20, 28672
    s_nop 0
    buffer_load_dwordx4 v1, s[8:11], s19 offen sc1 lds
    s_add_u32 s19, s19, 4096
    s_add_u32 m0, s20, 32768
    s_nop 0
    buffer_load_dwordx4 v1, s[8:11], s19 offen sc1 lds
    s_add_u32 s19, s19, 4096
    s_add_u32 m0, s20, 36864
    s_nop 0
    buffer_load_dwordx4 v1, s[8:11], s19 offen sc1 lds
    s_add_u32 s19, s19, 4096
    s_add_u32 m0, s20, 40960
    s_nop 0
    buffer_load_dwordx4 v1, s[8:11], s19 offen sc1 lds
    s_add_u32 s19, s19, 4096
    s_add_u32 m0, s20, 45056
    s_nop 0
    buffer_load_dwordx4 v1, s[8:11], s19 offen sc1 lds
    s_add_u32 s19, s19, 4096
    s_branch L_k_xf
L_k_p1load:
    s_add_u32 m0, s20, 49152
    s_nop 0
    buffer_load_dwordx4 v1, s[8:11], s19 offen sc1 lds
    s_add_u32 s19, s19, 4096
    s_add_u32 m0, s20, 53248
    s_nop 0
    buffer_load_dwordx4 v1, s[8:11], s19 offen sc1 lds
    s_add_u32 s19, s19, 4096
    s_add_u32 m0, s20, 57344
    s_nop 0
    buffer_load_dwordx4 v1, s[8:11], s19 offen sc1 lds
    s_add_u32 s19, s19, 4096
    s_waitcnt lgkmcnt(0)
    s_waitcnt vmcnt(3)
    s_barrier
    s_waitcnt vmcnt(1)
    s_barrier
    s_add_u32 m0, s20, 0
    s_nop 0
    buffer_load_dwordx4 v1, s[8:11], s19 offen sc1 lds
    s_add_u32 s19, s19, 4096
    s_add_u32 m0, s20, 4096
    s_nop 0
    buffer_load_dwordx4 v1, s[8:11], s19 offen sc1 lds
    s_add_u32 s19, s19, 4096
    s_add_u32 m0, s20, 8192
    s_nop 0
    buffer_load_dwordx4 v1, s[8:11], s19 offen sc1 lds
    s_add_u32 s19, s19, 4096
    s_add_u32 m0, s20, 12288
    s_nop 0
    buffer_load_dwordx4 v1, s[8:11], s19 offen sc1 lds
    s_add_u32 s19, s19, 4096
    s_waitcnt vmcnt(3)
    s_barrier
    s_add_u32 m0, s20, 16384
    s_nop 0
    buffer_load_dwordx4 v1, s[8:11], s19 offen sc1 lds
    s_add_u32 s19, s19, 4096
    s_add_u32 m0, s20, 20480
    s_nop 0
    buffer_load_dwordx4 v1, s[8:11], s19 offen sc1 lds
    s_add_u32 s19, s19, 4096
    s_add_u32 m0, s20, 24576
    s_nop 0
    buffer_load_dwordx4 v1, s[8:11], s19 offen sc1 lds
    s_add_u32 s19, s19, 4096
    s_add_u32 m0, s20, 28672
    s_nop 0
    buffer_load_dwordx4 v1, s[8:11], s19 offen sc1 lds
    s_add_u32 s19, s19, 4096
    s_waitcnt vmcnt(5)
    s_barrier
    s_add_u32 m0, s20, 32768
    s_nop 0
    buffer_load_dwordx4 v1, s[8:11], s19 offen sc1 lds
    s_add_u32 s19, s19, 4096
    s_add_u32 m0, s20, 36864
    s_nop 0
    buffer_load_dwordx4 v1, s[8:11], s19 offen sc1 lds
    s_add_u32 s19, s19, 4096
    s_add_u32 m0, s20, 40960
    s_nop 0
    buffer_load_dwordx4 v1, s[8:11], s19 offen sc1 lds
    s_add_u32 s19, s19, 4096
    s_add_u32 m0, s20, 45056
    s_nop 0
    buffer_load_dwordx4 v1, s[8:11], s19 offen sc1 lds
    s_add_u32 s19, s19, 4096
    s_waitcnt vmcnt(7)
    s_barrier
    s_add_u32 m0, s20, 49152
    s_nop 0
    buffer_load_dwordx4 v1, s[8:11], s19 offen sc1 lds
    s_add_u32 s19, s19, 4096
    s_add_u32 m0, s20, 53248
    s_nop 0
    buffer_load_dwordx4 v1, s[8:11], s19 offen sc1 lds
    s_add_u32 s19, s19, 4096
    s_waitcnt vmcnt(7)
    s_barrier
    s_add_u32 m0, s20, 57344
    s_nop 0
    buffer_load_dwordx4 v1, s[8:11], s19 offen sc1 lds
    s_add_u32 s19, s19, 4096
    s_waitcnt vmcnt(6)
    s_barrier
    s_waitcnt vmcnt(4)
    s_barrier
    s_waitcnt vmcnt(2)
    s_barrier
    s_waitcnt vmcnt(0)
    s_barrier
    s_barrier
    s_branch L_k_helper
L_k_att:
    v_lshrrev_b32 v7, 2, v1
    s_lshr_b32 s15, s14, 1
    s_and_b32 s16, s14, 1
    s_lshl_b32 s16, s16, 1
    s_lshl_b32 s17, s12, 1
    s_add_u32 s17, s17, s15
    s_mul_i32 s3, s15, 5120
    s_add_u32 s3, s3, 81920
    s_lshl_b32 s6, s16, 2
    s_add_u32 s6, s6, s3
    v_add_u32 v9, s6, v1
    s_lshl_b32 s6, s16, 10
    s_add_u32 s3, s3, s6
    v_add_u32 v8, s3, v1
    ds_read_b128 v[120:123], v8 offset:0
    ds_read_b32 v124, v9 offset:4096
    ds_read_b128 v[128:131], v8 offset:1024
    ds_read_b32 v132, v9 offset:4100
    s_lshl_b32 s38, s12, 8
    s_lshl_b32 s6, s13, 2
    s_add_u32 s6, s6, s14
    s_lshl_b32 s6, s6, 2
    s_add_u32 s38, s38, s6
    s_add_u32 s38, s38, 0x14020
    s_mov_b32 s39, 0
    s_lshl_b32 s51, s14, 2
    s_add_u32 s51, s51, 159744
    v_mov_b32 v125, 0
    v_mov_b32 v126, 0
    v_mov_b32 v104, 0xff800000
    v_mov_b32 v133, 0
    v_mov_b32 v134, 0
    v_mov_b32 v112, 0xff800000
    v_mov_b32 v127, 0
    v_mov_b32 v135, 0
    v_mov_b32 v143, 0
    v_mov_b32 v141, 0xbf80bf80
    v_mov_b32 v142, 0xbf80bf80
    s_mov_b32 s24, 0
    s_mov_b32 s25, 26624
    v_mov_b32 v152, 159812
    v_mov_b32 v4, v1
    v_mov_b32 v6, v1
    v_mov_b32 v5, v7
    v_mov_b32 v72, 0
    v_mov_b32 v73, 0
    v_mov_b32 v74, 0
    v_mov_b32 v75, 0
    v_mov_b32 v76, 0
    v_mov_b32 v77, 0
    v_mov_b32 v78, 0
    v_mov_b32 v79, 0
    v_mov_b32 v80, 0
    v_mov_b32 v81, 0
    v_mov_b32 v82, 0
    v_mov_b32 v83, 0
    v_mov_b32 v84, 0
    v_mov_b32 v85, 0
    v_mov_b32 v86, 0
    v_mov_b32 v87, 0
    v_mov_b32 v36, 0
    v_mov_b32 v37, 0
    v_mov_b32 v38, 0
    v_mov_b32 v39, 0
    v_mov_b32 v88, 0
    v_mov_b32 v89, 0
    v_mov_b32 v90, 0
    v_mov_b32 v91, 0
    v_mov_b32 v92, 0
    v_mov_b32 v93, 0
    v_mov_b32 v94, 0
    v_mov_b32 v95, 0
    v_mov_b32 v96, 0
    v_mov_b32 v97, 0
    v_mov_b32 v98, 0
    v_mov_b32 v99, 0
    v_mov_b32 v100, 0
    v_mov_b32 v101, 0
    v_mov_b32 v102, 0
    v_mov_b32 v103, 0
    v_mov_b32 v68, 0
    v_mov_b32 v69, 0
    v_mov_b32 v70, 0
    v_mov_b32 v71, 0
    v_mov_b32 v148, 0
    v_mov_b32 v149, 0
    v_mov_b32 v150, 0
    v_mov_b32 v151, 0
    s_mul_i32 s6, s13, 20
    s_mul_i32 s7, s16, 5
    s_add_u32 s6, s6, s7
    s_mul_i32 s22, s17, 40960
    s_add_u32 s22, s22, 0xe00000
    s_mul_i32 s7, s12, 81920
    s_add_u32 s22, s22, s7
    v_add_u32 v8, s6, v3
    v_add_u32 v8, 0, v8
    v_lshrrev_b32 v9, 2, v8
    v_lshlrev_b32 v9, 10, v9
    v_and_b32 v10, 1, v8
    v_lshl_add_u32 v9, v10, 9, v9
    v_bfe_u32 v10, v8, 1, 1
    v_lshl_add_u32 v9, v10, 3, v9
    v_lshl_add_u32 v154, v2, 4, v9
    v_add_u32 v8, s6, v3
    v_add_u32 v8, 2, v8
    v_lshrrev_b32 v9, 2, v8
    v_lshlrev_b32 v9, 10, v9
    v_and_b32 v10, 1, v8
    v_lshl_add_u32 v9, v10, 9, v9
    v_bfe_u32 v10, v8, 1, 1
    v_lshl_add_u32 v9, v10, 3, v9
    v_lshl_add_u32 v155, v2, 4, v9
    v_mov_b32 v8, s6
    v_add_u32 v8, 4, v8
    v_lshrrev_b32 v9, 2, v8
    v_lshlrev_b32 v9, 10, v9
    v_and_b32 v10, 1, v8
    v_lshl_add_u32 v9, v10, 9, v9
    v_bfe_u32 v10, v8, 1, 1
    v_lshl_add_u32 v9, v10, 3, v9
    v_lshl_add_u32 v156, v2, 4, v9
    v_add_u32 v8, s6, v3
    v_add_u32 v8, 5, v8
    v_lshrrev_b32 v9, 2, v8
    v_lshlrev_b32 v9, 10, v9
    v_and_b32 v10, 1, v8
    v_lshl_add_u32 v9, v10, 9, v9
    v_bfe_u32 v10, v8, 1, 1
    v_lshl_add_u32 v9, v10, 3, v9
    v_lshl_add_u32 v157, v2, 4, v9
    v_add_u32 v8, s6, v3
    v_add_u32 v8, 7, v8
    v_lshrrev_b32 v9, 2, v8
    v_lshlrev_b32 v9, 10, v9
    v_and_b32 v10, 1, v8
    v_lshl_add_u32 v9, v10, 9, v9
    v_bfe_u32 v10, v8, 1, 1
    v_lshl_add_u32 v9, v10, 3, v9
    v_lshl_add_u32 v158, v2, 4, v9
    v_mov_b32 v8, s6
    v_add_u32 v8, 9, v8
    v_lshrrev_b32 v9, 2, v8
    v_lshlrev_b32 v9, 10, v9
    v_and_b32 v10, 1, v8
    v_lshl_add_u32 v9, v10, 9, v9
    v_bfe_u32 v10, v8, 1, 1
    v_lshl_add_u32 v9, v10, 3, v9
    v_lshl_add_u32 v159, v2, 4, v9
    v_mov_b32 v160, 159776
    v_mov_b32 v162, 0
    v_mov_b32 v163, 0
    v_mov_b32 v161, 1
    s_waitcnt vmcnt(0) lgkmcnt(0)
    s_barrier
    ds_read_b128 v[136:139], v1 offset:0
    ds_read_b32 v140, v7 offset:24576
    s_waitcnt lgkmcnt(0)
    v_mfma_f32_32x32x16_bf16 v[8:23], v[140:143], v[124:127], 0
    v_mfma_f32_32x32x16_bf16 v[40:55], v[140:143], v[132:135], 0
    v_mfma_f32_32x32x16_bf16 v[8:23], v[136:139], v[120:123], v[8:23]
    v_mfma_f32_32x32x16_bf16 v[40:55], v[136:139], v[128:131], v[40:55]
    s_nop 10
    v_max3_f32 v104, v8, v9, v104
    v_max3_f32 v104, v10, v11, v104
    v_max3_f32 v104, v12, v13, v104
    v_max3_f32 v104, v14, v15, v104
    v_max3_f32 v104, v16, v17, v104
    v_max3_f32 v104, v18, v19, v104
    v_max3_f32 v104, v20, v21, v104
    v_max3_f32 v104, v22, v23, v104
    v_max3_f32 v112, v40, v41, v112
    v_max3_f32 v112, v42, v43, v112
    v_max3_f32 v112, v44, v45, v112
    v_max3_f32 v112, v46, v47, v112
    v_max3_f32 v112, v48, v49, v112
    v_max3_f32 v112, v50, v51, v112
    v_max3_f32 v112, v52, v53, v112
    v_max3_f32 v112, v54, v55, v112
    v_cmp_eq_u32 vcc, 0, v3
    v_mov_b32 v105, v104
    s_nop 1
    v_permlane32_swap_b32 v104, v105
    s_nop 1
    v_max_f32 v104, v104, v105
    v_and_b32 v105, 0xffff0000, v104
    v_sub_f32 v106, v104, v105
    v_and_b32 v107, 0xffff0000, v106
    v_sub_f32 v106, v106, v107
    v_lshrrev_b32 v105, 16, v105
    v_or_b32 v105, v105, v107
    v_lshrrev_b32 v106, 16, v106
    v_cndmask_b32 v125, 0, v105, vcc
    v_cndmask_b32 v126, 0, v106, vcc
    v_mov_b32 v113, v112
    s_nop 1
    v_permlane32_swap_b32 v112, v113
    s_nop 1
    v_max_f32 v112, v112, v113
    v_and_b32 v113, 0xffff0000, v112
    v_sub_f32 v114, v112, v113
    v_and_b32 v115, 0xffff0000, v114
    v_sub_f32 v114, v114, v115
    v_lshrrev_b32 v113, 16, v113
    v_or_b32 v113, v113, v115
    v_lshrrev_b32 v114, 16, v114
    v_cndmask_b32 v133, 0, v113, vcc
    v_cndmask_b32 v134, 0, v114, vcc
L_k_main:
    v_mov_b32 v108, 0
    v_mov_b32 v109, 0
    v_mov_b32 v116, 0
    v_mov_b32 v117, 0
    v_mfma_f32_32x32x16_bf16 v[8:23], v[140:143], v[124:127], 0
    v_mfma_f32_32x32x16_bf16 v[40:55], v[140:143], v[132:135], 0
    v_mfma_f32_32x32x16_bf16 v[8:23], v[136:139], v[120:123], v[8:23]
    v_mfma_f32_32x32x16_bf16 v[40:55], v[136:139], v[128:131], v[40:55]
    ds_read_b32 v140, v5 offset:24832
    ds_read_b32 v153, v5
    ds_read_b128 v[136:139], v4 offset:1024
    ds_read_b128 v[144:147], v4 offset:8192
    s_nop 5
L_k_loop:
    v_cvt_pk_bf16_f32 v110, v36, v37
    v_cvt_pk_bf16_f32 v111, v38, v39
    s_waitcnt lgkmcnt(2)
    v_mfma_f32_32x32x16_bf16 v[24:39], v[140:143], v[124:127], 0
    v_exp_f32 v8, v8
    v_exp_f32 v9, v9
    v_exp_f32 v10, v10
    v_exp_f32 v11, v11
    v_cvt_pk_bf16_f32 v118, v68, v69
    v_cvt_pk_bf16_f32 v119, v70, v71
    v_mfma_f32_32x32x16_bf16 v[56:71], v[140:143], v[132:135], 0
    ds_read_b32 v140, v5 offset:25088
    v_exp_f32 v40, v40
    v_exp_f32 v41, v41
    v_exp_f32 v42, v42
    v_exp_f32 v43, v43
    v_cvt_pk_bf16_f32 v104, v8, v9
    v_cvt_pk_bf16_f32 v105, v10, v11
    v_mfma_f32_32x32x16_bf16 v[72:87], v[148:151], v[108:111], v[72:87]
    v_exp_f32 v12, v12
    v_exp_f32 v13, v13
    v_exp_f32 v14, v14
    v_exp_f32 v15, v15
    v_cvt_pk_bf16_f32 v112, v40, v41
    v_cvt_pk_bf16_f32 v113, v42, v43
    v_mfma_f32_32x32x16_bf16 v[88:103], v[148:151], v[116:119], v[88:103]
    ds_read_b128 v[148:151], v6 offset:9216
    v_exp_f32 v44, v44
    v_exp_f32 v45, v45
    v_exp_f32 v46, v46
    v_exp_f32 v47, v47
    v_cvt_pk_bf16_f32 v106, v12, v13
    v_cvt_pk_bf16_f32 v107, v14, v15
    s_waitcnt lgkmcnt(2)
    v_mfma_f32_32x32x16_bf16 v[24:39], v[136:139], v[120:123], v[24:39]
    v_exp_f32 v16, v16
    v_exp_f32 v17, v17
    v_exp_f32 v18, v18
    v_exp_f32 v19, v19
    v_cvt_pk_bf16_f32 v114, v44, v45
    v_cvt_pk_bf16_f32 v115, v46, v47
    v_mfma_f32_32x32x16_bf16 v[56:71], v[136:139], v[128:131], v[56:71]
    ds_read_b128 v[136:139], v4 offset:2048
    v_exp_f32 v48, v48
    v_exp_f32 v49, v49
    v_exp_f32 v50, v50
    v_exp_f32 v51, v51
    v_cvt_pk_bf16_f32 v108, v16, v17
    v_cvt_pk_bf16_f32 v109, v18, v19
    v_mfma_f32_32x32x16_bf16 v[72:87], v[144:147], v[104:107], v[72:87]
    v_exp_f32 v20, v20
    v_exp_f32 v21, v21
    v_exp_f32 v22, v22
    v_exp_f32 v23, v23
    v_cvt_pk_bf16_f32 v116, v48, v49
    v_cvt_pk_bf16_f32 v117, v50, v51
    v_mfma_f32_32x32x16_bf16 v[88:103], v[144:147], v[112:115], v[88:103]
    ds_read_b128 v[144:147], v6 offset:10240
    v_exp_f32 v52, v52
    v_exp_f32 v53, v53
    v_exp_f32 v54, v54
    v_exp_f32 v55, v55
    v_cvt_pk_bf16_f32 v110, v20, v21
    v_cvt_pk_bf16_f32 v111, v22, v23
    s_waitcnt lgkmcnt(2)
    v_mfma_f32_32x32x16_bf16 v[8:23], v[140:143], v[124:127], 0
    v_exp_f32 v24, v24
    v_exp_f32 v25, v25
    v_exp_f32 v26, v26
    v_exp_f32 v27, v27
    v_cvt_pk_bf16_f32 v118, v52, v53
    v_cvt_pk_bf16_f32 v119, v54, v55
    v_mfma_f32_32x32x16_bf16 v[40:55], v[140:143], v[132:135], 0
    ds_read_b32 v140, v5 offset:25344
    v_exp_f32 v56, v56
    v_exp_f32 v57, v57
    v_exp_f32 v58, v58
    v_exp_f32 v59, v59
    v_cvt_pk_bf16_f32 v104, v24, v25
    v_cvt_pk_bf16_f32 v105, v26, v27
    v_mfma_f32_32x32x16_bf16 v[72:87], v[148:151], v[108:111], v[72:87]
    v_exp_f32 v28, v28
    v_exp_f32 v29, v29
    v_exp_f32 v30, v30
    v_exp_f32 v31, v31
    v_cvt_pk_bf16_f32 v112, v56, v57
    v_cvt_pk_bf16_f32 v113, v58, v59
    v_mfma_f32_32x32x16_bf16 v[88:103], v[148:151], v[116:119], v[88:103]
    ds_read_b128 v[148:151], v6 offset:11264
    v_exp_f32 v60, v60
    v_exp_f32 v61, v61
    v_exp_f32 v62, v62
    v_exp_f32 v63, v63
    v_cvt_pk_bf16_f32 v106, v28, v29
    v_cvt_pk_bf16_f32 v107, v30, v31
    s_waitcnt lgkmcnt(2)
    v_mfma_f32_32x32x16_bf16 v[8:23], v[136:139], v[120:123], v[8:23]
    v_exp_f32 v32, v32
    v_exp_f32 v33, v33
    v_exp_f32 v34, v34
    v_exp_f32 v35, v35
    v_cvt_pk_bf16_f32 v114, v60, v61
    v_cvt_pk_bf16_f32 v115, v62, v63
    v_mfma_f32_32x32x16_bf16 v[40:55], v[136:139], v[128:131], v[40:55]
    ds_read_b128 v[136:139], v4 offset:3072
    v_exp_f32 v64, v64
    v_exp_f32 v65, v65
    v_exp_f32 v66, v66
    v_exp_f32 v67, v67
    v_cvt_pk_bf16_f32 v108, v32, v33
    v_cvt_pk_bf16_f32 v109, v34, v35
    v_mfma_f32_32x32x16_bf16 v[72:87], v[144:147], v[104:107], v[72:87]
    v_exp_f32 v36, v36
    v_exp_f32 v37, v37
    v_exp_f32 v38, v38
    v_exp_f32 v39, v39
    v_cvt_pk_bf16_f32 v116, v64, v65
    v_cvt_pk_bf16_f32 v117, v66, v67
    v_mfma_f32_32x32x16_bf16 v[88:103], v[144:147], v[112:115], v[88:103]
    ds_read_b128 v[144:147], v6 offset:12288
    v_exp_f32 v68, v68
    v_exp_f32 v69, v69
    v_exp_f32 v70, v70
    v_exp_f32 v71, v71
    v_cvt_pk_bf16_f32 v110, v36, v37
    v_cvt_pk_bf16_f32 v111, v38, v39
    s_waitcnt lgkmcnt(2)
    v_mfma_f32_32x32x16_bf16 v[24:39], v[140:143], v[124:127], 0
    v_exp_f32 v8, v8
    v_exp_f32 v9, v9
    v_exp_f32 v10, v10
    v_exp_f32 v11, v11
    v_cvt_pk_bf16_f32 v118, v68, v69
    v_cvt_pk_bf16_f32 v119, v70, v71
    v_mfma_f32_32x32x16_bf16 v[56:71], v[140:143], v[132:135], 0
    ds_read_b32 v140, v5 offset:25600
    v_exp_f32 v40, v40
    v_exp_f32 v41, v41
    v_exp_f32 v42, v42
    v_exp_f32 v43, v43
    v_cvt_pk_bf16_f32 v104, v8, v9
    v_cvt_pk_bf16_f32 v105, v10, v11
    v_mfma_f32_32x32x16_bf16 v[72:87], v[148:151], v[108:111], v[72:87]
    v_exp_f32 v12, v12
    v_exp_f32 v13, v13
    v_exp_f32 v14, v14
    v_exp_f32 v15, v15
    v_cvt_pk_bf16_f32 v112, v40, v41
    v_cvt_pk_bf16_f32 v113, v42, v43
    v_mfma_f32_32x32x16_bf16 v[88:103], v[148:151], v[116:119], v[88:103]
    ds_read_b128 v[148:151], v6 offset:13312
    v_exp_f32 v44, v44
    v_exp_f32 v45, v45
    v_exp_f32 v46, v46
    v_exp_f32 v47, v47
    v_cvt_pk_bf16_f32 v106, v12, v13
    v_cvt_pk_bf16_f32 v107, v14, v15
    s_waitcnt lgkmcnt(2)
    v_mfma_f32_32x32x16_bf16 v[24:39], v[136:139], v[120:123], v[24:39]
    v_exp_f32 v16, v16
    v_exp_f32 v17, v17
    v_exp_f32 v18, v18
    v_exp_f32 v19, v19
    v_cvt_pk_bf16_f32 v114, v44, v45
    v_cvt_pk_bf16_f32 v115, v46, v47
    v_mfma_f32_32x32x16_bf16 v[56:71], v[136:139], v[128:131], v[56:71]
    ds_read_b128 v[136:139], v4 offset:4096
    v_exp_f32 v48, v48
    v_exp_f32 v49, v49
    v_exp_f32 v50, v50
    v_exp_f32 v51, v51
    v_cvt_pk_bf16_f32 v108, v16, v17
    v_cvt_pk_bf16_f32 v109, v18, v19
    v_mfma_f32_32x32x16_bf16 v[72:87], v[144:147], v[104:107], v[72:87]
    v_exp_f32 v20, v20
    v_exp_f32 v21, v21
    v_exp_f32 v22, v22
    v_exp_f32 v23, v23
    v_cvt_pk_bf16_f32 v116, v48, v49
    v_cvt_pk_bf16_f32 v117, v50, v51
    v_mfma_f32_32x32x16_bf16 v[88:103], v[144:147], v[112:115], v[88:103]
    ds_read_b128 v[144:147], v6 offset:14336
    v_exp_f32 v52, v52
    v_exp_f32 v53, v53
    v_exp_f32 v54, v54
    v_exp_f32 v55, v55
    v_cvt_pk_bf16_f32 v110, v20, v21
    v_cvt_pk_bf16_f32 v111, v22, v23
    s_waitcnt lgkmcnt(2)
    v_mfma_f32_32x32x16_bf16 v[8:23], v[140:143], v[124:127], 0
    v_exp_f32 v24, v24
    v_exp_f32 v25, v25
    v_exp_f32 v26, v26
    v_exp_f32 v27, v27
    v_cvt_pk_bf16_f32 v118, v52, v53
    v_cvt_pk_bf16_f32 v119, v54, v55
    v_mfma_f32_32x32x16_bf16 v[40:55], v[140:143], v[132:135], 0
    ds_read_b32 v140, v5 offset:25856
    v_exp_f32 v56, v56
    v_exp_f32 v57, v57
    v_exp_f32 v58, v58
    v_exp_f32 v59, v59
    v_cvt_pk_bf16_f32 v104, v24, v25
    v_cvt_pk_bf16_f32 v105, v26, v27
    v_mfma_f32_32x32x16_bf16 v[72:87], v[148:151], v[108:111], v[72:87]
    v_exp_f32 v28, v28
    v_exp_f32 v29, v29
    v_exp_f32 v30, v30
    v_exp_f32 v31, v31
    v_cvt_pk_bf16_f32 v112, v56, v57
    v_cvt_pk_bf16_f32 v113, v58, v59
    v_mfma_f32_32x32x16_bf16 v[88:103], v[148:151], v[116:119], v[88:103]
    ds_read_b128 v[148:151], v6 offset:15360
    v_exp_f32 v60, v60
    v_exp_f32 v61, v61
    v_exp_f32 v62, v62
    v_exp_f32 v63, v63
    v_cvt_pk_bf16_f32 v106, v28, v29
    v_cvt_pk_bf16_f32 v107, v30, v31
    s_waitcnt lgkmcnt(2)
    v_mfma_f32_32x32x16_bf16 v[8:23], v[136:139], v[120:123], v[8:23]
    v_exp_f32 v32, v32
    v_exp_f32 v33, v33
    v_exp_f32 v34, v34
    v_exp_f32 v35, v35
    v_cvt_pk_bf16_f32 v114, v60, v61
    v_cvt_pk_bf16_f32 v115, v62, v63
    v_mfma_f32_32x32x16_bf16 v[40:55], v[136:139], v[128:131], v[40:55]
    ds_read_b128 v[136:139], v4 offset:5120
    v_exp_f32 v64, v64
    v_exp_f32 v65, v65
    v_exp_f32 v66, v66
    v_exp_f32 v67, v67
    v_cvt_pk_bf16_f32 v108, v32, v33
    v_cvt_pk_bf16_f32 v109, v34, v35
    v_mfma_f32_32x32x16_bf16 v[72:87], v[144:147], v[104:107], v[72:87]
    v_exp_f32 v36, v36
    v_exp_f32 v37, v37
    v_exp_f32 v38, v38
    v_exp_f32 v39, v39
    v_cvt_pk_bf16_f32 v116, v64, v65
    v_cvt_pk_bf16_f32 v117, v66, v67
    v_mfma_f32_32x32x16_bf16 v[88:103], v[144:147], v[112:115], v[88:103]
    ds_read_b128 v[144:147], v6 offset:16384
    v_exp_f32 v68, v68
    v_exp_f32 v69, v69
    v_exp_f32 v70, v70
    v_exp_f32 v71, v71
    v_cvt_pk_bf16_f32 v110, v36, v37
    v_cvt_pk_bf16_f32 v111, v38, v39
    s_waitcnt lgkmcnt(2)
    v_mfma_f32_32x32x16_bf16 v[24:39], v[140:143], v[124:127], 0
    v_exp_f32 v8, v8
    v_exp_f32 v9, v9
    v_exp_f32 v10, v10
    v_exp_f32 v11, v11
    v_cvt_pk_bf16_f32 v118, v68, v69
    v_cvt_pk_bf16_f32 v119, v70, v71
    v_mfma_f32_32x32x16_bf16 v[56:71], v[140:143], v[132:135], 0
    ds_read_b32 v140, v5 offset:26112
    v_exp_f32 v40, v40
    v_exp_f32 v41, v41
    v_exp_f32 v42, v42
    v_exp_f32 v43, v43
    v_cvt_pk_bf16_f32 v104, v8, v9
    v_cvt_pk_bf16_f32 v105, v10, v11
    v_mfma_f32_32x32x16_bf16 v[72:87], v[148:151], v[108:111], v[72:87]
    v_exp_f32 v12, v12
    v_exp_f32 v13, v13
    v_exp_f32 v14, v14
    v_exp_f32 v15, v15
    v_cvt_pk_bf16_f32 v112, v40, v41
    v_cvt_pk_bf16_f32 v113, v42, v43
    v_mfma_f32_32x32x16_bf16 v[88:103], v[148:151], v[116:119], v[88:103]
    ds_read_b128 v[148:151], v6 offset:17408
    v_exp_f32 v44, v44
    v_exp_f32 v45, v45
    v_exp_f32 v46, v46
    v_exp_f32 v47, v47
    v_cvt_pk_bf16_f32 v106, v12, v13
    v_cvt_pk_bf16_f32 v107, v14, v15
    s_waitcnt lgkmcnt(2)
    v_mfma_f32_32x32x16_bf16 v[24:39], v[136:139], v[120:123], v[24:39]
    v_exp_f32 v16, v16
    v_exp_f32 v17, v17
    v_exp_f32 v18, v18
    v_exp_f32 v19, v19
    v_cvt_pk_bf16_f32 v114, v44, v45
    v_cvt_pk_bf16_f32 v115, v46, v47
    v_mfma_f32_32x32x16_bf16 v[56:71], v[136:139], v[128:131], v[56:71]
    ds_read_b128 v[136:139], v4 offset:6144
    v_exp_f32 v48, v48
    v_exp_f32 v49, v49
    v_exp_f32 v50, v50
    v_exp_f32 v51, v51
    v_cvt_pk_bf16_f32 v108, v16, v17
    v_cvt_pk_bf16_f32 v109, v18, v19
    v_mfma_f32_32x32x16_bf16 v[72:87], v[144:147], v[104:107], v[72:87]
    v_exp_f32 v20, v20
    v_exp_f32 v21, v21
    v_exp_f32 v22, v22
    v_exp_f32 v23, v23
    v_cvt_pk_bf16_f32 v116, v48, v49
    v_cvt_pk_bf16_f32 v117, v50, v51
    v_mfma_f32_32x32x16_bf16 v[88:103], v[144:147], v[112:115], v[88:103]
    ds_read_b128 v[144:147], v6 offset:18432
    v_exp_f32 v52, v52
    v_exp_f32 v53, v53
    v_exp_f32 v54, v54
    v_exp_f32 v55, v55
    v_cvt_pk_bf16_f32 v110, v20, v21
    v_cvt_pk_bf16_f32 v111, v22, v23
    s_waitcnt lgkmcnt(2)
    v_mfma_f32_32x32x16_bf16 v[8:23], v[140:143], v[124:127], 0
    s_cmp_eq_u32 s24, 5
    s_cselect_b32 s26, -133120, s25
    s_bitcmp1_b32 0x67, s24
    s_cbranch_scc0 L_k_bs_34
    s_bitcmp1_b32 0x44, s24
    s_cbranch_scc1 L_k_g2_35
    s_cmp_eq_u32 s24, 5
    s_cbranch_scc1 L_k_g5_36
    s_barrier
    s_branch L_k_bs_34
L_k_g2_35:
    s_mov_b64 exec, 1
    ds_add_u32 v160, v161
    s_mov_b64 exec, -1
    s_branch L_k_bs_34
L_k_g5_36:
    ds_read_b32 v153, v160 offset:4
    s_waitcnt lgkmcnt(0)
    v_readfirstlane_b32 s3, v153
    s_cmp_lt_u32 s3, 2
    s_cbranch_scc1 L_k_g5_36
    s_lshl_b32 s3, s12, 8
    s_add_u32 s3, s3, 0x10000
    v_and_b32 v152, 7, v0
    v_lshlrev_b32 v152, 2, v152
    buffer_load_dword v152, v152, s[8:11], s3 offen sc1
L_k_bs_34:
    v_exp_f32 v24, v24
    v_exp_f32 v25, v25
    v_exp_f32 v26, v26
    v_exp_f32 v27, v27
    v_cvt_pk_bf16_f32 v118, v52, v53
    v_cvt_pk_bf16_f32 v119, v54, v55
    v_mfma_f32_32x32x16_bf16 v[40:55], v[140:143], v[132:135], 0
    ds_read_b32 v140, v5 offset:26368
    v_exp_f32 v56, v56
    v_exp_f32 v57, v57
    v_exp_f32 v58, v58
    v_exp_f32 v59, v59
    v_cvt_pk_bf16_f32 v104, v24, v25
    v_cvt_pk_bf16_f32 v105, v26, v27
    v_mfma_f32_32x32x16_bf16 v[72:87], v[148:151], v[108:111], v[72:87]
    v_exp_f32 v28, v28
    v_exp_f32 v29, v29
    v_exp_f32 v30, v30
    v_exp_f32 v31, v31
    v_cvt_pk_bf16_f32 v112, v56, v57
    v_cvt_pk_bf16_f32 v113, v58, v59
    v_mfma_f32_32x32x16_bf16 v[88:103], v[148:151], v[116:119], v[88:103]
    ds_read_b128 v[148:151], v6 offset:19456
    v_exp_f32 v60, v60
    v_exp_f32 v61, v61
    v_exp_f32 v62, v62
    v_exp_f32 v63, v63
    v_cvt_pk_bf16_f32 v106, v28, v29
    v_cvt_pk_bf16_f32 v107, v30, v31
    s_waitcnt lgkmcnt(2)
    v_mfma_f32_32x32x16_bf16 v[8:23], v[136:139], v[120:123], v[8:23]
    v_exp_f32 v32, v32
    v_exp_f32 v33, v33
    v_exp_f32 v34, v34
    v_exp_f32 v35, v35
    v_cvt_pk_bf16_f32 v114, v60, v61
    v_cvt_pk_bf16_f32 v115, v62, v63
    v_mfma_f32_32x32x16_bf16 v[40:55], v[136:139], v[128:131], v[40:55]
    ds_read_b128 v[136:139], v4 offset:7168
    v_exp_f32 v64, v64
    v_exp_f32 v65, v65
    v_exp_f32 v66, v66
    v_exp_f32 v67, v67
    v_cvt_pk_bf16_f32 v108, v32, v33
    v_cvt_pk_bf16_f32 v109, v34, v35
    v_mfma_f32_32x32x16_bf16 v[72:87], v[144:147], v[104:107], v[72:87]
    v_exp_f32 v36, v36
    v_exp_f32 v37, v37
    v_exp_f32 v38, v38
    v_exp_f32 v39, v39
    v_cvt_pk_bf16_f32 v116, v64, v65
    v_cvt_pk_bf16_f32 v117, v66, v67
    v_mfma_f32_32x32x16_bf16 v[88:103], v[144:147], v[112:115], v[88:103]
    ds_read_b128 v[144:147], v6 offset:20480
    v_exp_f32 v68, v68
    v_exp_f32 v69, v69
    v_exp_f32 v70, v70
    v_exp_f32 v71, v71
    v_cvt_pk_bf16_f32 v110, v36, v37
    v_cvt_pk_bf16_f32 v111, v38, v39
    s_waitcnt lgkmcnt(2)
    v_mfma_f32_32x32x16_bf16 v[24:39], v[140:143], v[124:127], 0
    v_add_u32 v5, s26, v5
    v_add_u32 v4, s26, v4
    v_exp_f32 v8, v8
    v_exp_f32 v9, v9
    v_exp_f32 v10, v10
    v_exp_f32 v11, v11
    v_cvt_pk_bf16_f32 v118, v68, v69
    v_cvt_pk_bf16_f32 v119, v70, v71
    v_mfma_f32_32x32x16_bf16 v[56:71], v[140:143], v[132:135], 0
    ds_read_b32 v140, v5 offset:24576
    v_exp_f32 v40, v40
    v_exp_f32 v41, v41
    v_exp_f32 v42, v42
    v_exp_f32 v43, v43
    v_cvt_pk_bf16_f32 v104, v8, v9
    v_cvt_pk_bf16_f32 v105, v10, v11
    v_mfma_f32_32x32x16_bf16 v[72:87], v[148:151], v[108:111], v[72:87]
    v_exp_f32 v12, v12
    v_exp_f32 v13, v13
    v_exp_f32 v14, v14
    v_exp_f32 v15, v15
    v_cvt_pk_bf16_f32 v112, v40, v41
    v_cvt_pk_bf16_f32 v113, v42, v43
    v_mfma_f32_32x32x16_bf16 v[88:103], v[148:151], v[116:119], v[88:103]
    ds_read_b128 v[148:151], v6 offset:21504
    v_exp_f32 v44, v44
    v_exp_f32 v45, v45
    v_exp_f32 v46, v46
    v_exp_f32 v47, v47
    v_cvt_pk_bf16_f32 v106, v12, v13
    v_cvt_pk_bf16_f32 v107, v14, v15
    s_waitcnt lgkmcnt(2)
    v_mfma_f32_32x32x16_bf16 v[24:39], v[136:139], v[120:123], v[24:39]
    v_exp_f32 v16, v16
    v_exp_f32 v17, v17
    v_exp_f32 v18, v18
    v_exp_f32 v19, v19
    v_cvt_pk_bf16_f32 v114, v44, v45
    v_cvt_pk_bf16_f32 v115, v46, v47
    v_mfma_f32_32x32x16_bf16 v[56:71], v[136:139], v[128:131], v[56:71]
    ds_read_b128 v[136:139], v4 offset:0
    v_exp_f32 v48, v48
    v_exp_f32 v49, v49
    v_exp_f32 v50, v50
    v_exp_f32 v51, v51
    v_cvt_pk_bf16_f32 v108, v16, v17
    v_cvt_pk_bf16_f32 v109, v18, v19
    v_mfma_f32_32x32x16_bf16 v[72:87], v[144:147], v[104:107], v[72:87]
    v_exp_f32 v20, v20
    v_exp_f32 v21, v21
    v_exp_f32 v22, v22
    v_exp_f32 v23, v23
    v_cvt_pk_bf16_f32 v116, v48, v49
    v_cvt_pk_bf16_f32 v117, v50, v51
    v_mfma_f32_32x32x16_bf16 v[88:103], v[144:147], v[112:115], v[88:103]
    ds_read_b128 v[144:147], v6 offset:22528
    v_exp_f32 v52, v52
    v_exp_f32 v53, v53
    v_exp_f32 v54, v54
    v_exp_f32 v55, v55
    v_cvt_pk_bf16_f32 v110, v20, v21
    v_cvt_pk_bf16_f32 v111, v22, v23
    s_waitcnt lgkmcnt(2)
    v_mfma_f32_32x32x16_bf16 v[8:23], v[140:143], v[124:127], 0
    v_exp_f32 v24, v24
    v_exp_f32 v25, v25
    v_exp_f32 v26, v26
    v_exp_f32 v27, v27
    v_cvt_pk_bf16_f32 v118, v52, v53
    v_cvt_pk_bf16_f32 v119, v54, v55
    v_mfma_f32_32x32x16_bf16 v[40:55], v[140:143], v[132:135], 0
    ds_read_b32 v140, v5 offset:24832
    v_exp_f32 v56, v56
    v_exp_f32 v57, v57
    v_exp_f32 v58, v58
    v_exp_f32 v59, v59
    v_cvt_pk_bf16_f32 v104, v24, v25
    v_cvt_pk_bf16_f32 v105, v26, v27
    v_mfma_f32_32x32x16_bf16 v[72:87], v[148:151], v[108:111], v[72:87]
    v_exp_f32 v28, v28
    v_exp_f32 v29, v29
    v_exp_f32 v30, v30
    v_exp_f32 v31, v31
    v_cvt_pk_bf16_f32 v112, v56, v57
    v_cvt_pk_bf16_f32 v113, v58, v59
    v_mfma_f32_32x32x16_bf16 v[88:103], v[148:151], v[116:119], v[88:103]
    ds_read_b128 v[148:151], v6 offset:23552
    v_exp_f32 v60, v60
    v_exp_f32 v61, v61
    v_exp_f32 v62, v62
    v_exp_f32 v63, v63
    v_cvt_pk_bf16_f32 v106, v28, v29
    v_cvt_pk_bf16_f32 v107, v30, v31
    s_waitcnt lgkmcnt(2)
    v_mfma_f32_32x32x16_bf16 v[8:23], v[136:139], v[120:123], v[8:23]
    v_add_u32 v6, s26, v6
    v_exp_f32 v32, v32
    v_exp_f32 v33, v33
    v_exp_f32 v34, v34
    v_exp_f32 v35, v35
    v_cvt_pk_bf16_f32 v114, v60, v61
    v_cvt_pk_bf16_f32 v115, v62, v63
    v_mfma_f32_32x32x16_bf16 v[40:55], v[136:139], v[128:131], v[40:55]
    ds_read_b128 v[136:139], v4 offset:1024
    v_exp_f32 v64, v64
    v_exp_f32 v65, v65
    v_exp_f32 v66, v66
    v_exp_f32 v67, v67
    v_cvt_pk_bf16_f32 v108, v32, v33
    v_cvt_pk_bf16_f32 v109, v34, v35
    v_mfma_f32_32x32x16_bf16 v[72:87], v[144:147], v[104:107], v[72:87]
    v_exp_f32 v36, v36
    v_exp_f32 v37, v37
    v_exp_f32 v38, v38
    v_exp_f32 v39, v39
    v_cvt_pk_bf16_f32 v116, v64, v65
    v_cvt_pk_bf16_f32 v117, v66, v67
    v_mfma_f32_32x32x16_bf16 v[88:103], v[144:147], v[112:115], v[88:103]
    ds_read_b128 v[144:147], v6 offset:8192
    v_exp_f32 v68, v68
    v_exp_f32 v69, v69
    v_exp_f32 v70, v70
    v_exp_f32 v71, v71
    s_add_u32 s24, s24, 1
    s_cmp_lt_u32 s24, 8
    s_cbranch_scc1 L_k_loop
    v_cvt_pk_bf16_f32 v110, v36, v37
    v_cvt_pk_bf16_f32 v111, v38, v39
    v_cvt_pk_bf16_f32 v118, v68, v69
    v_cvt_pk_bf16_f32 v119, v70, v71
    s_waitcnt vmcnt(0)
    s_getreg_b32 s36, hwreg(HW_REG_XCC_ID, 0, 4)
    s_add_u32 s36, s36, s50
    v_cmp_ne_u32 vcc, s36, v152
    s_nop 1
    s_cmp_eq_u64 vcc, 0
    s_cselect_b32 s37, 1, 0
    s_waitcnt lgkmcnt(0)
    v_cmp_eq_u32 vcc, 0, v3
    v_mfma_f32_32x32x16_bf16 v[72:87], v[148:151], v[108:111], v[72:87]
    v_mfma_f32_32x32x16_bf16 v[88:103], v[148:151], v[116:119], v[88:103]
    v_mov_b32 v136, 0x4e800000
    v_mov_b32 v137, 0x30800000
    s_mov_b64 s[28:29], 0
    v_mov_b32 v145, s51
    s_nop 7
    s_cmp_eq_u32 s39, 1
    s_cbranch_scc1 L_k_rb
    v_cndmask_b32 v104, v72, v76, vcc
    v_rcp_f32 v105, v104
    v_cmp_nle_f32 s[30:31], v104, v136
    s_or_b64 s[28:29], s[28:29], s[30:31]
    v_cmp_nge_f32 s[30:31], v104, v137
    s_or_b64 s[28:29], s[28:29], s[30:31]
    v_mul_f32 v14, v80, v105
    v_mul_f32 v15, v81, v105
    v_mul_f32 v16, v82, v105
    v_mul_f32 v17, v83, v105
    v_mul_f32 v18, v84, v105
    v_mul_f32 v19, v85, v105
    v_mul_f32 v20, v86, v105
    v_mul_f32 v21, v87, v105
    v_mul_f32 v22, v72, v105
    v_mul_f32 v23, v73, v105
    v_mul_f32 v24, v74, v105
    v_mul_f32 v25, v75, v105
    v_cvt_pk_bf16_f32 v8, v14, v15
    v_cvt_pk_bf16_f32 v9, v16, v17
    v_cvt_pk_bf16_f32 v10, v18, v19
    v_cvt_pk_bf16_f32 v11, v20, v21
    v_cvt_pk_bf16_f32 v12, v22, v23
    v_cvt_pk_bf16_f32 v13, v24, v25
    s_cmp_eq_u32 s37, 1
    s_cbranch_scc1 L_k_hs_37
    buffer_store_dwordx2 v[8:9], v154, s[8:11], s22 offen sc1
    s_branch L_k_hd_38
L_k_hs_37:
    buffer_store_dwordx2 v[8:9], v154, s[8:11], s22 offen
L_k_hd_38:
    s_cmp_eq_u32 s37, 1
    s_cbranch_scc1 L_k_hs_39
    buffer_store_dwordx2 v[10:11], v155, s[8:11], s22 offen sc1
    s_branch L_k_hd_40
L_k_hs_39:
    buffer_store_dwordx2 v[10:11], v155, s[8:11], s22 offen
L_k_hd_40:
    s_mov_b32 exec_hi, 0
    s_cmp_eq_u32 s37, 1
    s_cbranch_scc1 L_k_hs_41
    buffer_store_dwordx2 v[12:13], v156, s[8:11], s22 offen sc1
    s_branch L_k_hd_42
L_k_hs_41:
    buffer_store_dwordx2 v[12:13], v156, s[8:11], s22 offen
L_k_hd_42:
    s_mov_b32 exec_hi, -1
    v_cndmask_b32 v112, v88, v92, vcc
    v_rcp_f32 v113, v112
    v_cmp_nle_f32 s[30:31], v112, v136
    s_or_b64 s[28:29], s[28:29], s[30:31]
    v_cmp_nge_f32 s[30:31], v112, v137
    s_or_b64 s[28:29], s[28:29], s[30:31]
    v_mul_f32 v46, v96, v113
    v_mul_f32 v47, v97, v113
    v_mul_f32 v48, v98, v113
    v_mul_f32 v49, v99, v113
    v_mul_f32 v50, v100, v113
    v_mul_f32 v51, v101, v113
    v_mul_f32 v52, v102, v113
    v_mul_f32 v53, v103, v113
    v_mul_f32 v54, v88, v113
    v_mul_f32 v55, v89, v113
    v_mul_f32 v56, v90, v113
    v_mul_f32 v57, v91, v113
    v_cvt_pk_bf16_f32 v40, v46, v47
    v_cvt_pk_bf16_f32 v41, v48, v49
    v_cvt_pk_bf16_f32 v42, v50, v51
    v_cvt_pk_bf16_f32 v43, v52, v53
    v_cvt_pk_bf16_f32 v44, v54, v55
    v_cvt_pk_bf16_f32 v45, v56, v57
    s_cmp_eq_u32 s37, 1
    s_cbranch_scc1 L_k_hs_43
    buffer_store_dwordx2 v[40:41], v157, s[8:11], s22 offen sc1
    s_branch L_k_hd_44
L_k_hs_43:
    buffer_store_dwordx2 v[40:41], v157, s[8:11], s22 offen
L_k_hd_44:
    s_cmp_eq_u32 s37, 1
    s_cbranch_scc1 L_k_hs_45
    buffer_store_dwordx2 v[42:43], v158, s[8:11], s22 offen sc1
    s_branch L_k_hd_46
L_k_hs_45:
    buffer_store_dwordx2 v[42:43], v158, s[8:11], s22 offen
L_k_hd_46:
    s_mov_b32 exec_hi, 0
    s_cmp_eq_u32 s37, 1
    s_cbranch_scc1 L_k_hs_47
    buffer_store_dwordx2 v[44:45], v159, s[8:11], s22 offen sc1
    s_branch L_k_hd_48
L_k_hs_47:
    buffer_store_dwordx2 v[44:45], v159, s[8:11], s22 offen
L_k_hd_48:
    s_mov_b32 exec_hi, -1
    s_cmp_eq_u32 s27, 1
    s_cbranch_scc1 L_k_pub
    s_cmp_lg_u64 s[28:29], 0
    s_cselect_b32 s3, 1, 0
    v_mov_b32 v144, s3
    ds_write_b32 v145, v144
    s_cbranch_scc1 L_k_bad_49
    v_mov_b32 v8, 0
    v_mov_b32 v9, s50
    s_mov_b64 exec, 1
    s_waitcnt vmcnt(0)
    s_cmp_eq_u32 s37, 1
    s_cbranch_scc1 L_k_hs_50
    buffer_store_dword v9, v8, s[8:11], s38 offen sc1
    s_branch L_k_hd_51
L_k_hs_50:
    buffer_store_dword v9, v8, s[8:11], s38 offen
L_k_hd_51:
    s_mov_b64 exec, -1
    s_mov_b32 s39, 1
L_k_bad_49:
    s_waitcnt lgkmcnt(0)
    s_barrier
    v_mov_b32 v44, 159744
    ds_read_b128 v[40:43], v44
    s_waitcnt lgkmcnt(0)
    v_or_b32 v40, v40, v41
    v_or_b32 v40, v40, v42
    v_or_b32 v40, v40, v43
    s_nop 0
    v_readfirstlane_b32 s3, v40
    s_cmp_eq_u32 s3, 0
    s_cbranch_scc1 L_k_pa
    s_mov_b32 s27, 1
    v_mov_b32 v125, 0
    v_mov_b32 v126, 0
    v_mov_b32 v104, 0xff800000
    v_mov_b32 v133, 0
    v_mov_b32 v134, 0
    v_mov_b32 v112, 0xff800000
    s_mov_b32 s24, 0
L_k_maxloop:
    s_barrier
    s_barrier
    ds_read_b128 v[136:139], v1 offset:0
    ds_read_b32 v140, v7 offset:24576
    s_waitcnt lgkmcnt(0)
    v_mfma_f32_32x32x16_bf16 v[8:23], v[140:143], v[124:127], 0
    v_mfma_f32_32x32x16_bf16 v[40:55], v[140:143], v[132:135], 0
    v_mfma_f32_32x32x16_bf16 v[8:23], v[136:139], v[120:123], v[8:23]
    v_mfma_f32_32x32x16_bf16 v[40:55], v[136:139], v[128:131], v[40:55]
    s_nop 10
    v_max3_f32 v104, v8, v9, v104
    v_max3_f32 v104, v10, v11, v104
    v_max3_f32 v104, v12, v13, v104
    v_max3_f32 v104, v14, v15, v104
    v_max3_f32 v104, v16, v17, v104
    v_max3_f32 v104, v18, v19, v104
    v_max3_f32 v104, v20, v21, v104
    v_max3_f32 v104, v22, v23, v104
    v_max3_f32 v112, v40, v41, v112
    v_max3_f32 v112, v42, v43, v112
    v_max3_f32 v112, v44, v45, v112
    v_max3_f32 v112, v46, v47, v112
    v_max3_f32 v112, v48, v49, v112
    v_max3_f32 v112, v50, v51, v112
    v_max3_f32 v112, v52, v53, v112
    v_max3_f32 v112, v54, v55, v112
    ds_read_b128 v[136:139], v1 offset:1024
    ds_read_b32 v140, v7 offset:24832
    s_waitcnt lgkmcnt(0)
    v_mfma_f32_32x32x16_bf16 v[8:23], v[140:143], v[124:127], 0
    v_mfma_f32_32x32x16_bf16 v[40:55], v[140:143], v[132:135], 0
    v_mfma_f32_32x32x16_bf16 v[8:23], v[136:139], v[120:123], v[8:23]
    v_mfma_f32_32x32x16_bf16 v[40:55], v[136:139], v[128:131], v[40:55]
    s_nop 10
    v_max3_f32 v104, v8, v9, v104
    v_max3_f32 v104, v10, v11, v104
    v_max3_f32 v104, v12, v13, v104
    v_max3_f32 v104, v14, v15, v104
    v_max3_f32 v104, v16, v17, v104
    v_max3_f32 v104, v18, v19, v104
    v_max3_f32 v104, v20, v21, v104
    v_max3_f32 v104, v22, v23, v104
    v_max3_f32 v112, v40, v41, v112
    v_max3_f32 v112, v42, v43, v112
    v_max3_f32 v112, v44, v45, v112
    v_max3_f32 v112, v46, v47, v112
    v_max3_f32 v112, v48, v49, v112
    v_max3_f32 v112, v50, v51, v112
    v_max3_f32 v112, v52, v53, v112
    v_max3_f32 v112, v54, v55, v112
    ds_read_b128 v[136:139], v1 offset:2048
    ds_read_b32 v140, v7 offset:25088
    s_waitcnt lgkmcnt(0)
    v_mfma_f32_32x32x16_bf16 v[8:23], v[140:143], v[124:127], 0
    v_mfma_f32_32x32x16_bf16 v[40:55], v[140:143], v[132:135], 0
    v_mfma_f32_32x32x16_bf16 v[8:23], v[136:139], v[120:123], v[8:23]
    v_mfma_f32_32x32x16_bf16 v[40:55], v[136:139], v[128:131], v[40:55]
    s_nop 10
    v_max3_f32 v104, v8, v9, v104
    v_max3_f32 v104, v10, v11, v104
    v_max3_f32 v104, v12, v13, v104
    v_max3_f32 v104, v14, v15, v104
    v_max3_f32 v104, v16, v17, v104
    v_max3_f32 v104, v18, v19, v104
    v_max3_f32 v104, v20, v21, v104
    v_max3_f32 v104, v22, v23, v104
    v_max3_f32 v112, v40, v41, v112
    v_max3_f32 v112, v42, v43, v112
    v_max3_f32 v112, v44, v45, v112
    v_max3_f32 v112, v46, v47, v112
    v_max3_f32 v112, v48, v49, v112
    v_max3_f32 v112, v50, v51, v112
    v_max3_f32 v112, v52, v53, v112
    v_max3_f32 v112, v54, v55, v112
    ds_read_b128 v[136:139], v1 offset:3072
    ds_read_b32 v140, v7 offset:25344
    s_waitcnt lgkmcnt(0)
    v_mfma_f32_32x32x16_bf16 v[8:23], v[140:143], v[124:127], 0
    v_mfma_f32_32x32x16_bf16 v[40:55], v[140:143], v[132:135], 0
    v_mfma_f32_32x32x16_bf16 v[8:23], v[136:139], v[120:123], v[8:23]
    v_mfma_f32_32x32x16_bf16 v[40:55], v[136:139], v[128:131], v[40:55]
    s_nop 10
    v_max3_f32 v104, v8, v9, v104
    v_max3_f32 v104, v10, v11, v104
    v_max3_f32 v104, v12, v13, v104
    v_max3_f32 v104, v14, v15, v104
    v_max3_f32 v104, v16, v17, v104
    v_max3_f32 v104, v18, v19, v104
    v_max3_f32 v104, v20, v21, v104
    v_max3_f32 v104, v22, v23, v104
    v_max3_f32 v112, v40, v41, v112
    v_max3_f32 v112, v42, v43, v112
    v_max3_f32 v112, v44, v45, v112
    v_max3_f32 v112, v46, v47, v112
    v_max3_f32 v112, v48, v49, v112
    v_max3_f32 v112, v50, v51, v112
    v_max3_f32 v112, v52, v53, v112
    v_max3_f32 v112, v54, v55, v112
    ds_read_b128 v[136:139], v1 offset:4096
    ds_read_b32 v140, v7 offset:25600
    s_waitcnt lgkmcnt(0)
    v_mfma_f32_32x32x16_bf16 v[8:23], v[140:143], v[124:127], 0
    v_mfma_f32_32x32x16_bf16 v[40:55], v[140:143], v[132:135], 0
    v_mfma_f32_32x32x16_bf16 v[8:23], v[136:139], v[120:123], v[8:23]
    v_mfma_f32_32x32x16_bf16 v[40:55], v[136:139], v[128:131], v[40:55]
    s_nop 10
    v_max3_f32 v104, v8, v9, v104
    v_max3_f32 v104, v10, v11, v104
    v_max3_f32 v104, v12, v13, v104
    v_max3_f32 v104, v14, v15, v104
    v_max3_f32 v104, v16, v17, v104
    v_max3_f32 v104, v18, v19, v104
    v_max3_f32 v104, v20, v21, v104
    v_max3_f32 v104, v22, v23, v104
    v_max3_f32 v112, v40, v41, v112
    v_max3_f32 v112, v42, v43, v112
    v_max3_f32 v112, v44, v45, v112
    v_max3_f32 v112, v46, v47, v112
    v_max3_f32 v112, v48, v49, v112
    v_max3_f32 v112, v50, v51, v112
    v_max3_f32 v112, v52, v53, v112
    v_max3_f32 v112, v54, v55, v112
    ds_read_b128 v[136:139], v1 offset:5120
    ds_read_b32 v140, v7 offset:25856
    s_waitcnt lgkmcnt(0)
    v_mfma_f32_32x32x16_bf16 v[8:23], v[140:143], v[124:127], 0
    v_mfma_f32_32x32x16_bf16 v[40:55], v[140:143], v[132:135], 0
    v_mfma_f32_32x32x16_bf16 v[8:23], v[136:139], v[120:123], v[8:23]
    v_mfma_f32_32x32x16_bf16 v[40:55], v[136:139], v[128:131], v[40:55]
    s_nop 10
    v_max3_f32 v104, v8, v9, v104
    v_max3_f32 v104, v10, v11, v104
    v_max3_f32 v104, v12, v13, v104
    v_max3_f32 v104, v14, v15, v104
    v_max3_f32 v104, v16, v17, v104
    v_max3_f32 v104, v18, v19, v104
    v_max3_f32 v104, v20, v21, v104
    v_max3_f32 v104, v22, v23, v104
    v_max3_f32 v112, v40, v41, v112
    v_max3_f32 v112, v42, v43, v112
    v_max3_f32 v112, v44, v45, v112
    v_max3_f32 v112, v46, v47, v112
    v_max3_f32 v112, v48, v49, v112
    v_max3_f32 v112, v50, v51, v112
    v_max3_f32 v112, v52, v53, v112
    v_max3_f32 v112, v54, v55, v112
    ds_read_b128 v[136:139], v1 offset:6144
    ds_read_b32 v140, v7 offset:26112
    s_waitcnt lgkmcnt(0)
    v_mfma_f32_32x32x16_bf16 v[8:23], v[140:143], v[124:127], 0
    v_mfma_f32_32x32x16_bf16 v[40:55], v[140:143], v[132:135], 0
    v_mfma_f32_32x32x16_bf16 v[8:23], v[136:139], v[120:123], v[8:23]
    v_mfma_f32_32x32x16_bf16 v[40:55], v[136:139], v[128:131], v[40:55]
    s_nop 10
    v_max3_f32 v104, v8, v9, v104
    v_max3_f32 v104, v10, v11, v104
    v_max3_f32 v104, v12, v13, v104
    v_max3_f32 v104, v14, v15, v104
    v_max3_f32 v104, v16, v17, v104
    v_max3_f32 v104, v18, v19, v104
    v_max3_f32 v104, v20, v21, v104
    v_max3_f32 v104, v22, v23, v104
    v_max3_f32 v112, v40, v41, v112
    v_max3_f32 v112, v42, v43, v112
    v_max3_f32 v112, v44, v45, v112
    v_max3_f32 v112, v46, v47, v112
    v_max3_f32 v112, v48, v49, v112
    v_max3_f32 v112, v50, v51, v112
    v_max3_f32 v112, v52, v53, v112
    v_max3_f32 v112, v54, v55, v112
    ds_read_b128 v[136:139], v1 offset:7168
    ds_read_b32 v140, v7 offset:26368
    s_waitcnt lgkmcnt(0)
    v_mfma_f32_32x32x16_bf16 v[8:23], v[140:143], v[124:127], 0
    v_mfma_f32_32x32x16_bf16 v[40:55], v[140:143], v[132:135], 0
    v_mfma_f32_32x32x16_bf16 v[8:23], v[136:139], v[120:123], v[8:23]
    v_mfma_f32_32x32x16_bf16 v[40:55], v[136:139], v[128:131], v[40:55]
    s_nop 10
    v_max3_f32 v104, v8, v9, v104
    v_max3_f32 v104, v10, v11, v104
    v_max3_f32 v104, v12, v13, v104
    v_max3_f32 v104, v14, v15, v104
    v_max3_f32 v104, v16, v17, v104
    v_max3_f32 v104, v18, v19, v104
    v_max3_f32 v104, v20, v21, v104
    v_max3_f32 v104, v22, v23, v104
    v_max3_f32 v112, v40, v41, v112
    v_max3_f32 v112, v42, v43, v112
    v_max3_f32 v112, v44, v45, v112
    v_max3_f32 v112, v46, v47, v112
    v_max3_f32 v112, v48, v49, v112
    v_max3_f32 v112, v50, v51, v112
    v_max3_f32 v112, v52, v53, v112
    v_max3_f32 v112, v54, v55, v112
    s_add_u32 s24, s24, 1
    s_cmp_lt_u32 s24, 8
    s_cbranch_scc1 L_k_maxloop
    v_cmp_eq_u32 vcc, 0, v3
    v_mov_b32 v105, v104
    s_nop 1
    v_permlane32_swap_b32 v104, v105
    s_nop 1
    v_max_f32 v104, v104, v105
    v_and_b32 v105, 0xffff0000, v104
    v_sub_f32 v106, v104, v105
    v_and_b32 v107, 0xffff0000, v106
    v_sub_f32 v106, v106, v107
    v_lshrrev_b32 v105, 16, v105
    v_or_b32 v105, v105, v107
    v_lshrrev_b32 v106, 16, v106
    v_cndmask_b32 v125, 0, v105, vcc
    v_cndmask_b32 v126, 0, v106, vcc
    v_mov_b32 v113, v112
    s_nop 1
    v_permlane32_swap_b32 v112, v113
    s_nop 1
    v_max_f32 v112, v112, v113
    v_and_b32 v113, 0xffff0000, v112
    v_sub_f32 v114, v112, v113
    v_and_b32 v115, 0xffff0000, v114
    v_sub_f32 v114, v114, v115
    v_lshrrev_b32 v113, 16, v113
    v_or_b32 v113, v113, v115
    v_lshrrev_b32 v114, 16, v114
    v_cndmask_b32 v133, 0, v113, vcc
    v_cndmask_b32 v134, 0, v114, vcc
    s_mov_b32 s24, 0
    s_mov_b32 s25, 26624
    v_mov_b32 v152, 159812
    v_mov_b32 v4, v1
    v_mov_b32 v6, v1
    v_mov_b32 v5, v7
    v_mov_b32 v72, 0
    v_mov_b32 v73, 0
    v_mov_b32 v74, 0
    v_mov_b32 v75, 0
    v_mov_b32 v76, 0
    v_mov_b32 v77, 0
    v_mov_b32 v78, 0
    v_mov_b32 v79, 0
    v_mov_b32 v80, 0
    v_mov_b32 v81, 0
    v_mov_b32 v82, 0
    v_mov_b32 v83, 0
    v_mov_b32 v84, 0
    v_mov_b32 v85, 0
    v_mov_b32 v86, 0
    v_mov_b32 v87, 0
    v_mov_b32 v36, 0
    v_mov_b32 v37, 0
    v_mov_b32 v38, 0
    v_mov_b32 v39, 0
    v_mov_b32 v88, 0
    v_mov_b32 v89, 0
    v_mov_b32 v90, 0
    v_mov_b32 v91, 0
    v_mov_b32 v92, 0
    v_mov_b32 v93, 0
    v_mov_b32 v94, 0
    v_mov_b32 v95, 0
    v_mov_b32 v96, 0
    v_mov_b32 v97, 0
    v_mov_b32 v98, 0
    v_mov_b32 v99, 0
    v_mov_b32 v100, 0
    v_mov_b32 v101, 0
    v_mov_b32 v102, 0
    v_mov_b32 v103, 0
    v_mov_b32 v68, 0
    v_mov_b32 v69, 0
    v_mov_b32 v70, 0
    v_mov_b32 v71, 0
    v_mov_b32 v148, 0
    v_mov_b32 v149, 0
    v_mov_b32 v150, 0
    v_mov_b32 v151, 0
    s_barrier
    ds_write_b64 v160, v[162:163]
    s_waitcnt lgkmcnt(0)
    s_barrier
    ds_read_b128 v[136:139], v1 offset:0
    ds_read_b32 v140, v7 offset:24576
    s_waitcnt lgkmcnt(0)
    s_branch L_k_main
L_k_pub:
    v_mov_b32 v8, 0
    v_mov_b32 v9, s50
    s_mov_b64 exec, 1
    s_waitcnt vmcnt(0)
    s_cmp_eq_u32 s37, 1
    s_cbranch_scc1 L_k_hs_52
    buffer_store_dword v9, v8, s[8:11], s38 offen sc1
    s_branch L_k_hd_53
L_k_hs_52:
    buffer_store_dword v9, v8, s[8:11], s38 offen
L_k_hd_53:
    s_mov_b64 exec, -1
L_k_rb:
    s_barrier
L_k_pa:
    s_cmp_ge_u32 s14, 3
    s_cselect_b32 s17, 1, 0
    s_mul_i32 s3, s17, 3
    s_sub_u32 s15, s14, s3
    s_lshl_b32 s16, s12, 1
    s_add_u32 s16, s16, s17
    s_mul_i32 s3, s17, 4096
    s_add_u32 s3, s3, 12288
    v_add_u32 v4, s3, v1
    v_add_u32 v5, 61440, v4
    s_lshl_b32 s3, s15, 10
    v_add_u32 v6, s3, v1
    v_add_u32 v7, 61440, v6
    s_cmp_lg_u32 s15, 2
    s_cbranch_scc1 L_k_c2_54
    v_and_b32 v6, 0xf0, v1
    v_lshl_add_u32 v6, v3, 8, v6
    v_add_u32 v6, 2048, v6
    v_add_u32 v7, 61440, v6
L_k_c2_54:
    s_lshl_b32 s22, s16, 3
    s_add_u32 s22, s22, s13
    s_mul_i32 s22, s22, 5
    s_lshl_b32 s6, s15, 1
    s_add_u32 s22, s22, s6
    s_lshl_b32 s22, s22, 10
    s_add_u32 s22, s22, 0x0
    s_mul_i32 s6, s12, 81920
    s_add_u32 s22, s22, s6
    s_add_u32 s22, s22, 0xe14000
    v_mul_u32_u24 v132, 160, v2
    v_lshl_add_u32 v132, v3, 3, v132
    s_mul_i32 s3, s17, 5120
    s_lshl_b32 s6, s15, 6
    s_add_u32 s3, s3, s6
    s_add_u32 s3, s3, 126976
    v_add_u32 v132, s3, v132
    s_lshl_b32 s3, s15, 7
    s_add_u32 s3, s3, 122880
    v_lshlrev_b32 v128, 4, v3
    v_add_u32 v128, s3, v128
    s_mul_i32 s7, s13, 3
    s_add_u32 s7, s7, s15
    s_mul_i32 s29, s16, 6144
    s_lshr_b32 s3, s7, 1
    s_lshl_b32 s3, s3, 9
    s_add_u32 s29, s29, s3
    s_and_b32 s3, s7, 1
    s_lshl_b32 s3, s3, 3
    s_add_u32 s29, s29, s3
    s_add_u32 s29, s29, 0x1300000
    s_lshl_b32 s38, s12, 8
    s_mul_i32 s6, s13, 6
    s_add_u32 s6, s6, s14
    s_lshl_b32 s6, s6, 2
    s_add_u32 s38, s38, s6
    s_add_u32 s38, s38, 0x10020
    s_barrier
    ds_read_b128 v[24:27], v5 offset:0
    ds_read_b128 v[28:31], v7 offset:0
    ds_read_b128 v[32:35], v5 offset:1024
    ds_read_b128 v[36:39], v7 offset:2560
    ds_read_b128 v[40:43], v5 offset:2048
    ds_read_b128 v[44:47], v7 offset:5120
    ds_read_b128 v[48:51], v5 offset:3072
    ds_read_b128 v[52:55], v7 offset:7680
    s_add_u32 s30, s29, 393216
    v_mov_b32 v130, -1
    v_mov_b32 v131, -1
    s_mov_b32 exec_hi, 0
    buffer_store_dwordx2 v[130:131], v1, s[8:11], s30 offen sc1
    s_mov_b32 exec_hi, -1
    s_barrier
    s_waitcnt lgkmcnt(6)
    v_mfma_f32_32x32x16_bf16 v[8:23], v[28:31], v[24:27], 0
    ds_read_b128 v[56:59], v5 offset:20480
    ds_read_b128 v[60:63], v7 offset:20480
    s_waitcnt lgkmcnt(6)
    v_mfma_f32_32x32x16_bf16 v[8:23], v[36:39], v[32:35], v[8:23]
    ds_read_b128 v[64:67], v5 offset:21504
    ds_read_b128 v[68:71], v7 offset:23040
    s_waitcnt lgkmcnt(6)
    v_mfma_f32_32x32x16_bf16 v[8:23], v[44:47], v[40:43], v[8:23]
    ds_read_b128 v[72:75], v5 offset:22528
    ds_read_b128 v[76:79], v7 offset:25600
    s_waitcnt lgkmcnt(6)
    v_mfma_f32_32x32x16_bf16 v[8:23], v[52:55], v[48:51], v[8:23]
    ds_read_b128 v[80:83], v5 offset:23552
    ds_read_b128 v[84:87], v7 offset:28160
    s_barrier
    s_waitcnt lgkmcnt(6)
    v_mfma_f32_32x32x16_bf16 v[8:23], v[60:63], v[56:59], v[8:23]
    ds_read_b128 v[24:27], v5 offset:40960
    ds_read_b128 v[28:31], v7 offset:40960
    s_waitcnt lgkmcnt(6)
    v_mfma_f32_32x32x16_bf16 v[8:23], v[68:71], v[64:67], v[8:23]
    ds_read_b128 v[32:35], v5 offset:41984
    ds_read_b128 v[36:39], v7 offset:43520
    s_waitcnt lgkmcnt(6)
    v_mfma_f32_32x32x16_bf16 v[8:23], v[76:79], v[72:75], v[8:23]
    ds_read_b128 v[40:43], v5 offset:43008
    ds_read_b128 v[44:47], v7 offset:46080
    s_waitcnt lgkmcnt(6)
    v_mfma_f32_32x32x16_bf16 v[8:23], v[84:87], v[80:83], v[8:23]
    ds_read_b128 v[48:51], v5 offset:44032
    ds_read_b128 v[52:55], v7 offset:48640
    s_barrier
    s_waitcnt lgkmcnt(6)
    v_mfma_f32_32x32x16_bf16 v[8:23], v[28:31], v[24:27], v[8:23]
    ds_read_b128 v[56:59], v4 offset:0
    ds_read_b128 v[60:63], v6 offset:0
    s_waitcnt lgkmcnt(6)
    v_mfma_f32_32x32x16_bf16 v[8:23], v[36:39], v[32:35], v[8:23]
    ds_read_b128 v[64:67], v4 offset:1024
    ds_read_b128 v[68:71], v6 offset:2560
    s_waitcnt lgkmcnt(6)
    v_mfma_f32_32x32x16_bf16 v[8:23], v[44:47], v[40:43], v[8:23]
    ds_read_b128 v[72:75], v4 offset:2048
    ds_read_b128 v[76:79], v6 offset:5120
    s_waitcnt lgkmcnt(6)
    v_mfma_f32_32x32x16_bf16 v[8:23], v[52:55], v[48:51], v[8:23]
    ds_read_b128 v[80:83], v4 offset:3072
    ds_read_b128 v[84:87], v6 offset:7680
    s_barrier
    s_waitcnt lgkmcnt(6)
    v_mfma_f32_32x32x16_bf16 v[8:23], v[60:63], v[56:59], v[8:23]
    ds_read_b128 v[24:27], v4 offset:20480
    ds_read_b128 v[28:31], v6 offset:20480
    s_waitcnt lgkmcnt(6)
    v_mfma_f32_32x32x16_bf16 v[8:23], v[68:71], v[64:67], v[8:23]
    ds_read_b128 v[32:35], v4 offset:21504
    ds_read_b128 v[36:39], v6 offset:23040
    s_waitcnt lgkmcnt(6)
    v_mfma_f32_32x32x16_bf16 v[8:23], v[76:79], v[72:75], v[8:23]
    ds_read_b128 v[40:43], v4 offset:22528
    ds_read_b128 v[44:47], v6 offset:25600
    s_waitcnt lgkmcnt(6)
    v_mfma_f32_32x32x16_bf16 v[8:23], v[84:87], v[80:83], v[8:23]
    ds_read_b128 v[48:51], v4 offset:23552
    ds_read_b128 v[52:55], v6 offset:28160
    s_barrier
    s_waitcnt lgkmcnt(6)
    v_mfma_f32_32x32x16_bf16 v[8:23], v[28:31], v[24:27], v[8:23]
    ds_read_b128 v[56:59], v4 offset:40960
    ds_read_b128 v[60:63], v6 offset:40960
    s_waitcnt lgkmcnt(6)
    v_mfma_f32_32x32x16_bf16 v[8:23], v[36:39], v[32:35], v[8:23]
    ds_read_b128 v[64:67], v4 offset:41984
    ds_read_b128 v[68:71], v6 offset:43520
    s_waitcnt lgkmcnt(6)
    v_mfma_f32_32x32x16_bf16 v[8:23], v[44:47], v[40:43], v[8:23]
    ds_read_b128 v[72:75], v4 offset:43008
    ds_read_b128 v[76:79], v6 offset:46080
    s_waitcnt lgkmcnt(6)
    v_mfma_f32_32x32x16_bf16 v[8:23], v[52:55], v[48:51], v[8:23]
    ds_read_b128 v[80:83], v4 offset:44032
    ds_read_b128 v[84:87], v6 offset:48640
    s_lshl_b32 s3, s12, 8
    s_add_u32 s3, s3, 0x10000
    v_and_b32 v129, 7, v0
    v_lshlrev_b32 v129, 2, v129
    buffer_load_dword v129, v129, s[8:11], s3 offen sc1
    s_barrier
    s_waitcnt lgkmcnt(6)
    v_mfma_f32_32x32x16_bf16 v[8:23], v[60:63], v[56:59], v[8:23]
    ds_read_b128 v[24:27], v5 offset:0
    ds_read_b128 v[28:31], v7 offset:0
    s_waitcnt lgkmcnt(6)
    v_mfma_f32_32x32x16_bf16 v[8:23], v[68:71], v[64:67], v[8:23]
    ds_read_b128 v[32:35], v5 offset:1024
    ds_read_b128 v[36:39], v7 offset:2560
    s_waitcnt lgkmcnt(6)
    v_mfma_f32_32x32x16_bf16 v[8:23], v[76:79], v[72:75], v[8:23]
    ds_read_b128 v[40:43], v5 offset:2048
    ds_read_b128 v[44:47], v7 offset:5120
    s_waitcnt lgkmcnt(6)
    v_mfma_f32_32x32x16_bf16 v[8:23], v[84:87], v[80:83], v[8:23]
    ds_read_b128 v[48:51], v5 offset:3072
    ds_read_b128 v[52:55], v7 offset:7680
    s_barrier
    s_waitcnt lgkmcnt(6)
    v_mfma_f32_32x32x16_bf16 v[8:23], v[28:31], v[24:27], v[8:23]
    ds_read_b128 v[56:59], v5 offset:20480
    ds_read_b128 v[60:63], v7 offset:20480
    s_waitcnt lgkmcnt(6)
    v_mfma_f32_32x32x16_bf16 v[8:23], v[36:39], v[32:35], v[8:23]
    ds_read_b128 v[64:67], v5 offset:21504
    ds_read_b128 v[68:71], v7 offset:23040
    s_waitcnt lgkmcnt(6)
    v_mfma_f32_32x32x16_bf16 v[8:23], v[44:47], v[40:43], v[8:23]
    ds_read_b128 v[72:75], v5 offset:22528
    ds_read_b128 v[76:79], v7 offset:25600
    s_waitcnt lgkmcnt(6)
    v_mfma_f32_32x32x16_bf16 v[8:23], v[52:55], v[48:51], v[8:23]
    ds_read_b128 v[80:83], v5 offset:23552
    ds_read_b128 v[84:87], v7 offset:28160
    s_barrier
    s_waitcnt lgkmcnt(6)
    v_mfma_f32_32x32x16_bf16 v[8:23], v[60:63], v[56:59], v[8:23]
    ds_read_b128 v[24:27], v5 offset:40960
    ds_read_b128 v[28:31], v7 offset:40960
    s_waitcnt lgkmcnt(6)
    v_mfma_f32_32x32x16_bf16 v[8:23], v[68:71], v[64:67], v[8:23]
    ds_read_b128 v[32:35], v5 offset:41984
    ds_read_b128 v[36:39], v7 offset:43520
    s_waitcnt lgkmcnt(6)
    v_mfma_f32_32x32x16_bf16 v[8:23], v[76:79], v[72:75], v[8:23]
    ds_read_b128 v[40:43], v5 offset:43008
    ds_read_b128 v[44:47], v7 offset:46080
    s_waitcnt lgkmcnt(6)
    v_mfma_f32_32x32x16_bf16 v[8:23], v[84:87], v[80:83], v[8:23]
    ds_read_b128 v[48:51], v5 offset:44032
    ds_read_b128 v[52:55], v7 offset:48640
    ds_read_b128 v[88:91], v128 offset:0
    ds_read_b128 v[92:95], v128 offset:32
    ds_read_b128 v[96:99], v128 offset:64
    ds_read_b128 v[100:103], v128 offset:96
    ds_read_b64 v[104:105], v132 offset:0
    ds_read_b64 v[106:107], v132 offset:16
    ds_read_b64 v[108:109], v132 offset:32
    ds_read_b64 v[110:111], v132 offset:48
    s_barrier
    s_waitcnt lgkmcnt(14)
    v_mfma_f32_32x32x16_bf16 v[8:23], v[28:31], v[24:27], v[8:23]
    ds_read_b128 v[56:59], v4 offset:0
    ds_read_b128 v[60:63], v6 offset:0
    s_waitcnt lgkmcnt(14)
    v_mfma_f32_32x32x16_bf16 v[8:23], v[36:39], v[32:35], v[8:23]
    ds_read_b128 v[64:67], v4 offset:1024
    ds_read_b128 v[68:71], v6 offset:2560
    s_waitcnt lgkmcnt(14)
    v_mfma_f32_32x32x16_bf16 v[8:23], v[44:47], v[40:43], v[8:23]
    ds_read_b128 v[72:75], v4 offset:2048
    ds_read_b128 v[76:79], v6 offset:5120
    s_waitcnt lgkmcnt(14)
    v_mfma_f32_32x32x16_bf16 v[8:23], v[52:55], v[48:51], v[8:23]
    ds_read_b128 v[80:83], v4 offset:3072
    ds_read_b128 v[84:87], v6 offset:7680
    s_waitcnt vmcnt(0)
    s_getreg_b32 s36, hwreg(HW_REG_XCC_ID, 0, 4)
    s_add_u32 s36, s36, s50
    v_cmp_ne_u32 vcc, s36, v129
    s_nop 1
    s_cmp_eq_u64 vcc, 0
    s_cselect_b32 s37, 1, 0
    v_mov_b32 v124, 0
    v_mov_b32 v125, 0
    s_waitcnt lgkmcnt(6)
    v_mfma_f32_32x32x16_bf16 v[8:23], v[60:63], v[56:59], v[8:23]
    s_waitcnt lgkmcnt(4)
    v_mfma_f32_32x32x16_bf16 v[8:23], v[68:71], v[64:67], v[8:23]
    s_waitcnt lgkmcnt(2)
    v_mfma_f32_32x32x16_bf16 v[8:23], v[76:79], v[72:75], v[8:23]
    s_waitcnt lgkmcnt(0)
    v_mfma_f32_32x32x16_bf16 v[8:23], v[84:87], v[80:83], v[8:23]
    s_waitcnt lgkmcnt(0)
    s_nop 8
    v_lshlrev_b32 v112, 16, v104
    v_and_b32 v113, 0xffff0000, v104
    v_fmac_f32 v112, v88, v8
    v_fmac_f32 v113, v89, v9
    v_add_f32 v124, v124, v112
    v_fmac_f32 v125, v112, v112
    v_add_f32 v124, v124, v113
    v_fmac_f32 v125, v113, v113
    v_cvt_pk_bf16_f32 v140, v112, v113
    v_lshlrev_b32 v114, 16, v105
    v_and_b32 v115, 0xffff0000, v105
    v_fmac_f32 v114, v90, v10
    v_fmac_f32 v115, v91, v11
    v_add_f32 v124, v124, v114
    v_fmac_f32 v125, v114, v114
    v_add_f32 v124, v124, v115
    v_fmac_f32 v125, v115, v115
    v_cvt_pk_bf16_f32 v141, v114, v115
    v_lshlrev_b32 v112, 16, v106
    v_and_b32 v113, 0xffff0000, v106
    v_fmac_f32 v112, v92, v12
    v_fmac_f32 v113, v93, v13
    v_add_f32 v124, v124, v112
    v_fmac_f32 v125, v112, v112
    v_add_f32 v124, v124, v113
    v_fmac_f32 v125, v113, v113
    v_cvt_pk_bf16_f32 v142, v112, v113
    v_lshlrev_b32 v114, 16, v107
    v_and_b32 v115, 0xffff0000, v107
    v_fmac_f32 v114, v94, v14
    v_fmac_f32 v115, v95, v15
    v_add_f32 v124, v124, v114
    v_fmac_f32 v125, v114, v114
    v_add_f32 v124, v124, v115
    v_fmac_f32 v125, v115, v115
    v_cvt_pk_bf16_f32 v143, v114, v115
    s_cmp_eq_u32 s37, 1
    s_cbranch_scc1 L_k_hs_56
    buffer_store_dwordx4 v[140:143], v1, s[8:11], s22 offen offset:0 sc1
    s_branch L_k_hd_57
L_k_hs_56:
    buffer_store_dwordx4 v[140:143], v1, s[8:11], s22 offen offset:0
L_k_hd_57:
    s_cmp_eq_u32 s15, 2
    s_cbranch_scc1 L_k_skip_55
    v_lshlrev_b32 v112, 16, v108
    v_and_b32 v113, 0xffff0000, v108
    v_fmac_f32 v112, v96, v16
    v_fmac_f32 v113, v97, v17
    v_add_f32 v124, v124, v112
    v_fmac_f32 v125, v112, v112
    v_add_f32 v124, v124, v113
    v_fmac_f32 v125, v113, v113
    v_cvt_pk_bf16_f32 v144, v112, v113
    v_lshlrev_b32 v114, 16, v109
    v_and_b32 v115, 0xffff0000, v109
    v_fmac_f32 v114, v98, v18
    v_fmac_f32 v115, v99, v19
    v_add_f32 v124, v124, v114
    v_fmac_f32 v125, v114, v114
    v_add_f32 v124, v124, v115
    v_fmac_f32 v125, v115, v115
    v_cvt_pk_bf16_f32 v145, v114, v115
    v_lshlrev_b32 v112, 16, v110
    v_and_b32 v113, 0xffff0000, v110
    v_fmac_f32 v112, v100, v20
    v_fmac_f32 v113, v101, v21
    v_add_f32 v124, v124, v112
    v_fmac_f32 v125, v112, v112
    v_add_f32 v124, v124, v113
    v_fmac_f32 v125, v113, v113
    v_cvt_pk_bf16_f32 v146, v112, v113
    v_lshlrev_b32 v114, 16, v111
    v_and_b32 v115, 0xffff0000, v111
    v_fmac_f32 v114, v102, v22
    v_fmac_f32 v115, v103, v23
    v_add_f32 v124, v124, v114
    v_fmac_f32 v125, v114, v114
    v_add_f32 v124, v124, v115
    v_fmac_f32 v125, v115, v115
    v_cvt_pk_bf16_f32 v147, v114, v115
    s_cmp_eq_u32 s37, 1
    s_cbranch_scc1 L_k_hs_58
    buffer_store_dwordx4 v[144:147], v1, s[8:11], s22 offen offset:1024 sc1
    s_branch L_k_hd_59
L_k_hs_58:
    buffer_store_dwordx4 v[144:147], v1, s[8:11], s22 offen offset:1024
L_k_hd_59:
L_k_skip_55:
    v_mov_b32 v126, v124
    v_mov_b32 v127, v125
    s_nop 1
    v_permlane32_swap_b32 v124, v126
    v_permlane32_swap_b32 v125, v127
    s_nop 1
    v_add_f32 v124, v124, v126
    v_add_f32 v125, v125, v127
    v_max_f32 v125, 0, v125
    s_mov_b32 exec_hi, 0
    s_cmp_eq_u32 s37, 1
    s_cbranch_scc1 L_k_hs_60
    buffer_store_dwordx2 v[124:125], v1, s[8:11], s29 offen sc1
    s_branch L_k_hd_61
L_k_hs_60:
    buffer_store_dwordx2 v[124:125], v1, s[8:11], s29 offen
L_k_hd_61:
    s_mov_b32 exec_hi, -1
    v_mov_b32 v8, 0
    v_mov_b32 v9, s50
    s_mov_b64 exec, 1
    s_waitcnt vmcnt(0)
    s_cmp_eq_u32 s37, 1
    s_cbranch_scc1 L_k_hs_62
    buffer_store_dword v9, v8, s[8:11], s38 offen sc1
    s_branch L_k_hd_63
L_k_hs_62:
    buffer_store_dword v9, v8, s[8:11], s38 offen
L_k_hd_63:
    s_mov_b64 exec, -1
    s_mul_i32 s3, s17, 2048
    s_add_u32 s3, s3, 12288
    v_add_u32 v4, s3, v1
    v_add_u32 v5, 61440, v4
    s_lshl_b32 s3, s15, 10
    v_add_u32 v6, s3, v1
    v_add_u32 v7, 61440, v6
    s_mul_i32 s30, s16, 6144
    s_add_u32 s30, s30, 0x1360000
    s_add_u32 s31, s30, 4096
    s_mul_i32 s3, s17, 6144
    s_add_u32 s3, s3, 126976
    v_add_u32 v122, s3, v1
    s_add_u32 s29, s29, 393216
    s_lshl_b32 s3, s15, 8
    s_add_u32 s3, s3, 123904
    v_lshlrev_b32 v115, 5, v3
    v_add_u32 v115, s3, v115
    s_mov_b32 s28, 0xbdd2d3e8
    v_mov_b32 v114, 0xc0135761
    s_barrier
    ds_read_b128 v[40:43], v4 offset:20480
    ds_read_b128 v[44:47], v6 offset:20480
    ds_read_b128 v[48:51], v6 offset:23552
    ds_read_b128 v[52:55], v4 offset:21504
    ds_read_b128 v[56:59], v6 offset:26624
    ds_read_b128 v[60:63], v6 offset:29696
    s_barrier
    s_waitcnt lgkmcnt(3)
    v_mfma_f32_32x32x16_bf16 v[8:23], v[44:47], v[40:43], 0
    v_mfma_f32_32x32x16_bf16 v[24:39], v[48:51], v[40:43], 0
    ds_read_b128 v[64:67], v4 offset:40960
    ds_read_b128 v[68:71], v6 offset:40960
    ds_read_b128 v[72:75], v6 offset:44032
    s_waitcnt lgkmcnt(3)
    v_mfma_f32_32x32x16_bf16 v[8:23], v[56:59], v[52:55], v[8:23]
    v_mfma_f32_32x32x16_bf16 v[24:39], v[60:63], v[52:55], v[24:39]
    ds_read_b128 v[76:79], v4 offset:41984
    ds_read_b128 v[80:83], v6 offset:47104
    ds_read_b128 v[84:87], v6 offset:50176
    s_barrier
    s_waitcnt lgkmcnt(3)
    v_mfma_f32_32x32x16_bf16 v[8:23], v[68:71], v[64:67], v[8:23]
    v_mfma_f32_32x32x16_bf16 v[24:39], v[72:75], v[64:67], v[24:39]
    ds_read_b128 v[40:43], v5 offset:0
    ds_read_b128 v[44:47], v7 offset:0
    ds_read_b128 v[48:51], v7 offset:3072
    s_waitcnt lgkmcnt(3)
    v_mfma_f32_32x32x16_bf16 v[8:23], v[80:83], v[76:79], v[8:23]
    v_mfma_f32_32x32x16_bf16 v[24:39], v[84:87], v[76:79], v[24:39]
    ds_read_b128 v[52:55], v5 offset:1024
    ds_read_b128 v[56:59], v7 offset:6144
    ds_read_b128 v[60:63], v7 offset:9216
    s_barrier
    s_waitcnt lgkmcnt(3)
    v_mfma_f32_32x32x16_bf16 v[8:23], v[44:47], v[40:43], v[8:23]
    v_mfma_f32_32x32x16_bf16 v[24:39], v[48:51], v[40:43], v[24:39]
    ds_read_b128 v[64:67], v5 offset:20480
    ds_read_b128 v[68:71], v7 offset:20480
    ds_read_b128 v[72:75], v7 offset:23552
    s_waitcnt lgkmcnt(3)
    v_mfma_f32_32x32x16_bf16 v[8:23], v[56:59], v[52:55], v[8:23]
    v_mfma_f32_32x32x16_bf16 v[24:39], v[60:63], v[52:55], v[24:39]
    ds_read_b128 v[76:79], v5 offset:21504
    ds_read_b128 v[80:83], v7 offset:26624
    ds_read_b128 v[84:87], v7 offset:29696
    s_barrier
    s_waitcnt lgkmcnt(3)
    v_mfma_f32_32x32x16_bf16 v[8:23], v[68:71], v[64:67], v[8:23]
    v_mfma_f32_32x32x16_bf16 v[24:39], v[72:75], v[64:67], v[24:39]
    ds_read_b128 v[40:43], v5 offset:40960
    ds_read_b128 v[44:47], v7 offset:40960
    ds_read_b128 v[48:51], v7 offset:44032
    s_waitcnt lgkmcnt(3)
    v_mfma_f32_32x32x16_bf16 v[8:23], v[80:83], v[76:79], v[8:23]
    v_mfma_f32_32x32x16_bf16 v[24:39], v[84:87], v[76:79], v[24:39]
    ds_read_b128 v[52:55], v5 offset:41984
    ds_read_b128 v[56:59], v7 offset:47104
    ds_read_b128 v[60:63], v7 offset:50176
    s_barrier
    s_waitcnt lgkmcnt(3)
    v_mfma_f32_32x32x16_bf16 v[8:23], v[44:47], v[40:43], v[8:23]
    v_mfma_f32_32x32x16_bf16 v[24:39], v[48:51], v[40:43], v[24:39]
    ds_read_b128 v[64:67], v4 offset:0
    ds_read_b128 v[68:71], v6 offset:0
    ds_read_b128 v[72:75], v6 offset:3072
    s_waitcnt lgkmcnt(3)
    v_mfma_f32_32x32x16_bf16 v[8:23], v[56:59], v[52:55], v[8:23]
    v_mfma_f32_32x32x16_bf16 v[24:39], v[60:63], v[52:55], v[24:39]
    ds_read_b128 v[76:79], v4 offset:1024
    ds_read_b128 v[80:83], v6 offset:6144
    ds_read_b128 v[84:87], v6 offset:9216
    s_barrier
    s_waitcnt lgkmcnt(3)
    v_mfma_f32_32x32x16_bf16 v[8:23], v[68:71], v[64:67], v[8:23]
    v_mfma_f32_32x32x16_bf16 v[24:39], v[72:75], v[64:67], v[24:39]
    ds_read_b128 v[40:43], v4 offset:20480
    ds_read_b128 v[44:47], v6 offset:20480
    ds_read_b128 v[48:51], v6 offset:23552
    s_waitcnt lgkmcnt(3)
    v_mfma_f32_32x32x16_bf16 v[8:23], v[80:83], v[76:79], v[8:23]
    v_mfma_f32_32x32x16_bf16 v[24:39], v[84:87], v[76:79], v[24:39]
    ds_read_b128 v[52:55], v4 offset:21504
    ds_read_b128 v[56:59], v6 offset:26624
    ds_read_b128 v[60:63], v6 offset:29696
    s_barrier
    s_waitcnt lgkmcnt(3)
    v_mfma_f32_32x32x16_bf16 v[8:23], v[44:47], v[40:43], v[8:23]
    v_mfma_f32_32x32x16_bf16 v[24:39], v[48:51], v[40:43], v[24:39]
    ds_read_b128 v[64:67], v4 offset:40960
    ds_read_b128 v[68:71], v6 offset:40960
    ds_read_b128 v[72:75], v6 offset:44032
    s_waitcnt lgkmcnt(3)
    v_mfma_f32_32x32x16_bf16 v[8:23], v[56:59], v[52:55], v[8:23]
    v_mfma_f32_32x32x16_bf16 v[24:39], v[60:63], v[52:55], v[24:39]
    ds_read_b128 v[76:79], v4 offset:41984
    ds_read_b128 v[80:83], v6 offset:47104
    ds_read_b128 v[84:87], v6 offset:50176
    ds_read_b128 v[88:91], v122 offset:0
    ds_read_b128 v[92:95], v122 offset:1024
    ds_read_b128 v[96:99], v122 offset:2048
    ds_read_b128 v[100:103], v122 offset:3072
    ds_read_b128 v[104:107], v122 offset:4096
    ds_read_b128 v[108:111], v122 offset:5120
    s_barrier
    s_waitcnt lgkmcnt(9)
    v_mfma_f32_32x32x16_bf16 v[8:23], v[68:71], v[64:67], v[8:23]
    v_mfma_f32_32x32x16_bf16 v[24:39], v[72:75], v[64:67], v[24:39]
    ds_read_b128 v[40:43], v5 offset:0
    ds_read_b128 v[44:47], v7 offset:0
    ds_read_b128 v[48:51], v7 offset:3072
    s_waitcnt lgkmcnt(9)
    v_mfma_f32_32x32x16_bf16 v[8:23], v[80:83], v[76:79], v[8:23]
    v_mfma_f32_32x32x16_bf16 v[24:39], v[84:87], v[76:79], v[24:39]
    ds_read_b128 v[52:55], v5 offset:1024
    ds_read_b128 v[56:59], v7 offset:6144
    ds_read_b128 v[60:63], v7 offset:9216
    s_barrier
    s_waitcnt lgkmcnt(3)
    v_mfma_f32_32x32x16_bf16 v[8:23], v[44:47], v[40:43], v[8:23]
    v_mfma_f32_32x32x16_bf16 v[24:39], v[48:51], v[40:43], v[24:39]
    ds_read_b128 v[64:67], v5 offset:20480
    ds_read_b128 v[68:71], v7 offset:20480
    ds_read_b128 v[72:75], v7 offset:23552
    s_waitcnt lgkmcnt(3)
    v_mfma_f32_32x32x16_bf16 v[8:23], v[56:59], v[52:55], v[8:23]
    v_mfma_f32_32x32x16_bf16 v[24:39], v[60:63], v[52:55], v[24:39]
    ds_read_b128 v[76:79], v5 offset:21504
    ds_read_b128 v[80:83], v7 offset:26624
    ds_read_b128 v[84:87], v7 offset:29696
    v_add_f32 v88, v88, v90
    v_add_f32 v89, v89, v91
    v_add_f32 v88, v88, v92
    v_add_f32 v89, v89, v93
    v_add_f32 v88, v88, v94
    v_add_f32 v89, v89, v95
    v_add_f32 v88, v88, v96
    v_add_f32 v89, v89, v97
    v_add_f32 v88, v88, v98
    v_add_f32 v89, v89, v99
    v_add_f32 v88, v88, v100
    v_add_f32 v89, v89, v101
    v_add_f32 v88, v88, v102
    v_add_f32 v89, v89, v103
    v_add_f32 v88, v88, v104
    v_add_f32 v89, v89, v105
    v_add_f32 v88, v88, v106
    v_add_f32 v89, v89, v107
    v_add_f32 v88, v88, v108
    v_add_f32 v89, v89, v109
    v_add_f32 v88, v88, v110
    v_add_f32 v89, v89, v111
    v_mov_b32 v90, v88
    v_mov_b32 v91, v89
    s_nop 1
    v_permlane32_swap_b32 v88, v90
    v_permlane32_swap_b32 v89, v91
    s_nop 1
    v_add_f32 v88, v88, v90
    v_add_f32 v89, v89, v91
    v_mul_f32 v88, 0x3acccccd, v88
    v_mul_f32 v89, 0x3acccccd, v89
    v_fma_f32 v89, -v88, v88, v89
    v_max_f32 v89, 0, v89
    v_add_f32 v89, 0x3727c5ac, v89
    v_rsq_f32 v112, v89
    s_nop 0
    v_mul_f32 v113, v88, v112
    v_sub_f32 v113, 0, v113
    s_barrier
    s_waitcnt lgkmcnt(3)
    v_mfma_f32_32x32x16_bf16 v[8:23], v[68:71], v[64:67], v[8:23]
    v_mfma_f32_32x32x16_bf16 v[24:39], v[72:75], v[64:67], v[24:39]
    ds_read_b128 v[40:43], v5 offset:40960
    ds_read_b128 v[44:47], v7 offset:40960
    ds_read_b128 v[48:51], v7 offset:44032
    s_waitcnt lgkmcnt(3)
    v_mfma_f32_32x32x16_bf16 v[8:23], v[80:83], v[76:79], v[8:23]
    v_mfma_f32_32x32x16_bf16 v[24:39], v[84:87], v[76:79], v[24:39]
    ds_read_b128 v[52:55], v5 offset:41984
    ds_read_b128 v[56:59], v7 offset:47104
    ds_read_b128 v[60:63], v7 offset:50176
    s_barrier
    s_waitcnt lgkmcnt(3)
    v_mfma_f32_32x32x16_bf16 v[8:23], v[44:47], v[40:43], v[8:23]
    v_mfma_f32_32x32x16_bf16 v[24:39], v[48:51], v[40:43], v[24:39]
    ds_read_b128 v[64:67], v4 offset:0
    ds_read_b128 v[68:71], v6 offset:0
    ds_read_b128 v[72:75], v6 offset:3072
    s_waitcnt lgkmcnt(3)
    v_mfma_f32_32x32x16_bf16 v[8:23], v[56:59], v[52:55], v[8:23]
    v_mfma_f32_32x32x16_bf16 v[24:39], v[60:63], v[52:55], v[24:39]
    ds_read_b128 v[76:79], v4 offset:1024
    ds_read_b128 v[80:83], v6 offset:6144
    ds_read_b128 v[84:87], v6 offset:9216
    s_barrier
    s_waitcnt lgkmcnt(3)
    v_mfma_f32_32x32x16_bf16 v[8:23], v[68:71], v[64:67], v[8:23]
    v_mfma_f32_32x32x16_bf16 v[24:39], v[72:75], v[64:67], v[24:39]
    ds_read_b128 v[40:43], v4 offset:20480
    ds_read_b128 v[44:47], v6 offset:20480
    ds_read_b128 v[48:51], v6 offset:23552
    s_waitcnt lgkmcnt(3)
    v_mfma_f32_32x32x16_bf16 v[8:23], v[80:83], v[76:79], v[8:23]
    v_mfma_f32_32x32x16_bf16 v[24:39], v[84:87], v[76:79], v[24:39]
    ds_read_b128 v[52:55], v4 offset:21504
    ds_read_b128 v[56:59], v6 offset:26624
    ds_read_b128 v[60:63], v6 offset:29696
    s_barrier
    s_waitcnt lgkmcnt(3)
    v_mfma_f32_32x32x16_bf16 v[8:23], v[44:47], v[40:43], v[8:23]
    v_mfma_f32_32x32x16_bf16 v[24:39], v[48:51], v[40:43], v[24:39]
    ds_read_b128 v[64:67], v4 offset:40960
    ds_read_b128 v[68:71], v6 offset:40960
    ds_read_b128 v[72:75], v6 offset:44032
    s_waitcnt lgkmcnt(3)
    v_mfma_f32_32x32x16_bf16 v[8:23], v[56:59], v[52:55], v[8:23]
    v_mfma_f32_32x32x16_bf16 v[24:39], v[60:63], v[52:55], v[24:39]
    ds_read_b128 v[76:79], v4 offset:41984
    ds_read_b128 v[80:83], v6 offset:47104
    ds_read_b128 v[84:87], v6 offset:50176
    s_barrier
    s_waitcnt lgkmcnt(3)
    v_mfma_f32_32x32x16_bf16 v[8:23], v[68:71], v[64:67], v[8:23]
    v_mfma_f32_32x32x16_bf16 v[24:39], v[72:75], v[64:67], v[24:39]
    ds_read_b128 v[40:43], v5 offset:0
    ds_read_b128 v[44:47], v7 offset:0
    ds_read_b128 v[48:51], v7 offset:3072
    s_waitcnt lgkmcnt(3)
    v_mfma_f32_32x32x16_bf16 v[8:23], v[80:83], v[76:79], v[8:23]
    v_mfma_f32_32x32x16_bf16 v[24:39], v[84:87], v[76:79], v[24:39]
    ds_read_b128 v[52:55], v5 offset:1024
    ds_read_b128 v[56:59], v7 offset:6144
    ds_read_b128 v[60:63], v7 offset:9216
    s_barrier
    s_waitcnt lgkmcnt(3)
    v_mfma_f32_32x32x16_bf16 v[8:23], v[44:47], v[40:43], v[8:23]
    v_mfma_f32_32x32x16_bf16 v[24:39], v[48:51], v[40:43], v[24:39]
    ds_read_b128 v[64:67], v5 offset:20480
    ds_read_b128 v[68:71], v7 offset:20480
    ds_read_b128 v[72:75], v7 offset:23552
    s_waitcnt lgkmcnt(3)
    v_mfma_f32_32x32x16_bf16 v[8:23], v[56:59], v[52:55], v[8:23]
    v_mfma_f32_32x32x16_bf16 v[24:39], v[60:63], v[52:55], v[24:39]
    ds_read_b128 v[76:79], v5 offset:21504
    ds_read_b128 v[80:83], v7 offset:26624
    ds_read_b128 v[84:87], v7 offset:29696
    s_barrier
    s_waitcnt lgkmcnt(3)
    v_mfma_f32_32x32x16_bf16 v[8:23], v[68:71], v[64:67], v[8:23]
    v_mfma_f32_32x32x16_bf16 v[24:39], v[72:75], v[64:67], v[24:39]
    ds_read_b128 v[40:43], v5 offset:40960
    ds_read_b128 v[44:47], v7 offset:40960
    ds_read_b128 v[48:51], v7 offset:44032
    s_waitcnt lgkmcnt(3)
    v_mfma_f32_32x32x16_bf16 v[8:23], v[80:83], v[76:79], v[8:23]
    v_mfma_f32_32x32x16_bf16 v[24:39], v[84:87], v[76:79], v[24:39]
    ds_read_b128 v[52:55], v5 offset:41984
    ds_read_b128 v[56:59], v7 offset:47104
    ds_read_b128 v[60:63], v7 offset:50176
    s_barrier
    s_waitcnt lgkmcnt(3)
    v_mfma_f32_32x32x16_bf16 v[8:23], v[44:47], v[40:43], v[8:23]
    v_mfma_f32_32x32x16_bf16 v[24:39], v[48:51], v[40:43], v[24:39]
    ds_read_b128 v[64:67], v4 offset:0
    ds_read_b128 v[68:71], v6 offset:0
    ds_read_b128 v[72:75], v6 offset:3072
    s_waitcnt lgkmcnt(3)
    v_mfma_f32_32x32x16_bf16 v[8:23], v[56:59], v[52:55], v[8:23]
    v_mfma_f32_32x32x16_bf16 v[24:39], v[60:63], v[52:55], v[24:39]
    ds_read_b128 v[76:79], v4 offset:1024
    ds_read_b128 v[80:83], v6 offset:6144
    ds_read_b128 v[84:87], v6 offset:9216
    s_barrier
    s_waitcnt lgkmcnt(3)
    v_mfma_f32_32x32x16_bf16 v[8:23], v[68:71], v[64:67], v[8:23]
    v_mfma_f32_32x32x16_bf16 v[24:39], v[72:75], v[64:67], v[24:39]
    ds_read_b128 v[40:43], v4 offset:20480
    ds_read_b128 v[44:47], v6 offset:20480
    ds_read_b128 v[48:51], v6 offset:23552
    s_waitcnt lgkmcnt(3)
    v_mfma_f32_32x32x16_bf16 v[8:23], v[80:83], v[76:79], v[8:23]
    v_mfma_f32_32x32x16_bf16 v[24:39], v[84:87], v[76:79], v[24:39]
    ds_read_b128 v[52:55], v4 offset:21504
    ds_read_b128 v[56:59], v6 offset:26624
    ds_read_b128 v[60:63], v6 offset:29696
    s_barrier
    s_waitcnt lgkmcnt(3)
    v_mfma_f32_32x32x16_bf16 v[8:23], v[44:47], v[40:43], v[8:23]
    v_mfma_f32_32x32x16_bf16 v[24:39], v[48:51], v[40:43], v[24:39]
    ds_read_b128 v[64:67], v4 offset:40960
    ds_read_b128 v[68:71], v6 offset:40960
    ds_read_b128 v[72:75], v6 offset:44032
    s_waitcnt lgkmcnt(3)
    v_mfma_f32_32x32x16_bf16 v[8:23], v[56:59], v[52:55], v[8:23]
    v_mfma_f32_32x32x16_bf16 v[24:39], v[60:63], v[52:55], v[24:39]
    ds_read_b128 v[76:79], v4 offset:41984
    ds_read_b128 v[80:83], v6 offset:47104
    ds_read_b128 v[84:87], v6 offset:50176
    s_waitcnt lgkmcnt(3)
    v_mfma_f32_32x32x16_bf16 v[8:23], v[68:71], v[64:67], v[8:23]
    v_mfma_f32_32x32x16_bf16 v[24:39], v[72:75], v[64:67], v[24:39]
    s_waitcnt lgkmcnt(0)
    v_mfma_f32_32x32x16_bf16 v[8:23], v[80:83], v[76:79], v[8:23]
    v_mfma_f32_32x32x16_bf16 v[24:39], v[84:87], v[76:79], v[24:39]
    s_setprio 1
    ds_read_b128 v[40:43], v115 offset:0
    ds_read_b128 v[44:47], v115 offset:16
    ds_read_b128 v[48:51], v115 offset:64
    ds_read_b128 v[52:55], v115 offset:80
    ds_read_b128 v[56:59], v115 offset:128
    ds_read_b128 v[60:63], v115 offset:144
    ds_read_b128 v[64:67], v115 offset:192
    ds_read_b128 v[68:71], v115 offset:208
    s_waitcnt lgkmcnt(0)
    s_nop 2
    v_fma_f32 v41, v40, v113, v41
    v_fma_f32 v43, v42, v113, v43
    v_fma_f32 v45, v44, v113, v45
    v_fma_f32 v47, v46, v113, v47
    v_fma_f32 v49, v48, v113, v49
    v_fma_f32 v51, v50, v113, v51
    v_fma_f32 v53, v52, v113, v53
    v_fma_f32 v55, v54, v113, v55
    v_fma_f32 v57, v56, v113, v57
    v_fma_f32 v59, v58, v113, v59
    v_fma_f32 v61, v60, v113, v61
    v_fma_f32 v63, v62, v113, v63
    v_fma_f32 v65, v64, v113, v65
    v_fma_f32 v67, v66, v113, v67
    v_fma_f32 v69, v68, v113, v69
    v_fma_f32 v71, v70, v113, v71
    v_fma_f32 v8, v8, v112, v41
    v_fma_f32 v9, v9, v112, v43
    v_fma_f32 v10, v10, v112, v45
    v_fma_f32 v11, v11, v112, v47
    v_fma_f32 v12, v12, v112, v49
    v_fma_f32 v13, v13, v112, v51
    v_fma_f32 v14, v14, v112, v53
    v_fma_f32 v15, v15, v112, v55
    v_fma_f32 v16, v16, v112, v57
    v_fma_f32 v17, v17, v112, v59
    v_fma_f32 v18, v18, v112, v61
    v_fma_f32 v19, v19, v112, v63
    v_fma_f32 v20, v20, v112, v65
    v_fma_f32 v21, v21, v112, v67
    v_fma_f32 v22, v22, v112, v69
    v_fma_f32 v23, v23, v112, v71
    v_mul_f32 v72, v8, v8
    v_mul_f32 v73, v9, v9
    v_mul_f32 v74, v10, v10
    v_mul_f32 v75, v11, v11
    v_mul_f32 v76, v12, v12
    v_mul_f32 v77, v13, v13
    v_mul_f32 v78, v14, v14
    v_mul_f32 v79, v15, v15
    v_mul_f32 v80, v16, v16
    v_mul_f32 v81, v17, v17
    v_mul_f32 v82, v18, v18
    v_mul_f32 v83, v19, v19
    v_mul_f32 v84, v20, v20
    v_mul_f32 v85, v21, v21
    v_mul_f32 v86, v22, v22
    v_mul_f32 v87, v23, v23
    v_fma_f32 v72, v72, s28, v114
    v_fma_f32 v73, v73, s28, v114
    v_fma_f32 v74, v74, s28, v114
    v_fma_f32 v75, v75, s28, v114
    v_fma_f32 v76, v76, s28, v114
    v_fma_f32 v77, v77, s28, v114
    v_fma_f32 v78, v78, s28, v114
    v_fma_f32 v79, v79, s28, v114
    v_fma_f32 v80, v80, s28, v114
    v_fma_f32 v81, v81, s28, v114
    v_fma_f32 v82, v82, s28, v114
    v_fma_f32 v83, v83, s28, v114
    v_fma_f32 v84, v84, s28, v114
    v_fma_f32 v85, v85, s28, v114
    v_fma_f32 v86, v86, s28, v114
    v_fma_f32 v87, v87, s28, v114
    v_mul_f32 v72, v72, v8
    v_mul_f32 v73, v73, v9
    v_mul_f32 v74, v74, v10
    v_mul_f32 v75, v75, v11
    v_mul_f32 v76, v76, v12
    v_mul_f32 v77, v77, v13
    v_mul_f32 v78, v78, v14
    v_mul_f32 v79, v79, v15
    v_mul_f32 v80, v80, v16
    v_mul_f32 v81, v81, v17
    v_mul_f32 v82, v82, v18
    v_mul_f32 v83, v83, v19
    v_mul_f32 v84, v84, v20
    v_mul_f32 v85, v85, v21
    v_mul_f32 v86, v86, v22
    v_mul_f32 v87, v87, v23
    v_exp_f32 v72, v72
    v_exp_f32 v73, v73
    v_exp_f32 v74, v74
    v_exp_f32 v75, v75
    v_exp_f32 v76, v76
    v_exp_f32 v77, v77
    v_exp_f32 v78, v78
    v_exp_f32 v79, v79
    v_exp_f32 v80, v80
    v_exp_f32 v81, v81
    v_exp_f32 v82, v82
    v_exp_f32 v83, v83
    v_exp_f32 v84, v84
    v_exp_f32 v85, v85
    v_exp_f32 v86, v86
    v_exp_f32 v87, v87
    v_add_f32 v72, 1.0, v72
    v_add_f32 v73, 1.0, v73
    v_add_f32 v74, 1.0, v74
    v_add_f32 v75, 1.0, v75
    v_add_f32 v76, 1.0, v76
    v_add_f32 v77, 1.0, v77
    v_add_f32 v78, 1.0, v78
    v_add_f32 v79, 1.0, v79
    v_add_f32 v80, 1.0, v80
    v_add_f32 v81, 1.0, v81
    v_add_f32 v82, 1.0, v82
    v_add_f32 v83, 1.0, v83
    v_add_f32 v84, 1.0, v84
    v_add_f32 v85, 1.0, v85
    v_add_f32 v86, 1.0, v86
    v_add_f32 v87, 1.0, v87
    v_rcp_f32 v72, v72
    v_rcp_f32 v73, v73
    v_rcp_f32 v74, v74
    v_rcp_f32 v75, v75
    v_rcp_f32 v76, v76
    v_rcp_f32 v77, v77
    v_rcp_f32 v78, v78
    v_rcp_f32 v79, v79
    v_rcp_f32 v80, v80
    v_rcp_f32 v81, v81
    v_rcp_f32 v82, v82
    v_rcp_f32 v83, v83
    v_rcp_f32 v84, v84
    v_rcp_f32 v85, v85
    v_rcp_f32 v86, v86
    v_rcp_f32 v87, v87
    v_mul_f32 v8, v8, v72
    v_mul_f32 v9, v9, v73
    v_mul_f32 v10, v10, v74
    v_mul_f32 v11, v11, v75
    v_mul_f32 v12, v12, v76
    v_mul_f32 v13, v13, v77
    v_mul_f32 v14, v14, v78
    v_mul_f32 v15, v15, v79
    v_mul_f32 v16, v16, v80
    v_mul_f32 v17, v17, v81
    v_mul_f32 v18, v18, v82
    v_mul_f32 v19, v19, v83
    v_mul_f32 v20, v20, v84
    v_mul_f32 v21, v21, v85
    v_mul_f32 v22, v22, v86
    v_mul_f32 v23, v23, v87
    v_mov_b32 v116, 0
    v_mov_b32 v117, 0
    v_add_f32 v116, v116, v8
    v_fmac_f32 v117, v8, v8
    v_add_f32 v116, v116, v9
    v_fmac_f32 v117, v9, v9
    v_add_f32 v116, v116, v10
    v_fmac_f32 v117, v10, v10
    v_add_f32 v116, v116, v11
    v_fmac_f32 v117, v11, v11
    v_add_f32 v116, v116, v12
    v_fmac_f32 v117, v12, v12
    v_add_f32 v116, v116, v13
    v_fmac_f32 v117, v13, v13
    v_add_f32 v116, v116, v14
    v_fmac_f32 v117, v14, v14
    v_add_f32 v116, v116, v15
    v_fmac_f32 v117, v15, v15
    v_add_f32 v116, v116, v16
    v_fmac_f32 v117, v16, v16
    v_add_f32 v116, v116, v17
    v_fmac_f32 v117, v17, v17
    v_add_f32 v116, v116, v18
    v_fmac_f32 v117, v18, v18
    v_add_f32 v116, v116, v19
    v_fmac_f32 v117, v19, v19
    v_add_f32 v116, v116, v20
    v_fmac_f32 v117, v20, v20
    v_add_f32 v116, v116, v21
    v_fmac_f32 v117, v21, v21
    v_add_f32 v116, v116, v22
    v_fmac_f32 v117, v22, v22
    v_add_f32 v116, v116, v23
    v_fmac_f32 v117, v23, v23
    v_mov_b32 v118, v116
    v_mov_b32 v119, v117
    s_nop 1
    v_permlane32_swap_b32 v116, v118
    v_permlane32_swap_b32 v117, v119
    s_nop 1
    v_add_f32 v116, v116, v118
    v_add_f32 v117, v117, v119
    v_max_f32 v117, 0, v117
    s_mov_b32 exec_hi, 0
    s_cmp_eq_u32 s37, 1
    s_cbranch_scc1 L_k_hs_64
    buffer_store_dwordx2 v[116:117], v1, s[8:11], s29 offen sc1
    s_branch L_k_hd_65
L_k_hs_64:
    buffer_store_dwordx2 v[116:117], v1, s[8:11], s29 offen
L_k_hd_65:
    s_mov_b32 exec_hi, -1
    s_setprio 0
    s_mul_i32 s6, s17, 6656
    s_lshl_b32 s7, s15, 6
    s_add_u32 s6, s6, s7
    s_add_u32 s6, s6, 126976
    v_mul_u32_u24 v4, 208, v2
    v_lshl_add_u32 v4, v3, 3, v4
    v_add_u32 v4, s6, v4
    v_bfe_u32 v5, v0, 2, 2
    v_lshl_add_u32 v5, v3, 3, v5
    v_mul_u32_u24 v5, 208, v5
    v_and_b32 v6, 3, v0
    v_lshl_add_u32 v5, v6, 3, v5
    v_bfe_u32 v6, v0, 4, 1
    v_lshl_add_u32 v5, v6, 5, v5
    v_add_u32 v5, s6, v5
    s_lshl_b32 s6, s13, 7
    s_lshl_b32 s7, s16, 1
    s_add_u32 s6, s6, s7
    s_mul_i32 s6, s6, 3
    s_add_u32 s6, s6, s15
    s_lshl_b32 s6, s6, 10
    s_add_u32 s26, s6, 0x16c0000
    s_lshl_b32 s3, s17, 8
    s_add_u32 s3, s3, 125440
    v_lshlrev_b32 v123, 3, v2
    v_add_u32 v123, s3, v123
    s_lshl_b32 s3, s17, 2
    s_add_u32 s3, s3, 159844
    v_mov_b32 v124, s3
    s_sub_u32 s3, s14, 2
    s_cmp_gt_u32 s3, 1
    s_cbranch_scc1 L_k_follow_66
    buffer_load_dwordx4 v[88:91], v1, s[8:11], s30 offen offset:0 sc1
    buffer_load_dwordx4 v[92:95], v1, s[8:11], s30 offen offset:1024 sc1
    buffer_load_dwordx4 v[96:99], v1, s[8:11], s30 offen offset:2048 sc1
    buffer_load_dwordx4 v[100:103], v1, s[8:11], s30 offen offset:3072 sc1
    buffer_load_dwordx4 v[104:107], v1, s[8:11], s31 offen offset:0 sc1
    buffer_load_dwordx4 v[108:111], v1, s[8:11], s31 offen offset:1024 sc1
    s_waitcnt vmcnt(0)
    s_mov_b32 s29, 0x4000
L_k_poll_68:
    v_or_b32 v116, v89, v91
    v_or_b32 v116, v116, v93
    v_or_b32 v116, v116, v95
    v_or_b32 v116, v116, v97
    v_or_b32 v116, v116, v99
    v_or_b32 v116, v116, v101
    v_or_b32 v116, v116, v103
    v_or_b32 v116, v116, v105
    v_or_b32 v116, v116, v107
    v_or_b32 v116, v116, v109
    v_or_b32 v116, v116, v111
    v_cmp_gt_i32 vcc, 0, v116
    s_sub_u32 s29, s29, 1
    s_cbranch_scc1 L_k_ok_69
    s_cbranch_vccz L_k_ok_69
    buffer_load_dwordx4 v[88:91], v1, s[8:11], s30 offen offset:0 sc1
    buffer_load_dwordx4 v[92:95], v1, s[8:11], s30 offen offset:1024 sc1
    buffer_load_dwordx4 v[96:99], v1, s[8:11], s30 offen offset:2048 sc1
    buffer_load_dwordx4 v[100:103], v1, s[8:11], s30 offen offset:3072 sc1
    buffer_load_dwordx4 v[104:107], v1, s[8:11], s31 offen offset:0 sc1
    buffer_load_dwordx4 v[108:111], v1, s[8:11], s31 offen offset:1024 sc1
    s_waitcnt vmcnt(0)
    s_branch L_k_poll_68
L_k_ok_69:
    s_setprio 1
    v_add_f32 v88, v88, v90
    v_add_f32 v89, v89, v91
    v_add_f32 v88, v88, v92
    v_add_f32 v89, v89, v93
    v_add_f32 v88, v88, v94
    v_add_f32 v89, v89, v95
    v_add_f32 v88, v88, v96
    v_add_f32 v89, v89, v97
    v_add_f32 v88, v88, v98
    v_add_f32 v89, v89, v99
    v_add_f32 v88, v88, v100
    v_add_f32 v89, v89, v101
    v_add_f32 v88, v88, v102
    v_add_f32 v89, v89, v103
    v_add_f32 v88, v88, v104
    v_add_f32 v89, v89, v105
    v_add_f32 v88, v88, v106
    v_add_f32 v89, v89, v107
    v_add_f32 v88, v88, v108
    v_add_f32 v89, v89, v109
    v_add_f32 v88, v88, v110
    v_add_f32 v89, v89, v111
    v_mov_b32 v90, v88
    v_mov_b32 v91, v89
    s_nop 1
    v_permlane32_swap_b32 v88, v90
    v_permlane32_swap_b32 v89, v91
    s_nop 1
    v_add_f32 v88, v88, v90
    v_add_f32 v89, v89, v91
    v_mul_f32 v88, 0x3aaaaaab, v88
    v_mul_f32 v89, 0x3aaaaaab, v89
    v_fma_f32 v89, -v88, v88, v89
    v_max_f32 v89, 0, v89
    v_add_f32 v89, 0x3727c5ac, v89
    v_rsq_f32 v120, v89
    s_nop 0
    v_mul_f32 v121, v88, v120
    v_sub_f32 v121, 0, v121
    v_mov_b32 v125, 1
    ds_write_b64 v123, v[120:121]
    s_waitcnt lgkmcnt(0)
    ds_write_b32 v124, v125
    s_branch L_k_join_67
L_k_follow_66:
    ds_read_b32 v125, v124
    s_waitcnt lgkmcnt(0)
    v_readfirstlane_b32 s3, v125
    s_cmp_eq_u32 s3, 0
    s_cbranch_scc1 L_k_follow_66
    s_setprio 1
    ds_read_b64 v[120:121], v123
    s_waitcnt lgkmcnt(0)
L_k_join_67:
    v_fma_f32 v8, v8, v120, v121
    v_fma_f32 v9, v9, v120, v121
    v_fma_f32 v10, v10, v120, v121
    v_fma_f32 v11, v11, v120, v121
    v_fma_f32 v12, v12, v120, v121
    v_fma_f32 v13, v13, v120, v121
    v_fma_f32 v14, v14, v120, v121
    v_fma_f32 v15, v15, v120, v121
    v_fma_f32 v16, v16, v120, v121
    v_fma_f32 v17, v17, v120, v121
    v_fma_f32 v18, v18, v120, v121
    v_fma_f32 v19, v19, v120, v121
    v_fma_f32 v20, v20, v120, v121
    v_fma_f32 v21, v21, v120, v121
    v_fma_f32 v22, v22, v120, v121
    v_fma_f32 v23, v23, v120, v121
    v_cvt_pk_bf16_f32 v80, v8, v9
    v_cvt_pk_bf16_f32 v81, v10, v11
    v_cvt_pk_bf16_f32 v82, v12, v13
    v_cvt_pk_bf16_f32 v83, v14, v15
    v_cvt_pk_bf16_f32 v84, v16, v17
    v_cvt_pk_bf16_f32 v85, v18, v19
    v_cvt_pk_bf16_f32 v86, v20, v21
    v_cvt_pk_bf16_f32 v87, v22, v23
    ds_write_b64 v4, v[80:81] offset:0
    ds_write_b64 v4, v[82:83] offset:16
    ds_write_b64 v4, v[84:85] offset:32
    ds_write_b64 v4, v[86:87] offset:48
    s_waitcnt lgkmcnt(0)
    ds_read_b64_tr_b16 v[40:41], v5 offset:0
    ds_read_b64_tr_b16 v[42:43], v5 offset:832
    ds_read_b64_tr_b16 v[44:45], v5 offset:3328
    ds_read_b64_tr_b16 v[46:47], v5 offset:4160
    s_waitcnt lgkmcnt(0)
    buffer_store_dwordx4 v[40:43], v1, s[8:11], s26 offen offset:0 sc1
    buffer_store_dwordx4 v[44:47], v1, s[8:11], s26 offen offset:3072 sc1
    s_lshl_b32 s6, s13, 5
    s_add_u32 s6, s6, s12
    s_lshl_b32 s6, s6, 7
    s_add_u32 s6, s6, 0x4c000
    v_mov_b32 v8, 159812
    v_mov_b32 v9, 1
    s_mov_b64 exec, 1
    s_waitcnt vmcnt(0)
    ds_add_rtn_u32 v9, v8, v9
    s_waitcnt lgkmcnt(0)
    v_readfirstlane_b32 s3, v9
    s_cmp_lg_u32 s3, 5
    s_cbranch_scc1 L_k_wf_70
    v_mov_b32 v8, 0
    v_mov_b32 v9, s50
    buffer_store_dword v9, v8, s[8:11], s6 offen sc1
L_k_wf_70:
    s_mov_b64 exec, -1
    s_barrier
    s_lshl_b32 s29, s16, 3
    s_add_u32 s29, s29, s13
    s_mul_i32 s29, s29, 6
    s_lshl_b32 s6, s15, 1
    s_add_u32 s29, s29, s6
    s_lshl_b32 s29, s29, 10
    s_add_u32 s29, s29, 0xe00000
    s_mul_i32 s6, s12, 65536
    s_add_u32 s29, s29, s6
    s_setprio 0
    ds_read_b128 v[40:43], v115 offset:768
    ds_read_b128 v[44:47], v115 offset:784
    ds_read_b128 v[48:51], v115 offset:832
    ds_read_b128 v[52:55], v115 offset:848
    ds_read_b128 v[56:59], v115 offset:896
    ds_read_b128 v[60:63], v115 offset:912
    ds_read_b128 v[64:67], v115 offset:960
    ds_read_b128 v[68:71], v115 offset:976
    s_waitcnt lgkmcnt(0)
    v_fma_f32 v41, v40, v113, v41
    v_fma_f32 v43, v42, v113, v43
    v_fma_f32 v45, v44, v113, v45
    v_fma_f32 v47, v46, v113, v47
    v_fma_f32 v49, v48, v113, v49
    v_fma_f32 v51, v50, v113, v51
    v_fma_f32 v53, v52, v113, v53
    v_fma_f32 v55, v54, v113, v55
    v_fma_f32 v57, v56, v113, v57
    v_fma_f32 v59, v58, v113, v59
    v_fma_f32 v61, v60, v113, v61
    v_fma_f32 v63, v62, v113, v63
    v_fma_f32 v65, v64, v113, v65
    v_fma_f32 v67, v66, v113, v67
    v_fma_f32 v69, v68, v113, v69
    v_fma_f32 v71, v70, v113, v71
    v_fma_f32 v24, v24, v112, v41
    v_fma_f32 v25, v25, v112, v43
    v_fma_f32 v26, v26, v112, v45
    v_fma_f32 v27, v27, v112, v47
    v_fma_f32 v28, v28, v112, v49
    v_fma_f32 v29, v29, v112, v51
    v_fma_f32 v30, v30, v112, v53
    v_fma_f32 v31, v31, v112, v55
    v_fma_f32 v32, v32, v112, v57
    v_fma_f32 v33, v33, v112, v59
    v_fma_f32 v34, v34, v112, v61
    v_fma_f32 v35, v35, v112, v63
    v_fma_f32 v36, v36, v112, v65
    v_fma_f32 v37, v37, v112, v67
    v_fma_f32 v38, v38, v112, v69
    v_fma_f32 v39, v39, v112, v71
    v_mul_f32 v72, v24, v24
    v_mul_f32 v73, v25, v25
    v_mul_f32 v74, v26, v26
    v_mul_f32 v75, v27, v27
    v_mul_f32 v76, v28, v28
    v_mul_f32 v77, v29, v29
    v_mul_f32 v78, v30, v30
    v_mul_f32 v79, v31, v31
    v_mul_f32 v80, v32, v32
    v_mul_f32 v81, v33, v33
    v_mul_f32 v82, v34, v34
    v_mul_f32 v83, v35, v35
    v_mul_f32 v84, v36, v36
    v_mul_f32 v85, v37, v37
    v_mul_f32 v86, v38, v38
    v_mul_f32 v87, v39, v39
    v_fma_f32 v72, v72, s28, v114
    v_fma_f32 v73, v73, s28, v114
    v_fma_f32 v74, v74, s28, v114
    v_fma_f32 v75, v75, s28, v114
    v_fma_f32 v76, v76, s28, v114
    v_fma_f32 v77, v77, s28, v114
    v_fma_f32 v78, v78, s28, v114
    v_fma_f32 v79, v79, s28, v114
    v_fma_f32 v80, v80, s28, v114
    v_fma_f32 v81, v81, s28, v114
    v_fma_f32 v82, v82, s28, v114
    v_fma_f32 v83, v83, s28, v114
    v_fma_f32 v84, v84, s28, v114
    v_fma_f32 v85, v85, s28, v114
    v_fma_f32 v86, v86, s28, v114
    v_fma_f32 v87, v87, s28, v114
    v_mul_f32 v72, v72, v24
    v_mul_f32 v73, v73, v25
    v_mul_f32 v74, v74, v26
    v_mul_f32 v75, v75, v27
    v_mul_f32 v76, v76, v28
    v_mul_f32 v77, v77, v29
    v_mul_f32 v78, v78, v30
    v_mul_f32 v79, v79, v31
    v_mul_f32 v80, v80, v32
    v_mul_f32 v81, v81, v33
    v_mul_f32 v82, v82, v34
    v_mul_f32 v83, v83, v35
    v_mul_f32 v84, v84, v36
    v_mul_f32 v85, v85, v37
    v_mul_f32 v86, v86, v38
    v_mul_f32 v87, v87, v39
    v_exp_f32 v72, v72
    v_exp_f32 v73, v73
    v_exp_f32 v74, v74
    v_exp_f32 v75, v75
    v_exp_f32 v76, v76
    v_exp_f32 v77, v77
    v_exp_f32 v78, v78
    v_exp_f32 v79, v79
    v_exp_f32 v80, v80
    v_exp_f32 v81, v81
    v_exp_f32 v82, v82
    v_exp_f32 v83, v83
    v_exp_f32 v84, v84
    v_exp_f32 v85, v85
    v_exp_f32 v86, v86
    v_exp_f32 v87, v87
    v_add_f32 v72, 1.0, v72
    v_add_f32 v73, 1.0, v73
    v_add_f32 v74, 1.0, v74
    v_add_f32 v75, 1.0, v75
    v_add_f32 v76, 1.0, v76
    v_add_f32 v77, 1.0, v77
    v_add_f32 v78, 1.0, v78
    v_add_f32 v79, 1.0, v79
    v_add_f32 v80, 1.0, v80
    v_add_f32 v81, 1.0, v81
    v_add_f32 v82, 1.0, v82
    v_add_f32 v83, 1.0, v83
    v_add_f32 v84, 1.0, v84
    v_add_f32 v85, 1.0, v85
    v_add_f32 v86, 1.0, v86
    v_add_f32 v87, 1.0, v87
    v_rcp_f32 v72, v72
    v_rcp_f32 v73, v73
    v_rcp_f32 v74, v74
    v_rcp_f32 v75, v75
    v_rcp_f32 v76, v76
    v_rcp_f32 v77, v77
    v_rcp_f32 v78, v78
    v_rcp_f32 v79, v79
    v_rcp_f32 v80, v80
    v_rcp_f32 v81, v81
    v_rcp_f32 v82, v82
    v_rcp_f32 v83, v83
    v_rcp_f32 v84, v84
    v_rcp_f32 v85, v85
    v_rcp_f32 v86, v86
    v_rcp_f32 v87, v87
    v_mul_f32 v24, v24, v72
    v_mul_f32 v25, v25, v73
    v_mul_f32 v26, v26, v74
    v_mul_f32 v27, v27, v75
    v_mul_f32 v28, v28, v76
    v_mul_f32 v29, v29, v77
    v_mul_f32 v30, v30, v78
    v_mul_f32 v31, v31, v79
    v_mul_f32 v32, v32, v80
    v_mul_f32 v33, v33, v81
    v_mul_f32 v34, v34, v82
    v_mul_f32 v35, v35, v83
    v_mul_f32 v36, v36, v84
    v_mul_f32 v37, v37, v85
    v_mul_f32 v38, v38, v86
    v_mul_f32 v39, v39, v87
    v_cvt_pk_bf16_f32 v148, v24, v25
    v_cvt_pk_bf16_f32 v149, v26, v27
    v_cvt_pk_bf16_f32 v150, v28, v29
    v_cvt_pk_bf16_f32 v151, v30, v31
    v_cvt_pk_bf16_f32 v152, v32, v33
    v_cvt_pk_bf16_f32 v153, v34, v35
    v_cvt_pk_bf16_f32 v154, v36, v37
    v_cvt_pk_bf16_f32 v155, v38, v39
    s_mul_i32 s3, s17, 4096
    s_add_u32 s3, s3, 12288
    v_add_u32 v4, s3, v1
    v_add_u32 v5, 61440, v4
    s_lshl_b32 s3, s15, 10
    v_add_u32 v6, s3, v1
    v_add_u32 v7, 61440, v6
    s_lshl_b32 s38, s12, 8
    s_mul_i32 s6, s13, 6
    s_add_u32 s6, s6, s14
    s_lshl_b32 s6, s6, 2
    s_add_u32 s38, s38, s6
    s_add_u32 s38, s38, 0x12020
    v_lshlrev_b32 v97, 1, v2
    s_lshl_b32 s6, s16, 6
    s_mov_b32 s24, s62
    s_mov_b32 s25, s63
    s_mov_b32 s26, 0x1000
    s_mov_b32 s27, 0x20000
    buffer_load_ushort v96, v97, s[24:27], s6 offen
    v_mov_b32 v8, 0
    v_mov_b32 v9, 0
    v_mov_b32 v10, 0
    v_mov_b32 v11, 0
    v_mov_b32 v12, 0
    v_mov_b32 v13, 0
    v_mov_b32 v14, 0
    v_mov_b32 v15, 0
    v_mov_b32 v16, 0
    v_mov_b32 v17, 0
    v_mov_b32 v18, 0
    v_mov_b32 v19, 0
    v_mov_b32 v20, 0
    v_mov_b32 v21, 0
    v_mov_b32 v22, 0
    v_mov_b32 v23, 0
    s_barrier
    ds_read_b128 v[24:27], v5 offset:0
    ds_read_b128 v[28:31], v7 offset:0
    ds_read_b128 v[32:35], v5 offset:1024
    ds_read_b128 v[36:39], v7 offset:3072
    ds_read_b128 v[40:43], v5 offset:2048
    ds_read_b128 v[44:47], v7 offset:6144
    ds_read_b128 v[48:51], v5 offset:3072
    ds_read_b128 v[52:55], v7 offset:9216
    s_mov_b32 s30, 5
L_k_cloop:
    s_barrier
    s_waitcnt lgkmcnt(6)
    v_mfma_f32_32x32x16_bf16 v[8:23], v[28:31], v[24:27], v[8:23]
    ds_read_b128 v[56:59], v5 offset:20480
    ds_read_b128 v[60:63], v7 offset:20480
    s_waitcnt lgkmcnt(6)
    v_mfma_f32_32x32x16_bf16 v[8:23], v[36:39], v[32:35], v[8:23]
    ds_read_b128 v[64:67], v5 offset:21504
    ds_read_b128 v[68:71], v7 offset:23552
    s_waitcnt lgkmcnt(6)
    v_mfma_f32_32x32x16_bf16 v[8:23], v[44:47], v[40:43], v[8:23]
    ds_read_b128 v[72:75], v5 offset:22528
    ds_read_b128 v[76:79], v7 offset:26624
    s_waitcnt lgkmcnt(6)
    v_mfma_f32_32x32x16_bf16 v[8:23], v[52:55], v[48:51], v[8:23]
    ds_read_b128 v[80:83], v5 offset:23552
    ds_read_b128 v[84:87], v7 offset:29696
    s_barrier
    s_waitcnt lgkmcnt(6)
    v_mfma_f32_32x32x16_bf16 v[8:23], v[60:63], v[56:59], v[8:23]
    ds_read_b128 v[24:27], v5 offset:40960
    ds_read_b128 v[28:31], v7 offset:40960
    s_waitcnt lgkmcnt(6)
    v_mfma_f32_32x32x16_bf16 v[8:23], v[68:71], v[64:67], v[8:23]
    ds_read_b128 v[32:35], v5 offset:41984
    ds_read_b128 v[36:39], v7 offset:44032
    s_waitcnt lgkmcnt(6)
    v_mfma_f32_32x32x16_bf16 v[8:23], v[76:79], v[72:75], v[8:23]
    ds_read_b128 v[40:43], v5 offset:43008
    ds_read_b128 v[44:47], v7 offset:47104
    s_waitcnt lgkmcnt(6)
    v_mfma_f32_32x32x16_bf16 v[8:23], v[84:87], v[80:83], v[8:23]
    ds_read_b128 v[48:51], v5 offset:44032
    ds_read_b128 v[52:55], v7 offset:50176
    s_barrier
    s_waitcnt lgkmcnt(6)
    v_mfma_f32_32x32x16_bf16 v[8:23], v[28:31], v[24:27], v[8:23]
    ds_read_b128 v[56:59], v4 offset:0
    ds_read_b128 v[60:63], v6 offset:0
    s_waitcnt lgkmcnt(6)
    v_mfma_f32_32x32x16_bf16 v[8:23], v[36:39], v[32:35], v[8:23]
    ds_read_b128 v[64:67], v4 offset:1024
    ds_read_b128 v[68:71], v6 offset:3072
    s_waitcnt lgkmcnt(6)
    v_mfma_f32_32x32x16_bf16 v[8:23], v[44:47], v[40:43], v[8:23]
    ds_read_b128 v[72:75], v4 offset:2048
    ds_read_b128 v[76:79], v6 offset:6144
    s_waitcnt lgkmcnt(6)
    v_mfma_f32_32x32x16_bf16 v[8:23], v[52:55], v[48:51], v[8:23]
    ds_read_b128 v[80:83], v4 offset:3072
    ds_read_b128 v[84:87], v6 offset:9216
    s_barrier
    s_waitcnt lgkmcnt(6)
    v_mfma_f32_32x32x16_bf16 v[8:23], v[60:63], v[56:59], v[8:23]
    ds_read_b128 v[24:27], v4 offset:20480
    ds_read_b128 v[28:31], v6 offset:20480
    s_waitcnt lgkmcnt(6)
    v_mfma_f32_32x32x16_bf16 v[8:23], v[68:71], v[64:67], v[8:23]
    ds_read_b128 v[32:35], v4 offset:21504
    ds_read_b128 v[36:39], v6 offset:23552
    s_waitcnt lgkmcnt(6)
    v_mfma_f32_32x32x16_bf16 v[8:23], v[76:79], v[72:75], v[8:23]
    ds_read_b128 v[40:43], v4 offset:22528
    ds_read_b128 v[44:47], v6 offset:26624
    s_waitcnt lgkmcnt(6)
    v_mfma_f32_32x32x16_bf16 v[8:23], v[84:87], v[80:83], v[8:23]
    ds_read_b128 v[48:51], v4 offset:23552
    ds_read_b128 v[52:55], v6 offset:29696
    s_barrier
    s_waitcnt lgkmcnt(6)
    v_mfma_f32_32x32x16_bf16 v[8:23], v[28:31], v[24:27], v[8:23]
    ds_read_b128 v[56:59], v4 offset:40960
    ds_read_b128 v[60:63], v6 offset:40960
    s_waitcnt lgkmcnt(6)
    v_mfma_f32_32x32x16_bf16 v[8:23], v[36:39], v[32:35], v[8:23]
    ds_read_b128 v[64:67], v4 offset:41984
    ds_read_b128 v[68:71], v6 offset:44032
    s_waitcnt lgkmcnt(6)
    v_mfma_f32_32x32x16_bf16 v[8:23], v[44:47], v[40:43], v[8:23]
    ds_read_b128 v[72:75], v4 offset:43008
    ds_read_b128 v[76:79], v6 offset:47104
    s_waitcnt lgkmcnt(6)
    v_mfma_f32_32x32x16_bf16 v[8:23], v[52:55], v[48:51], v[8:23]
    ds_read_b128 v[80:83], v4 offset:44032
    ds_read_b128 v[84:87], v6 offset:50176
    s_barrier
    s_waitcnt lgkmcnt(6)
    v_mfma_f32_32x32x16_bf16 v[8:23], v[60:63], v[56:59], v[8:23]
    ds_read_b128 v[24:27], v5 offset:0
    ds_read_b128 v[28:31], v7 offset:0
    s_waitcnt lgkmcnt(6)
    v_mfma_f32_32x32x16_bf16 v[8:23], v[68:71], v[64:67], v[8:23]
    ds_read_b128 v[32:35], v5 offset:1024
    ds_read_b128 v[36:39], v7 offset:3072
    s_waitcnt lgkmcnt(6)
    v_mfma_f32_32x32x16_bf16 v[8:23], v[76:79], v[72:75], v[8:23]
    ds_read_b128 v[40:43], v5 offset:2048
    ds_read_b128 v[44:47], v7 offset:6144
    s_waitcnt lgkmcnt(6)
    v_mfma_f32_32x32x16_bf16 v[8:23], v[84:87], v[80:83], v[8:23]
    ds_read_b128 v[48:51], v5 offset:3072
    ds_read_b128 v[52:55], v7 offset:9216
    s_sub_u32 s30, s30, 1
    s_cmp_lg_u32 s30, 0
    s_cbranch_scc1 L_k_cloop
    s_waitcnt vmcnt(0)
    v_lshlrev_b32 v96, 16, v96
    s_barrier
    s_waitcnt lgkmcnt(6)
    v_mfma_f32_32x32x16_bf16 v[8:23], v[28:31], v[24:27], v[8:23]
    ds_read_b128 v[56:59], v5 offset:20480
    ds_read_b128 v[60:63], v7 offset:20480
    s_waitcnt lgkmcnt(6)
    v_mfma_f32_32x32x16_bf16 v[8:23], v[36:39], v[32:35], v[8:23]
    ds_read_b128 v[64:67], v5 offset:21504
    ds_read_b128 v[68:71], v7 offset:23552
    s_waitcnt lgkmcnt(6)
    v_mfma_f32_32x32x16_bf16 v[8:23], v[44:47], v[40:43], v[8:23]
    ds_read_b128 v[72:75], v5 offset:22528
    ds_read_b128 v[76:79], v7 offset:26624
    s_waitcnt lgkmcnt(6)
    v_mfma_f32_32x32x16_bf16 v[8:23], v[52:55], v[48:51], v[8:23]
    ds_read_b128 v[80:83], v5 offset:23552
    ds_read_b128 v[84:87], v7 offset:29696
    s_waitcnt lgkmcnt(6)
    v_mfma_f32_32x32x16_bf16 v[8:23], v[60:63], v[56:59], v[8:23]
    s_waitcnt lgkmcnt(4)
    v_mfma_f32_32x32x16_bf16 v[8:23], v[68:71], v[64:67], v[8:23]
    s_waitcnt lgkmcnt(2)
    v_mfma_f32_32x32x16_bf16 v[8:23], v[76:79], v[72:75], v[8:23]
    s_waitcnt lgkmcnt(0)
    v_mfma_f32_32x32x16_bf16 v[8:23], v[84:87], v[80:83], v[8:23]
    s_nop 11
    v_add_f32 v8, v8, v96
    v_add_f32 v9, v9, v96
    v_lshlrev_b32 v100, 16, v148
    v_and_b32 v101, 0xffff0000, v148
    v_mul_f32 v8, v8, v100
    v_mul_f32 v9, v9, v101
    v_cvt_pk_bf16_f32 v104, v8, v9
    v_add_f32 v10, v10, v96
    v_add_f32 v11, v11, v96
    v_lshlrev_b32 v102, 16, v149
    v_and_b32 v103, 0xffff0000, v149
    v_mul_f32 v10, v10, v102
    v_mul_f32 v11, v11, v103
    v_cvt_pk_bf16_f32 v105, v10, v11
    v_add_f32 v12, v12, v96
    v_add_f32 v13, v13, v96
    v_lshlrev_b32 v100, 16, v150
    v_and_b32 v101, 0xffff0000, v150
    v_mul_f32 v12, v12, v100
    v_mul_f32 v13, v13, v101
    v_cvt_pk_bf16_f32 v106, v12, v13
    v_add_f32 v14, v14, v96
    v_add_f32 v15, v15, v96
    v_lshlrev_b32 v102, 16, v151
    v_and_b32 v103, 0xffff0000, v151
    v_mul_f32 v14, v14, v102
    v_mul_f32 v15, v15, v103
    v_cvt_pk_bf16_f32 v107, v14, v15
    s_cmp_eq_u32 s37, 1
    s_cbranch_scc1 L_k_hs_71
    buffer_store_dwordx4 v[104:107], v1, s[8:11], s29 offen offset:0 sc1
    s_branch L_k_hd_72
L_k_hs_71:
    buffer_store_dwordx4 v[104:107], v1, s[8:11], s29 offen offset:0
L_k_hd_72:
    v_add_f32 v16, v16, v96
    v_add_f32 v17, v17, v96
    v_lshlrev_b32 v100, 16, v152
    v_and_b32 v101, 0xffff0000, v152
    v_mul_f32 v16, v16, v100
    v_mul_f32 v17, v17, v101
    v_cvt_pk_bf16_f32 v108, v16, v17
    v_add_f32 v18, v18, v96
    v_add_f32 v19, v19, v96
    v_lshlrev_b32 v102, 16, v153
    v_and_b32 v103, 0xffff0000, v153
    v_mul_f32 v18, v18, v102
    v_mul_f32 v19, v19, v103
    v_cvt_pk_bf16_f32 v109, v18, v19
    v_add_f32 v20, v20, v96
    v_add_f32 v21, v21, v96
    v_lshlrev_b32 v100, 16, v154
    v_and_b32 v101, 0xffff0000, v154
    v_mul_f32 v20, v20, v100
    v_mul_f32 v21, v21, v101
    v_cvt_pk_bf16_f32 v110, v20, v21
    v_add_f32 v22, v22, v96
    v_add_f32 v23, v23, v96
    v_lshlrev_b32 v102, 16, v155
    v_and_b32 v103, 0xffff0000, v155
    v_mul_f32 v22, v22, v102
    v_mul_f32 v23, v23, v103
    v_cvt_pk_bf16_f32 v111, v22, v23
    s_cmp_eq_u32 s37, 1
    s_cbranch_scc1 L_k_hs_73
    buffer_store_dwordx4 v[108:111], v1, s[8:11], s29 offen offset:1024 sc1
    s_branch L_k_hd_74
L_k_hs_73:
    buffer_store_dwordx4 v[108:111], v1, s[8:11], s29 offen offset:1024
L_k_hd_74:
    v_mov_b32 v8, 0
    v_mov_b32 v9, s50
    s_mov_b64 exec, 1
    s_waitcnt vmcnt(0)
    s_cmp_eq_u32 s37, 1
    s_cbranch_scc1 L_k_hs_75
    buffer_store_dword v9, v8, s[8:11], s38 offen sc1
    s_branch L_k_hd_76
L_k_hs_75:
    buffer_store_dword v9, v8, s[8:11], s38 offen
L_k_hd_76:
    s_mov_b64 exec, -1
    s_mov_b32 s24, s44
    s_mov_b32 s25, s45
    s_mov_b32 s26, 0x280000
    s_mov_b32 s27, 0x20000
    s_lshl_b32 s3, s15, 7
    s_add_u32 s3, s3, 125952
    v_lshlrev_b32 v136, 4, v3
    v_add_u32 v136, s3, v136
    v_mul_u32_u24 v137, 1280, v2
    v_lshl_add_u32 v137, v3, 4, v137
    s_mul_i32 s28, s16, 40960
    s_mul_i32 s6, s13, 160
    s_add_u32 s28, s28, s6
    s_lshl_b32 s6, s15, 6
    s_add_u32 s28, s28, s6
    s_mul_i32 s3, s17, 4096
    s_add_u32 s3, s3, 12288
    v_add_u32 v4, s3, v1
    v_add_u32 v5, 61440, v4
    s_lshl_b32 s3, s15, 10
    v_add_u32 v6, s3, v1
    v_add_u32 v7, 61440, v6
    s_cmp_lg_u32 s15, 2
    s_cbranch_scc1 L_k_c2_77
    v_and_b32 v6, 0xf0, v1
    v_lshl_add_u32 v6, v3, 8, v6
    v_add_u32 v6, 2048, v6
    v_add_u32 v7, 61440, v6
L_k_c2_77:
    s_barrier
    ds_read_b128 v[24:27], v5 offset:40960
    ds_read_b128 v[28:31], v7 offset:40960
    ds_read_b128 v[32:35], v5 offset:41984
    ds_read_b128 v[36:39], v7 offset:43520
    ds_read_b128 v[40:43], v5 offset:43008
    ds_read_b128 v[44:47], v7 offset:46080
    ds_read_b128 v[48:51], v5 offset:44032
    ds_read_b128 v[52:55], v7 offset:48640
    s_barrier
    s_waitcnt lgkmcnt(6)
    v_mfma_f32_32x32x16_bf16 v[8:23], v[28:31], v[24:27], 0
    ds_read_b128 v[56:59], v4 offset:0
    ds_read_b128 v[60:63], v6 offset:0
    s_waitcnt lgkmcnt(6)
    v_mfma_f32_32x32x16_bf16 v[8:23], v[36:39], v[32:35], v[8:23]
    ds_read_b128 v[64:67], v4 offset:1024
    ds_read_b128 v[68:71], v6 offset:2560
    s_waitcnt lgkmcnt(6)
    v_mfma_f32_32x32x16_bf16 v[8:23], v[44:47], v[40:43], v[8:23]
    ds_read_b128 v[72:75], v4 offset:2048
    ds_read_b128 v[76:79], v6 offset:5120
    s_waitcnt lgkmcnt(6)
    v_mfma_f32_32x32x16_bf16 v[8:23], v[52:55], v[48:51], v[8:23]
    ds_read_b128 v[80:83], v4 offset:3072
    ds_read_b128 v[84:87], v6 offset:7680
    s_barrier
    s_waitcnt lgkmcnt(6)
    v_mfma_f32_32x32x16_bf16 v[8:23], v[60:63], v[56:59], v[8:23]
    ds_read_b128 v[24:27], v4 offset:20480
    ds_read_b128 v[28:31], v6 offset:20480
    s_waitcnt lgkmcnt(6)
    v_mfma_f32_32x32x16_bf16 v[8:23], v[68:71], v[64:67], v[8:23]
    ds_read_b128 v[32:35], v4 offset:21504
    ds_read_b128 v[36:39], v6 offset:23040
    s_waitcnt lgkmcnt(6)
    v_mfma_f32_32x32x16_bf16 v[8:23], v[76:79], v[72:75], v[8:23]
    ds_read_b128 v[40:43], v4 offset:22528
    ds_read_b128 v[44:47], v6 offset:25600
    s_waitcnt lgkmcnt(6)
    v_mfma_f32_32x32x16_bf16 v[8:23], v[84:87], v[80:83], v[8:23]
    ds_read_b128 v[48:51], v4 offset:23552
    ds_read_b128 v[52:55], v6 offset:28160
    s_barrier
    s_waitcnt lgkmcnt(6)
    v_mfma_f32_32x32x16_bf16 v[8:23], v[28:31], v[24:27], v[8:23]
    ds_read_b128 v[56:59], v4 offset:40960
    ds_read_b128 v[60:63], v6 offset:40960
    s_waitcnt lgkmcnt(6)
    v_mfma_f32_32x32x16_bf16 v[8:23], v[36:39], v[32:35], v[8:23]
    ds_read_b128 v[64:67], v4 offset:41984
    ds_read_b128 v[68:71], v6 offset:43520
    s_waitcnt lgkmcnt(6)
    v_mfma_f32_32x32x16_bf16 v[8:23], v[44:47], v[40:43], v[8:23]
    ds_read_b128 v[72:75], v4 offset:43008
    ds_read_b128 v[76:79], v6 offset:46080
    s_waitcnt lgkmcnt(6)
    v_mfma_f32_32x32x16_bf16 v[8:23], v[52:55], v[48:51], v[8:23]
    ds_read_b128 v[80:83], v4 offset:44032
    ds_read_b128 v[84:87], v6 offset:48640
    s_barrier
    s_waitcnt lgkmcnt(6)
    v_mfma_f32_32x32x16_bf16 v[8:23], v[60:63], v[56:59], v[8:23]
    ds_read_b128 v[24:27], v5 offset:0
    ds_read_b128 v[28:31], v7 offset:0
    s_waitcnt lgkmcnt(6)
    v_mfma_f32_32x32x16_bf16 v[8:23], v[68:71], v[64:67], v[8:23]
    ds_read_b128 v[32:35], v5 offset:1024
    ds_read_b128 v[36:39], v7 offset:2560
    s_waitcnt lgkmcnt(6)
    v_mfma_f32_32x32x16_bf16 v[8:23], v[76:79], v[72:75], v[8:23]
    ds_read_b128 v[40:43], v5 offset:2048
    ds_read_b128 v[44:47], v7 offset:5120
    s_waitcnt lgkmcnt(6)
    v_mfma_f32_32x32x16_bf16 v[8:23], v[84:87], v[80:83], v[8:23]
    ds_read_b128 v[48:51], v5 offset:3072
    ds_read_b128 v[52:55], v7 offset:7680
    s_barrier
    s_waitcnt lgkmcnt(6)
    v_mfma_f32_32x32x16_bf16 v[8:23], v[28:31], v[24:27], v[8:23]
    ds_read_b128 v[56:59], v5 offset:20480
    ds_read_b128 v[60:63], v7 offset:20480
    s_waitcnt lgkmcnt(6)
    v_mfma_f32_32x32x16_bf16 v[8:23], v[36:39], v[32:35], v[8:23]
    ds_read_b128 v[64:67], v5 offset:21504
    ds_read_b128 v[68:71], v7 offset:23040
    s_waitcnt lgkmcnt(6)
    v_mfma_f32_32x32x16_bf16 v[8:23], v[44:47], v[40:43], v[8:23]
    ds_read_b128 v[72:75], v5 offset:22528
    ds_read_b128 v[76:79], v7 offset:25600
    s_waitcnt lgkmcnt(6)
    v_mfma_f32_32x32x16_bf16 v[8:23], v[52:55], v[48:51], v[8:23]
    ds_read_b128 v[80:83], v5 offset:23552
    ds_read_b128 v[84:87], v7 offset:28160
    s_barrier
    s_waitcnt lgkmcnt(6)
    v_mfma_f32_32x32x16_bf16 v[8:23], v[60:63], v[56:59], v[8:23]
    ds_read_b128 v[24:27], v5 offset:40960
    ds_read_b128 v[28:31], v7 offset:40960
    s_waitcnt lgkmcnt(6)
    v_mfma_f32_32x32x16_bf16 v[8:23], v[68:71], v[64:67], v[8:23]
    ds_read_b128 v[32:35], v5 offset:41984
    ds_read_b128 v[36:39], v7 offset:43520
    s_waitcnt lgkmcnt(6)
    v_mfma_f32_32x32x16_bf16 v[8:23], v[76:79], v[72:75], v[8:23]
    ds_read_b128 v[40:43], v5 offset:43008
    ds_read_b128 v[44:47], v7 offset:46080
    s_waitcnt lgkmcnt(6)
    v_mfma_f32_32x32x16_bf16 v[8:23], v[84:87], v[80:83], v[8:23]
    ds_read_b128 v[48:51], v5 offset:44032
    ds_read_b128 v[52:55], v7 offset:48640
    s_barrier
    s_waitcnt lgkmcnt(6)
    v_mfma_f32_32x32x16_bf16 v[8:23], v[28:31], v[24:27], v[8:23]
    ds_read_b128 v[56:59], v4 offset:0
    ds_read_b128 v[60:63], v6 offset:0
    s_waitcnt lgkmcnt(6)
    v_mfma_f32_32x32x16_bf16 v[8:23], v[36:39], v[32:35], v[8:23]
    ds_read_b128 v[64:67], v4 offset:1024
    ds_read_b128 v[68:71], v6 offset:2560
    s_waitcnt lgkmcnt(6)
    v_mfma_f32_32x32x16_bf16 v[8:23], v[44:47], v[40:43], v[8:23]
    ds_read_b128 v[72:75], v4 offset:2048
    ds_read_b128 v[76:79], v6 offset:5120
    s_waitcnt lgkmcnt(6)
    v_mfma_f32_32x32x16_bf16 v[8:23], v[52:55], v[48:51], v[8:23]
    ds_read_b128 v[80:83], v4 offset:3072
    ds_read_b128 v[84:87], v6 offset:7680
    s_barrier
    s_waitcnt lgkmcnt(6)
    v_mfma_f32_32x32x16_bf16 v[8:23], v[60:63], v[56:59], v[8:23]
    ds_read_b128 v[24:27], v4 offset:20480
    ds_read_b128 v[28:31], v6 offset:20480
    s_waitcnt lgkmcnt(6)
    v_mfma_f32_32x32x16_bf16 v[8:23], v[68:71], v[64:67], v[8:23]
    ds_read_b128 v[32:35], v4 offset:21504
    ds_read_b128 v[36:39], v6 offset:23040
    s_waitcnt lgkmcnt(6)
    v_mfma_f32_32x32x16_bf16 v[8:23], v[76:79], v[72:75], v[8:23]
    ds_read_b128 v[40:43], v4 offset:22528
    ds_read_b128 v[44:47], v6 offset:25600
    s_waitcnt lgkmcnt(6)
    v_mfma_f32_32x32x16_bf16 v[8:23], v[84:87], v[80:83], v[8:23]
    ds_read_b128 v[48:51], v4 offset:23552
    ds_read_b128 v[52:55], v6 offset:28160
    s_barrier
    s_waitcnt lgkmcnt(6)
    v_mfma_f32_32x32x16_bf16 v[8:23], v[28:31], v[24:27], v[8:23]
    ds_read_b128 v[56:59], v4 offset:40960
    ds_read_b128 v[60:63], v6 offset:40960
    s_waitcnt lgkmcnt(6)
    v_mfma_f32_32x32x16_bf16 v[8:23], v[36:39], v[32:35], v[8:23]
    ds_read_b128 v[64:67], v4 offset:41984
    ds_read_b128 v[68:71], v6 offset:43520
    s_waitcnt lgkmcnt(6)
    v_mfma_f32_32x32x16_bf16 v[8:23], v[44:47], v[40:43], v[8:23]
    ds_read_b128 v[72:75], v4 offset:43008
    ds_read_b128 v[76:79], v6 offset:46080
    s_waitcnt lgkmcnt(6)
    v_mfma_f32_32x32x16_bf16 v[8:23], v[52:55], v[48:51], v[8:23]
    ds_read_b128 v[80:83], v4 offset:44032
    ds_read_b128 v[84:87], v6 offset:48640
    s_barrier
    s_waitcnt lgkmcnt(6)
    v_mfma_f32_32x32x16_bf16 v[8:23], v[60:63], v[56:59], v[8:23]
    ds_read_b128 v[24:27], v5 offset:0
    ds_read_b128 v[28:31], v7 offset:0
    s_waitcnt lgkmcnt(6)
    v_mfma_f32_32x32x16_bf16 v[8:23], v[68:71], v[64:67], v[8:23]
    ds_read_b128 v[32:35], v5 offset:1024
    ds_read_b128 v[36:39], v7 offset:2560
    s_waitcnt lgkmcnt(6)
    v_mfma_f32_32x32x16_bf16 v[8:23], v[76:79], v[72:75], v[8:23]
    ds_read_b128 v[40:43], v5 offset:2048
    ds_read_b128 v[44:47], v7 offset:5120
    s_waitcnt lgkmcnt(6)
    v_mfma_f32_32x32x16_bf16 v[8:23], v[84:87], v[80:83], v[8:23]
    ds_read_b128 v[48:51], v5 offset:3072
    ds_read_b128 v[52:55], v7 offset:7680
    ds_read_b128 v[112:115], v136 offset:0
    ds_read_b128 v[116:119], v136 offset:32
    ds_read_b128 v[120:123], v136 offset:64
    ds_read_b128 v[124:127], v136 offset:96
    s_barrier
    s_waitcnt lgkmcnt(10)
    v_mfma_f32_32x32x16_bf16 v[8:23], v[28:31], v[24:27], v[8:23]
    ds_read_b128 v[56:59], v5 offset:20480
    ds_read_b128 v[60:63], v7 offset:20480
    s_waitcnt lgkmcnt(10)
    v_mfma_f32_32x32x16_bf16 v[8:23], v[36:39], v[32:35], v[8:23]
    ds_read_b128 v[64:67], v5 offset:21504
    ds_read_b128 v[68:71], v7 offset:23040
    s_waitcnt lgkmcnt(10)
    v_mfma_f32_32x32x16_bf16 v[8:23], v[44:47], v[40:43], v[8:23]
    ds_read_b128 v[72:75], v5 offset:22528
    ds_read_b128 v[76:79], v7 offset:25600
    s_waitcnt lgkmcnt(10)
    v_mfma_f32_32x32x16_bf16 v[8:23], v[52:55], v[48:51], v[8:23]
    ds_read_b128 v[80:83], v5 offset:23552
    ds_read_b128 v[84:87], v7 offset:28160
    s_waitcnt lgkmcnt(6)
    v_mfma_f32_32x32x16_bf16 v[8:23], v[60:63], v[56:59], v[8:23]
    s_waitcnt lgkmcnt(4)
    v_mfma_f32_32x32x16_bf16 v[8:23], v[68:71], v[64:67], v[8:23]
    s_waitcnt lgkmcnt(2)
    v_mfma_f32_32x32x16_bf16 v[8:23], v[76:79], v[72:75], v[8:23]
    s_waitcnt lgkmcnt(0)
    v_mfma_f32_32x32x16_bf16 v[8:23], v[84:87], v[80:83], v[8:23]
    s_waitcnt lgkmcnt(0)
    s_nop 8
    v_lshlrev_b32 v100, 16, v140
    v_and_b32 v101, 0xffff0000, v140
    v_fmac_f32 v100, v112, v8
    v_fmac_f32 v101, v113, v9
    v_cvt_pk_bf16_f32 v104, v100, v101
    v_lshlrev_b32 v102, 16, v141
    v_and_b32 v103, 0xffff0000, v141
    v_fmac_f32 v102, v114, v10
    v_fmac_f32 v103, v115, v11
    v_cvt_pk_bf16_f32 v105, v102, v103
    v_lshlrev_b32 v100, 16, v142
    v_and_b32 v101, 0xffff0000, v142
    v_fmac_f32 v100, v116, v12
    v_fmac_f32 v101, v117, v13
    v_cvt_pk_bf16_f32 v106, v100, v101
    v_lshlrev_b32 v102, 16, v143
    v_and_b32 v103, 0xffff0000, v143
    v_fmac_f32 v102, v118, v14
    v_fmac_f32 v103, v119, v15
    v_cvt_pk_bf16_f32 v107, v102, v103
    s_nop 1
    v_permlane32_swap_b32 v104, v106
    v_permlane32_swap_b32 v105, v107
    buffer_store_dwordx4 v[104:107], v137, s[24:27], s28 offen offset:0 sc1
    s_cmp_eq_u32 s15, 2
    s_cbranch_scc1 L_k_skip_78
    v_lshlrev_b32 v100, 16, v144
    v_and_b32 v101, 0xffff0000, v144
    v_fmac_f32 v100, v120, v16
    v_fmac_f32 v101, v121, v17
    v_cvt_pk_bf16_f32 v108, v100, v101
    v_lshlrev_b32 v102, 16, v145
    v_and_b32 v103, 0xffff0000, v145
    v_fmac_f32 v102, v122, v18
    v_fmac_f32 v103, v123, v19
    v_cvt_pk_bf16_f32 v109, v102, v103
    v_lshlrev_b32 v100, 16, v146
    v_and_b32 v101, 0xffff0000, v146
    v_fmac_f32 v100, v124, v20
    v_fmac_f32 v101, v125, v21
    v_cvt_pk_bf16_f32 v110, v100, v101
    v_lshlrev_b32 v102, 16, v147
    v_and_b32 v103, 0xffff0000, v147
    v_fmac_f32 v102, v126, v22
    v_fmac_f32 v103, v127, v23
    v_cvt_pk_bf16_f32 v111, v102, v103
    s_nop 1
    v_permlane32_swap_b32 v108, v110
    v_permlane32_swap_b32 v109, v111
    buffer_store_dwordx4 v[108:111], v137, s[24:27], s28 offen offset:32 sc1
L_k_skip_78:
    s_branch L_k_end
L_k_idle:
    s_sub_u32 s15, s14, 4
    s_and_b32 s49, s12, 7
    s_barrier
L_k_idle2:
    s_barrier
    s_barrier
    s_cmp_eq_u32 s27, 1
    s_cbranch_scc1 L_k_isk_79
    s_mov_b32 s40, s58
    s_mov_b32 s41, s59
    s_mov_b32 s42, 0x800000
    s_mov_b32 s43, 0x20000
    s_lshl_b32 s17, s12, 1
    s_add_u32 s17, s17, s15
    s_lshl_b32 s6, s17, 17
    s_lshl_b32 s7, s13, 9
    s_add_u32 s6, s6, s7
    v_lshlrev_b32 v4, 12, v2
    v_lshl_add_u32 v4, v3, 4, v4
    buffer_load_dwordx4 v[16:19], v4, s[40:43], s6 offen offset:0 nt
    buffer_load_dwordx4 v[20:23], v4, s[40:43], s6 offen offset:32 nt
    buffer_load_dwordx4 v[24:27], v4, s[40:43], s6 offen offset:64 nt
    buffer_load_dwordx4 v[28:31], v4, s[40:43], s6 offen offset:96 nt
    buffer_load_dwordx4 v[32:35], v4, s[40:43], s6 offen offset:128 nt
    buffer_load_dwordx4 v[36:39], v4, s[40:43], s6 offen offset:160 nt
    buffer_load_dwordx4 v[40:43], v4, s[40:43], s6 offen offset:192 nt
    buffer_load_dwordx4 v[44:47], v4, s[40:43], s6 offen offset:224 nt
    buffer_load_dwordx4 v[48:51], v4, s[40:43], s6 offen offset:256 nt
    buffer_load_dwordx4 v[52:55], v4, s[40:43], s6 offen offset:288 nt
    buffer_load_dwordx4 v[56:59], v4, s[40:43], s6 offen offset:320 nt
    buffer_load_dwordx4 v[60:63], v4, s[40:43], s6 offen offset:352 nt
    buffer_load_dwordx4 v[64:67], v4, s[40:43], s6 offen offset:384 nt
    buffer_load_dwordx4 v[68:71], v4, s[40:43], s6 offen offset:416 nt
    buffer_load_dwordx4 v[72:75], v4, s[40:43], s6 offen offset:448 nt
    buffer_load_dwordx4 v[76:79], v4, s[40:43], s6 offen offset:480 nt
    s_lshl_b32 s3, s12, 8
    s_add_u32 s3, s3, 0x10000
    v_and_b32 v80, 7, v0
    v_lshlrev_b32 v80, 2, v80
    buffer_load_dword v80, v80, s[8:11], s3 offen sc1
L_k_isk_79:
    v_mov_b32 v6, 159776
    v_mov_b32 v7, 1
L_k_wdone_80:
    ds_read_b32 v8, v6
    s_waitcnt lgkmcnt(0)
    v_readfirstlane_b32 s3, v8
    s_cmp_ge_u32 s3, 4
    s_cbranch_scc1 L_k_wdone_80x
    s_sleep 16
    s_branch L_k_wdone_80
L_k_wdone_80x:
    s_add_u32 s3, s49, s15
    s_add_u32 s3, s3, 6
    s_and_b32 s3, s3, 7
    s_mul_i32 s31, s3, 26624
    s_add_u32 s31, s31, 0xd00000
    s_mul_i32 s3, s15, 26624
    s_mov_b32 m0, s3
    s_mov_b32 s30, 26
L_k_wdone_80d:
    buffer_load_dwordx4 v1, s[8:11], s31 offen sc1 lds
    s_add_u32 m0, m0, 1024
    s_add_u32 s31, s31, 1024
    s_sub_u32 s30, s30, 1
    s_cmp_lg_u32 s30, 0
    s_cbranch_scc1 L_k_wdone_80d
    s_waitcnt vmcnt(0)
    s_mov_b64 exec, 1
    ds_add_u32 v6, v7 offset:4
    s_mov_b64 exec, -1
    s_waitcnt lgkmcnt(0)
    s_cmp_eq_u32 s27, 1
    s_cbranch_scc1 L_k_rb
    s_getreg_b32 s36, hwreg(HW_REG_XCC_ID, 0, 4)
    s_add_u32 s36, s36, s50
    v_cmp_ne_u32 vcc, s36, v80
    s_nop 1
    s_cmp_eq_u64 vcc, 0
    s_cselect_b32 s37, 1, 0
    s_lshl_b32 s6, s17, 7
    s_lshl_b32 s7, s13, 4
    s_add_u32 s6, s6, s7
    s_lshl_b32 s6, s6, 10
    s_add_u32 s6, s6, 0x1d00000
    s_cmp_eq_u32 s37, 1
    s_cbranch_scc1 L_k_wf_81
    buffer_store_dwordx4 v[16:19], v1, s[8:11], s6 offen offset:0 sc1
    buffer_store_dwordx4 v[20:23], v1, s[8:11], s6 offen offset:1024 sc1
    buffer_store_dwordx4 v[24:27], v1, s[8:11], s6 offen offset:2048 sc1
    buffer_store_dwordx4 v[28:31], v1, s[8:11], s6 offen offset:3072 sc1
    s_add_u32 s6, s6, 4096
    buffer_store_dwordx4 v[32:35], v1, s[8:11], s6 offen offset:0 sc1
    buffer_store_dwordx4 v[36:39], v1, s[8:11], s6 offen offset:1024 sc1
    buffer_store_dwordx4 v[40:43], v1, s[8:11], s6 offen offset:2048 sc1
    buffer_store_dwordx4 v[44:47], v1, s[8:11], s6 offen offset:3072 sc1
    s_add_u32 s6, s6, 4096
    buffer_store_dwordx4 v[48:51], v1, s[8:11], s6 offen offset:0 sc1
    buffer_store_dwordx4 v[52:55], v1, s[8:11], s6 offen offset:1024 sc1
    buffer_store_dwordx4 v[56:59], v1, s[8:11], s6 offen offset:2048 sc1
    buffer_store_dwordx4 v[60:63], v1, s[8:11], s6 offen offset:3072 sc1
    s_add_u32 s6, s6, 4096
    buffer_store_dwordx4 v[64:67], v1, s[8:11], s6 offen offset:0 sc1
    buffer_store_dwordx4 v[68:71], v1, s[8:11], s6 offen offset:1024 sc1
    buffer_store_dwordx4 v[72:75], v1, s[8:11], s6 offen offset:2048 sc1
    buffer_store_dwordx4 v[76:79], v1, s[8:11], s6 offen offset:3072 sc1
    s_add_u32 s6, s6, 4096
    s_branch L_k_wd_82
L_k_wf_81:
    buffer_store_dwordx4 v[16:19], v1, s[8:11], s6 offen offset:0 sc1
    buffer_store_dwordx4 v[20:23], v1, s[8:11], s6 offen offset:1024 sc1
    buffer_store_dwordx4 v[24:27], v1, s[8:11], s6 offen offset:2048 sc1
    buffer_store_dwordx4 v[28:31], v1, s[8:11], s6 offen offset:3072 sc1
    s_add_u32 s6, s6, 4096
    buffer_store_dwordx4 v[32:35], v1, s[8:11], s6 offen offset:0 sc1
    buffer_store_dwordx4 v[36:39], v1, s[8:11], s6 offen offset:1024 sc1
    buffer_store_dwordx4 v[40:43], v1, s[8:11], s6 offen offset:2048 sc1
    buffer_store_dwordx4 v[44:47], v1, s[8:11], s6 offen offset:3072 sc1
    s_add_u32 s6, s6, 4096
    buffer_store_dwordx4 v[48:51], v1, s[8:11], s6 offen offset:0 sc1
    buffer_store_dwordx4 v[52:55], v1, s[8:11], s6 offen offset:1024 sc1
    buffer_store_dwordx4 v[56:59], v1, s[8:11], s6 offen offset:2048 sc1
    buffer_store_dwordx4 v[60:63], v1, s[8:11], s6 offen offset:3072 sc1
    s_add_u32 s6, s6, 4096
    buffer_store_dwordx4 v[64:67], v1, s[8:11], s6 offen offset:0 sc1
    buffer_store_dwordx4 v[68:71], v1, s[8:11], s6 offen offset:1024 sc1
    buffer_store_dwordx4 v[72:75], v1, s[8:11], s6 offen offset:2048 sc1
    buffer_store_dwordx4 v[76:79], v1, s[8:11], s6 offen offset:3072 sc1
    s_add_u32 s6, s6, 4096
L_k_wd_82:
    v_lshlrev_b32 v4, 3, v1
    s_cmp_eq_u32 s14, 5
    s_cbranch_scc1 L_k_pt_83
    s_mul_i32 s28, s12, 163840
    s_mul_i32 s3, s13, 10240
    s_add_u32 s28, s28, s3
    s_add_u32 s28, s28, 0xe00000
    buffer_load_dword v12, v4, s[8:11], s28 offen
    s_add_u32 s28, s28, 8192
    s_mov_b32 exec_lo, 0xffff
    s_mov_b32 exec_hi, 0x0
    buffer_load_dword v12, v4, s[8:11], s28 offen
    s_mov_b64 exec, -1
    s_mul_i32 s28, s12, 12288
    s_mul_i32 s3, s13, 1536
    s_add_u32 s28, s28, s3
    s_add_u32 s28, s28, 0x1300000
    s_mov_b32 exec_lo, 0xfff
    s_mov_b32 exec_hi, 0x0
    buffer_load_dword v12, v4, s[8:11], s28 offen
    s_mov_b64 exec, -1
    s_mul_i32 s28, s12, 12288
    s_mul_i32 s3, s13, 1536
    s_add_u32 s28, s28, s3
    s_add_u32 s28, s28, 0x1360000
    s_mov_b32 exec_lo, 0xfff
    s_mov_b32 exec_hi, 0x0
    buffer_load_dword v12, v4, s[8:11], s28 offen
    s_mov_b64 exec, -1
    s_branch L_k_pt_84
L_k_pt_83:
    s_mul_i32 s28, s12, 163840
    s_mul_i32 s3, s13, 10240
    s_add_u32 s28, s28, s3
    s_add_u32 s28, s28, 0xe14000
    buffer_load_dword v12, v4, s[8:11], s28 offen
    s_add_u32 s28, s28, 8192
    s_mov_b32 exec_lo, 0xffff
    s_mov_b32 exec_hi, 0x0
    buffer_load_dword v12, v4, s[8:11], s28 offen
    s_mov_b64 exec, -1
    s_mov_b32 s40, s44
    s_mov_b32 s41, s45
    s_mov_b32 s42, 0x280000
    s_mov_b32 s43, 0x20000
    s_mul_i32 s28, s12, 81920
    s_mul_i32 s3, s13, 10240
    s_add_u32 s28, s28, s3
    s_add_u32 s28, s28, 0x0
    buffer_load_dword v12, v4, s[40:43], s28 offen
    s_add_u32 s28, s28, 8192
    s_mov_b32 exec_lo, 0xffff
    s_mov_b32 exec_hi, 0x0
    buffer_load_dword v12, v4, s[40:43], s28 offen
    s_mov_b64 exec, -1
L_k_pt_84:
    s_lshl_b32 s38, s12, 8
    s_lshl_b32 s6, s13, 1
    s_add_u32 s6, s6, s15
    s_lshl_b32 s6, s6, 2
    s_add_u32 s38, s38, s6
    s_add_u32 s38, s38, 0x18000
    v_mov_b32 v8, 0
    v_mov_b32 v9, s50
    s_mov_b64 exec, 1
    s_waitcnt vmcnt(0)
    s_cmp_eq_u32 s37, 1
    s_cbranch_scc1 L_k_hs_85
    buffer_store_dword v9, v8, s[8:11], s38 offen sc1
    s_branch L_k_hd_86
L_k_hs_85:
    buffer_store_dword v9, v8, s[8:11], s38 offen
L_k_hd_86:
    s_mov_b64 exec, -1
L_k_vote3:
    s_barrier
    v_mov_b32 v44, 159744
    ds_read_b128 v[40:43], v44
    s_waitcnt lgkmcnt(0)
    v_or_b32 v40, v40, v41
    v_or_b32 v40, v40, v42
    v_or_b32 v40, v40, v43
    s_nop 0
    v_readfirstlane_b32 s3, v40
    s_cmp_eq_u32 s3, 0
    s_cbranch_scc1 L_k_pa
    s_mov_b32 s27, 1
    s_mov_b32 s24, 18
L_k_idleb:
    s_barrier
    s_sub_u32 s24, s24, 1
    s_cmp_lg_u32 s24, 0
    s_cbranch_scc1 L_k_idleb
    s_branch L_k_idle2
L_k_helper:
    s_setprio 2
    s_lshl_b32 s47, s15, 10
    s_add_u32 s46, s47, 0xd00000
    s_mov_b32 s30, 0x48000
    s_and_b32 s49, s12, 7
    s_lshl_b32 s3, s49, 11
    s_add_u32 s30, s30, s3
    v_and_b32 v4, 15, v2
    v_lshlrev_b32 v4, 7, v4
    v_mov_b32 v12, 159804
    s_cmp_lg_u32 s15, 0
    s_cbranch_scc1 L_k_gw_89
    s_mov_b32 s29, 0x8000
L_k_gp_87:
    buffer_load_dword v6, v4, s[8:11], s30 offen sc1
    s_waitcnt vmcnt(0)
    v_xor_b32 v6, s50, v6
    v_cmp_ne_u32 vcc, 0, v6
    s_sub_u32 s29, s29, 1
    s_cbranch_scc1 L_k_go_88
    s_cbranch_vccz L_k_go_88
    s_sleep 2
    s_branch L_k_gp_87
L_k_go_88:
    v_mov_b32 v13, 1
    ds_write_b32 v12, v13
    s_waitcnt lgkmcnt(0)
    s_branch L_k_gd_90
L_k_gw_89:
    ds_read_b32 v13, v12
    s_waitcnt lgkmcnt(0)
    v_readfirstlane_b32 s3, v13
    s_cmp_eq_u32 s3, 1
    s_cbranch_scc1 L_k_gd_90
    s_sleep 1
    s_branch L_k_gw_89
L_k_gd_90:
    s_waitcnt vmcnt(0)
L_k_hmain:
    s_add_u32 s3, s49, 0
    s_and_b32 s3, s3, 7
    s_mul_i32 s3, s3, 26624
    s_add_u32 s31, s46, s3
    s_add_u32 m0, s47, 0
    s_add_u32 s48, s31, 0
    buffer_load_dwordx4 v1, s[8:11], s48 offen sc1 lds
    s_add_u32 m0, s47, 4096
    s_add_u32 s48, s31, 4096
    buffer_load_dwordx4 v1, s[8:11], s48 offen sc1 lds
    s_add_u32 m0, s47, 8192
    s_add_u32 s48, s31, 8192
    buffer_load_dwordx4 v1, s[8:11], s48 offen sc1 lds
    s_add_u32 m0, s47, 12288
    s_add_u32 s48, s31, 12288
    buffer_load_dwordx4 v1, s[8:11], s48 offen sc1 lds
    s_add_u32 m0, s47, 16384
    s_add_u32 s48, s31, 16384
    buffer_load_dwordx4 v1, s[8:11], s48 offen sc1 lds
    s_add_u32 m0, s47, 20480
    s_add_u32 s48, s31, 20480
    buffer_load_dwordx4 v1, s[8:11], s48 offen sc1 lds
    s_cmp_ge_u32 s15, 2
    s_cbranch_scc1 L_k_d_91
    s_add_u32 m0, s47, 24576
    s_add_u32 s48, s31, 24576
    buffer_load_dwordx4 v1, s[8:11], s48 offen sc1 lds
L_k_d_91:
    s_waitcnt vmcnt(0)
    s_barrier
    v_mov_b32 v6, 159776
    v_mov_b32 v7, 1
    s_mov_b32 s30, 0x48000
    v_lshlrev_b32 v4, 3, v1
    v_mov_b32 v12, 159816
    s_cmp_lg_u32 s15, 0
    s_cbranch_scc1 L_k_gw_94
    s_mov_b32 s29, 0x8000
L_k_gp_92:
    buffer_load_dword v6, v4, s[8:11], s30 offen sc1
    s_add_u32 s3, s30, 8192
    buffer_load_dword v7, v4, s[8:11], s3 offen sc1
    s_waitcnt vmcnt(0)
    v_xor_b32 v6, s50, v6
    v_xor_b32 v7, s50, v7
    v_or_b32 v6, v6, v7
    v_cmp_ne_u32 vcc, 0, v6
    s_sub_u32 s29, s29, 1
    s_cbranch_scc1 L_k_go_93
    s_cbranch_vccz L_k_go_93
    s_sleep 2
    s_branch L_k_gp_92
L_k_go_93:
    v_mov_b32 v13, 1
    ds_write_b32 v12, v13
    s_waitcnt lgkmcnt(0)
    s_branch L_k_gd_95
L_k_gw_94:
    ds_read_b32 v13, v12
    s_waitcnt lgkmcnt(0)
    v_readfirstlane_b32 s3, v13
    s_cmp_eq_u32 s3, 1
    s_cbranch_scc1 L_k_gd_95
    s_sleep 1
    s_branch L_k_gw_94
L_k_gd_95:
    s_waitcnt vmcnt(0)
    s_add_u32 s3, s49, 1
    s_and_b32 s3, s3, 7
    s_mul_i32 s3, s3, 26624
    s_add_u32 s31, s46, s3
    s_add_u32 m0, s47, 26624
    s_add_u32 s48, s31, 0
    buffer_load_dwordx4 v1, s[8:11], s48 offen sc1 lds
    s_add_u32 m0, s47, 30720
    s_add_u32 s48, s31, 4096
    buffer_load_dwordx4 v1, s[8:11], s48 offen sc1 lds
    s_add_u32 m0, s47, 34816
    s_add_u32 s48, s31, 8192
    buffer_load_dwordx4 v1, s[8:11], s48 offen sc1 lds
    s_add_u32 m0, s47, 38912
    s_add_u32 s48, s31, 12288
    buffer_load_dwordx4 v1, s[8:11], s48 offen sc1 lds
    s_add_u32 m0, s47, 43008
    s_add_u32 s48, s31, 16384
    buffer_load_dwordx4 v1, s[8:11], s48 offen sc1 lds
    s_add_u32 m0, s47, 47104
    s_add_u32 s48, s31, 20480
    buffer_load_dwordx4 v1, s[8:11], s48 offen sc1 lds
    s_cmp_ge_u32 s15, 2
    s_cbranch_scc1 L_k_d_96
    s_add_u32 m0, s47, 51200
    s_add_u32 s48, s31, 24576
    buffer_load_dwordx4 v1, s[8:11], s48 offen sc1 lds
L_k_d_96:
    s_add_u32 s3, s49, 2
    s_and_b32 s3, s3, 7
    s_mul_i32 s3, s3, 26624
    s_add_u32 s31, s46, s3
    s_add_u32 m0, s47, 53248
    s_add_u32 s48, s31, 0
    buffer_load_dwordx4 v1, s[8:11], s48 offen sc1 lds
    s_add_u32 m0, s47, 57344
    s_add_u32 s48, s31, 4096
    buffer_load_dwordx4 v1, s[8:11], s48 offen sc1 lds
    s_add_u32 m0, s47, 61440
    s_add_u32 s48, s31, 8192
    buffer_load_dwordx4 v1, s[8:11], s48 offen sc1 lds
    s_add_u32 m0, s47, 65536
    s_add_u32 s48, s31, 12288
    buffer_load_dwordx4 v1, s[8:11], s48 offen sc1 lds
    s_add_u32 m0, s47, 69632
    s_add_u32 s48, s31, 16384
    buffer_load_dwordx4 v1, s[8:11], s48 offen sc1 lds
    s_add_u32 m0, s47, 73728
    s_add_u32 s48, s31, 20480
    buffer_load_dwordx4 v1, s[8:11], s48 offen sc1 lds
    s_cmp_ge_u32 s15, 2
    s_cbranch_scc1 L_k_d_97
    s_add_u32 m0, s47, 77824
    s_add_u32 s48, s31, 24576
    buffer_load_dwordx4 v1, s[8:11], s48 offen sc1 lds
L_k_d_97:
    s_waitcnt vmcnt(0)
    s_barrier
    s_add_u32 s3, s49, 3
    s_and_b32 s3, s3, 7
    s_mul_i32 s3, s3, 26624
    s_add_u32 s31, s46, s3
    s_add_u32 m0, s47, 79872
    s_add_u32 s48, s31, 0
    buffer_load_dwordx4 v1, s[8:11], s48 offen sc1 lds
    s_add_u32 m0, s47, 83968
    s_add_u32 s48, s31, 4096
    buffer_load_dwordx4 v1, s[8:11], s48 offen sc1 lds
    s_add_u32 m0, s47, 88064
    s_add_u32 s48, s31, 8192
    buffer_load_dwordx4 v1, s[8:11], s48 offen sc1 lds
    s_add_u32 m0, s47, 92160
    s_add_u32 s48, s31, 12288
    buffer_load_dwordx4 v1, s[8:11], s48 offen sc1 lds
    s_add_u32 m0, s47, 96256
    s_add_u32 s48, s31, 16384
    buffer_load_dwordx4 v1, s[8:11], s48 offen sc1 lds
    s_add_u32 m0, s47, 100352
    s_add_u32 s48, s31, 20480
    buffer_load_dwordx4 v1, s[8:11], s48 offen sc1 lds
    s_cmp_ge_u32 s15, 2
    s_cbranch_scc1 L_k_d_98
    s_add_u32 m0, s47, 104448
    s_add_u32 s48, s31, 24576
    buffer_load_dwordx4 v1, s[8:11], s48 offen sc1 lds
L_k_d_98:
    s_add_u32 s3, s49, 4
    s_and_b32 s3, s3, 7
    s_mul_i32 s3, s3, 26624
    s_add_u32 s31, s46, s3
    s_add_u32 m0, s47, 106496
    s_add_u32 s48, s31, 0
    buffer_load_dwordx4 v1, s[8:11], s48 offen sc1 lds
    s_add_u32 m0, s47, 110592
    s_add_u32 s48, s31, 4096
    buffer_load_dwordx4 v1, s[8:11], s48 offen sc1 lds
    s_add_u32 m0, s47, 114688
    s_add_u32 s48, s31, 8192
    buffer_load_dwordx4 v1, s[8:11], s48 offen sc1 lds
    s_add_u32 m0, s47, 118784
    s_add_u32 s48, s31, 12288
    buffer_load_dwordx4 v1, s[8:11], s48 offen sc1 lds
    s_add_u32 m0, s47, 122880
    s_add_u32 s48, s31, 16384
    buffer_load_dwordx4 v1, s[8:11], s48 offen sc1 lds
    s_add_u32 m0, s47, 126976
    s_add_u32 s48, s31, 20480
    buffer_load_dwordx4 v1, s[8:11], s48 offen sc1 lds
    s_cmp_ge_u32 s15, 2
    s_cbranch_scc1 L_k_d_99
    s_add_u32 m0, s47, 131072
    s_add_u32 s48, s31, 24576
    buffer_load_dwordx4 v1, s[8:11], s48 offen sc1 lds
L_k_d_99:
    s_add_u32 s3, s49, 5
    s_and_b32 s3, s3, 7
    s_mul_i32 s3, s3, 26624
    s_add_u32 s31, s46, s3
    s_add_u32 m0, s47, 133120
    s_add_u32 s48, s31, 0
    buffer_load_dwordx4 v1, s[8:11], s48 offen sc1 lds
    s_add_u32 m0, s47, 137216
    s_add_u32 s48, s31, 4096
    buffer_load_dwordx4 v1, s[8:11], s48 offen sc1 lds
    s_add_u32 m0, s47, 141312
    s_add_u32 s48, s31, 8192
    buffer_load_dwordx4 v1, s[8:11], s48 offen sc1 lds
    s_add_u32 m0, s47, 145408
    s_add_u32 s48, s31, 12288
    buffer_load_dwordx4 v1, s[8:11], s48 offen sc1 lds
    s_add_u32 m0, s47, 149504
    s_add_u32 s48, s31, 16384
    buffer_load_dwordx4 v1, s[8:11], s48 offen sc1 lds
    s_add_u32 m0, s47, 153600
    s_add_u32 s48, s31, 20480
    buffer_load_dwordx4 v1, s[8:11], s48 offen sc1 lds
    s_cmp_ge_u32 s15, 2
    s_cbranch_scc1 L_k_d_100
    s_add_u32 m0, s47, 157696
    s_add_u32 s48, s31, 24576
    buffer_load_dwordx4 v1, s[8:11], s48 offen sc1 lds
L_k_d_100:
    s_waitcnt vmcnt(0)
    s_barrier
    s_cmp_lg_u32 s27, 0
    s_cbranch_scc1 L_k_noside_101
    v_lshlrev_b32 v4, 3, v1
    s_mov_b32 s30, 0x40000
    v_mov_b32 v12, 159784
    s_cmp_lg_u32 s15, 0
    s_cbranch_scc1 L_k_gw_104
    s_mov_b32 s29, 0x8000
L_k_gp_102:
    buffer_load_dword v6, v4, s[8:11], s30 offen sc1
    s_add_u32 s3, s30, 7168
    buffer_load_dword v7, v4, s[8:11], s3 offen sc1
    s_waitcnt vmcnt(0)
    v_xor_b32 v6, s50, v6
    v_xor_b32 v7, s50, v7
    v_or_b32 v6, v6, v7
    v_cmp_ne_u32 vcc, 0, v6
    s_sub_u32 s29, s29, 1
    s_cbranch_scc1 L_k_go_103
    s_cbranch_vccz L_k_go_103
    s_sleep 16
    s_branch L_k_gp_102
L_k_go_103:
    v_mov_b32 v13, 1
    ds_write_b32 v12, v13
    s_waitcnt lgkmcnt(0)
    s_branch L_k_gd_105
L_k_gw_104:
    ds_read_b32 v13, v12
    s_waitcnt lgkmcnt(0)
    v_readfirstlane_b32 s3, v13
    s_cmp_eq_u32 s3, 1
    s_cbranch_scc1 L_k_gd_105
    s_sleep 16
    s_branch L_k_gw_104
L_k_gd_105:
    s_waitcnt vmcnt(0)
    s_lshl_b32 s28, s15, 8
    s_add_u32 s28, s28, s2
    v_mul_u32_u24 v5, 12288, v3
    s_cmp_ge_u32 s28, 480
    s_cbranch_scc1 L_k_pko_106
    s_mov_b32 s40, s56
    s_mov_b32 s41, s57
    s_mov_b32 s42, 0x1e0000
    s_mov_b32 s43, 0x20000
    s_mul_i32 s16, s28, 104858
    s_lshr_b32 s16, s16, 20
    s_mul_i32 s3, s16, 10
    s_sub_u32 s17, s28, s3
    s_mul_i32 s18, s16, 174763
    s_lshr_b32 s18, s18, 20
    s_mul_i32 s3, s18, 6
    s_sub_u32 s19, s16, s3
    s_mul_i32 s6, s18, 96
    s_lshl_b32 s7, s19, 5
    s_add_u32 s6, s6, s7
    s_cmp_lt_u32 s19, 3
    s_cselect_b32 s7, 864, 0
    s_add_u32 s6, s6, s7
    s_sub_u32 s6, s6, 96
    v_add_lshl_u32 v4, v2, s6, 1
    v_add_u32 v4, v4, v5
    s_mul_i32 s22, s17, 196608
    s_add_u32 s7, s22, 0
    buffer_load_ushort v8, v4, s[40:43], s7 offen
    s_add_u32 s7, s22, 3072
    buffer_load_ushort v24, v4, s[40:43], s7 offen
    s_add_u32 s7, s22, 6144
    buffer_load_ushort v9, v4, s[40:43], s7 offen
    s_add_u32 s7, s22, 9216
    buffer_load_ushort v25, v4, s[40:43], s7 offen
    s_add_u32 s7, s22, 24576
    buffer_load_ushort v10, v4, s[40:43], s7 offen
    s_add_u32 s7, s22, 27648
    buffer_load_ushort v26, v4, s[40:43], s7 offen
    s_add_u32 s7, s22, 30720
    buffer_load_ushort v11, v4, s[40:43], s7 offen
    s_add_u32 s7, s22, 33792
    buffer_load_ushort v27, v4, s[40:43], s7 offen
    s_add_u32 s7, s22, 49152
    buffer_load_ushort v12, v4, s[40:43], s7 offen
    s_add_u32 s7, s22, 52224
    buffer_load_ushort v28, v4, s[40:43], s7 offen
    s_add_u32 s7, s22, 55296
    buffer_load_ushort v13, v4, s[40:43], s7 offen
    s_add_u32 s7, s22, 58368
    buffer_load_ushort v29, v4, s[40:43], s7 offen
    s_add_u32 s7, s22, 73728
    buffer_load_ushort v14, v4, s[40:43], s7 offen
    s_add_u32 s7, s22, 76800
    buffer_load_ushort v30, v4, s[40:43], s7 offen
    s_add_u32 s7, s22, 79872
    buffer_load_ushort v15, v4, s[40:43], s7 offen
    s_add_u32 s7, s22, 82944
    buffer_load_ushort v31, v4, s[40:43], s7 offen
    s_add_u32 s7, s22, 98304
    buffer_load_ushort v16, v4, s[40:43], s7 offen
    s_add_u32 s7, s22, 101376
    buffer_load_ushort v32, v4, s[40:43], s7 offen
    s_add_u32 s7, s22, 104448
    buffer_load_ushort v17, v4, s[40:43], s7 offen
    s_add_u32 s7, s22, 107520
    buffer_load_ushort v33, v4, s[40:43], s7 offen
    s_add_u32 s7, s22, 122880
    buffer_load_ushort v18, v4, s[40:43], s7 offen
    s_add_u32 s7, s22, 125952
    buffer_load_ushort v34, v4, s[40:43], s7 offen
    s_add_u32 s7, s22, 129024
    buffer_load_ushort v19, v4, s[40:43], s7 offen
    s_add_u32 s7, s22, 132096
    buffer_load_ushort v35, v4, s[40:43], s7 offen
    s_add_u32 s7, s22, 147456
    buffer_load_ushort v20, v4, s[40:43], s7 offen
    s_add_u32 s7, s22, 150528
    buffer_load_ushort v36, v4, s[40:43], s7 offen
    s_add_u32 s7, s22, 153600
    buffer_load_ushort v21, v4, s[40:43], s7 offen
    s_add_u32 s7, s22, 156672
    buffer_load_ushort v37, v4, s[40:43], s7 offen
    s_add_u32 s7, s22, 172032
    buffer_load_ushort v22, v4, s[40:43], s7 offen
    s_add_u32 s7, s22, 175104
    buffer_load_ushort v38, v4, s[40:43], s7 offen
    s_add_u32 s7, s22, 178176
    buffer_load_ushort v23, v4, s[40:43], s7 offen
    s_add_u32 s7, s22, 181248
    buffer_load_ushort v39, v4, s[40:43], s7 offen
    v_lshlrev_b32 v6, 4, v3
    s_lshl_b32 s7, s17, 8
    s_add_u32 s7, s7, 7680
    buffer_load_dwordx4 v[40:43], v6, s[8:11], s7 offen offset:0 sc1
    buffer_load_dwordx4 v[44:47], v6, s[8:11], s7 offen offset:32 sc1
    buffer_load_dwordx4 v[48:51], v6, s[8:11], s7 offen offset:2560 sc1
    buffer_load_dwordx4 v[52:55], v6, s[8:11], s7 offen offset:2592 sc1
    buffer_load_dwordx4 v[56:59], v6, s[8:11], s7 offen offset:64 sc1
    buffer_load_dwordx4 v[60:63], v6, s[8:11], s7 offen offset:96 sc1
    buffer_load_dwordx4 v[64:67], v6, s[8:11], s7 offen offset:2624 sc1
    buffer_load_dwordx4 v[68:71], v6, s[8:11], s7 offen offset:2656 sc1
    buffer_load_dwordx4 v[72:75], v6, s[8:11], s7 offen offset:128 sc1
    buffer_load_dwordx4 v[76:79], v6, s[8:11], s7 offen offset:160 sc1
    buffer_load_dwordx4 v[80:83], v6, s[8:11], s7 offen offset:2688 sc1
    buffer_load_dwordx4 v[84:87], v6, s[8:11], s7 offen offset:2720 sc1
    buffer_load_dwordx4 v[88:91], v6, s[8:11], s7 offen offset:192 sc1
    buffer_load_dwordx4 v[92:95], v6, s[8:11], s7 offen offset:224 sc1
    buffer_load_dwordx4 v[96:99], v6, s[8:11], s7 offen offset:2752 sc1
    buffer_load_dwordx4 v[100:103], v6, s[8:11], s7 offen offset:2784 sc1
    v_mov_b32 v6, 0
    v_mov_b32 v7, 0
    s_mul_i32 s22, s18, 40
    s_lshl_b32 s7, s17, 2
    s_add_u32 s22, s22, s7
    s_mul_i32 s22, s22, 6
    s_add_u32 s22, s22, s19
    s_lshl_b32 s22, s22, 10
    s_add_u32 s22, s22, 0x600000
    s_waitcnt vmcnt(0)
    v_lshlrev_b32 v8, 16, v8
    v_lshlrev_b32 v24, 16, v24
    v_fmac_f32 v7, v8, v40
    v_fmac_f32 v7, v24, v41
    v_mul_f32 v8, v8, v48
    v_mul_f32 v24, v24, v49
    v_cvt_pk_bf16_f32 v8, v8, v24
    v_lshlrev_b32 v24, 16, v8
    v_and_b32 v5, 0xffff0000, v8
    v_add_f32 v6, v6, v24
    v_add_f32 v6, v6, v5
    v_lshlrev_b32 v9, 16, v9
    v_lshlrev_b32 v25, 16, v25
    v_fmac_f32 v7, v9, v42
    v_fmac_f32 v7, v25, v43
    v_mul_f32 v9, v9, v50
    v_mul_f32 v25, v25, v51
    v_cvt_pk_bf16_f32 v9, v9, v25
    v_lshlrev_b32 v25, 16, v9
    v_and_b32 v5, 0xffff0000, v9
    v_add_f32 v6, v6, v25
    v_add_f32 v6, v6, v5
    v_lshlrev_b32 v10, 16, v10
    v_lshlrev_b32 v26, 16, v26
    v_fmac_f32 v7, v10, v44
    v_fmac_f32 v7, v26, v45
    v_mul_f32 v10, v10, v52
    v_mul_f32 v26, v26, v53
    v_cvt_pk_bf16_f32 v10, v10, v26
    v_lshlrev_b32 v26, 16, v10
    v_and_b32 v5, 0xffff0000, v10
    v_add_f32 v6, v6, v26
    v_add_f32 v6, v6, v5
    v_lshlrev_b32 v11, 16, v11
    v_lshlrev_b32 v27, 16, v27
    v_fmac_f32 v7, v11, v46
    v_fmac_f32 v7, v27, v47
    v_mul_f32 v11, v11, v54
    v_mul_f32 v27, v27, v55
    v_cvt_pk_bf16_f32 v11, v11, v27
    v_lshlrev_b32 v27, 16, v11
    v_and_b32 v5, 0xffff0000, v11
    v_add_f32 v6, v6, v27
    v_add_f32 v6, v6, v5
    buffer_store_dwordx4 v[8:11], v1, s[8:11], s22 offen sc1
    s_add_u32 s22, s22, 6144
    v_lshlrev_b32 v12, 16, v12
    v_lshlrev_b32 v28, 16, v28
    v_fmac_f32 v7, v12, v56
    v_fmac_f32 v7, v28, v57
    v_mul_f32 v12, v12, v64
    v_mul_f32 v28, v28, v65
    v_cvt_pk_bf16_f32 v12, v12, v28
    v_lshlrev_b32 v28, 16, v12
    v_and_b32 v5, 0xffff0000, v12
    v_add_f32 v6, v6, v28
    v_add_f32 v6, v6, v5
    v_lshlrev_b32 v13, 16, v13
    v_lshlrev_b32 v29, 16, v29
    v_fmac_f32 v7, v13, v58
    v_fmac_f32 v7, v29, v59
    v_mul_f32 v13, v13, v66
    v_mul_f32 v29, v29, v67
    v_cvt_pk_bf16_f32 v13, v13, v29
    v_lshlrev_b32 v29, 16, v13
    v_and_b32 v5, 0xffff0000, v13
    v_add_f32 v6, v6, v29
    v_add_f32 v6, v6, v5
    v_lshlrev_b32 v14, 16, v14
    v_lshlrev_b32 v30, 16, v30
    v_fmac_f32 v7, v14, v60
    v_fmac_f32 v7, v30, v61
    v_mul_f32 v14, v14, v68
    v_mul_f32 v30, v30, v69
    v_cvt_pk_bf16_f32 v14, v14, v30
    v_lshlrev_b32 v30, 16, v14
    v_and_b32 v5, 0xffff0000, v14
    v_add_f32 v6, v6, v30
    v_add_f32 v6, v6, v5
    v_lshlrev_b32 v15, 16, v15
    v_lshlrev_b32 v31, 16, v31
    v_fmac_f32 v7, v15, v62
    v_fmac_f32 v7, v31, v63
    v_mul_f32 v15, v15, v70
    v_mul_f32 v31, v31, v71
    v_cvt_pk_bf16_f32 v15, v15, v31
    v_lshlrev_b32 v31, 16, v15
    v_and_b32 v5, 0xffff0000, v15
    v_add_f32 v6, v6, v31
    v_add_f32 v6, v6, v5
    buffer_store_dwordx4 v[12:15], v1, s[8:11], s22 offen sc1
    s_add_u32 s22, s22, 6144
    v_lshlrev_b32 v16, 16, v16
    v_lshlrev_b32 v32, 16, v32
    v_fmac_f32 v7, v16, v72
    v_fmac_f32 v7, v32, v73
    v_mul_f32 v16, v16, v80
    v_mul_f32 v32, v32, v81
    v_cvt_pk_bf16_f32 v16, v16, v32
    v_lshlrev_b32 v32, 16, v16
    v_and_b32 v5, 0xffff0000, v16
    v_add_f32 v6, v6, v32
    v_add_f32 v6, v6, v5
    v_lshlrev_b32 v17, 16, v17
    v_lshlrev_b32 v33, 16, v33
    v_fmac_f32 v7, v17, v74
    v_fmac_f32 v7, v33, v75
    v_mul_f32 v17, v17, v82
    v_mul_f32 v33, v33, v83
    v_cvt_pk_bf16_f32 v17, v17, v33
    v_lshlrev_b32 v33, 16, v17
    v_and_b32 v5, 0xffff0000, v17
    v_add_f32 v6, v6, v33
    v_add_f32 v6, v6, v5
    v_lshlrev_b32 v18, 16, v18
    v_lshlrev_b32 v34, 16, v34
    v_fmac_f32 v7, v18, v76
    v_fmac_f32 v7, v34, v77
    v_mul_f32 v18, v18, v84
    v_mul_f32 v34, v34, v85
    v_cvt_pk_bf16_f32 v18, v18, v34
    v_lshlrev_b32 v34, 16, v18
    v_and_b32 v5, 0xffff0000, v18
    v_add_f32 v6, v6, v34
    v_add_f32 v6, v6, v5
    v_lshlrev_b32 v19, 16, v19
    v_lshlrev_b32 v35, 16, v35
    v_fmac_f32 v7, v19, v78
    v_fmac_f32 v7, v35, v79
    v_mul_f32 v19, v19, v86
    v_mul_f32 v35, v35, v87
    v_cvt_pk_bf16_f32 v19, v19, v35
    v_lshlrev_b32 v35, 16, v19
    v_and_b32 v5, 0xffff0000, v19
    v_add_f32 v6, v6, v35
    v_add_f32 v6, v6, v5
    buffer_store_dwordx4 v[16:19], v1, s[8:11], s22 offen sc1
    s_add_u32 s22, s22, 6144
    v_lshlrev_b32 v20, 16, v20
    v_lshlrev_b32 v36, 16, v36
    v_fmac_f32 v7, v20, v88
    v_fmac_f32 v7, v36, v89
    v_mul_f32 v20, v20, v96
    v_mul_f32 v36, v36, v97
    v_cvt_pk_bf16_f32 v20, v20, v36
    v_lshlrev_b32 v36, 16, v20
    v_and_b32 v5, 0xffff0000, v20
    v_add_f32 v6, v6, v36
    v_add_f32 v6, v6, v5
    v_lshlrev_b32 v21, 16, v21
    v_lshlrev_b32 v37, 16, v37
    v_fmac_f32 v7, v21, v90
    v_fmac_f32 v7, v37, v91
    v_mul_f32 v21, v21, v98
    v_mul_f32 v37, v37, v99
    v_cvt_pk_bf16_f32 v21, v21, v37
    v_lshlrev_b32 v37, 16, v21
    v_and_b32 v5, 0xffff0000, v21
    v_add_f32 v6, v6, v37
    v_add_f32 v6, v6, v5
    v_lshlrev_b32 v22, 16, v22
    v_lshlrev_b32 v38, 16, v38
    v_fmac_f32 v7, v22, v92
    v_fmac_f32 v7, v38, v93
    v_mul_f32 v22, v22, v100
    v_mul_f32 v38, v38, v101
    v_cvt_pk_bf16_f32 v22, v22, v38
    v_lshlrev_b32 v38, 16, v22
    v_and_b32 v5, 0xffff0000, v22
    v_add_f32 v6, v6, v38
    v_add_f32 v6, v6, v5
    v_lshlrev_b32 v23, 16, v23
    v_lshlrev_b32 v39, 16, v39
    v_fmac_f32 v7, v23, v94
    v_fmac_f32 v7, v39, v95
    v_mul_f32 v23, v23, v102
    v_mul_f32 v39, v39, v103
    v_cvt_pk_bf16_f32 v23, v23, v39
    v_lshlrev_b32 v39, 16, v23
    v_and_b32 v5, 0xffff0000, v23
    v_add_f32 v6, v6, v39
    v_add_f32 v6, v6, v5
    buffer_store_dwordx4 v[20:23], v1, s[8:11], s22 offen sc1
    s_add_u32 s22, s22, 6144
    v_mov_b32 v40, v6
    v_mov_b32 v41, v7
    s_nop 1
    v_permlane32_swap_b32 v6, v40
    v_permlane32_swap_b32 v7, v41
    s_nop 1
    v_add_f32 v6, v6, v40
    v_add_f32 v7, v7, v41
    s_mul_i32 s22, s17, 12288
    s_lshl_b32 s7, s16, 8
    s_add_u32 s22, s22, s7
    s_add_u32 s22, s22, 0x20000
    v_lshlrev_b32 v4, 3, v2
    s_mov_b32 exec_hi, 0
    buffer_store_dwordx2 v[6:7], v4, s[8:11], s22 offen sc1
    s_mov_b32 exec_hi, -1
    s_branch L_k_pkd_107
L_k_pko_106:
    s_sub_u32 s28, s28, 480
    s_cmp_ge_u32 s28, 528
    s_cbranch_scc1 L_k_pkd_107
    s_mov_b32 s42, 983040
    s_mov_b32 s31, 0x800000
    s_mov_b32 s6, 87382
    s_cmp_lt_u32 s28, 240
    s_cselect_b32 s40, s52, s54
    s_cselect_b32 s41, s53, s55
    s_mov_b32 s43, 0x20000
    s_cselect_b32 s30, 40, 48
    s_cmov_b32 s42, 819200
    s_cmov_b32 s31, 0x500000
    s_cmov_b32 s6, 104858
    s_cselect_b32 s7, 0, 240
    s_sub_u32 s28, s28, s7
    s_mul_i32 s16, s28, s6
    s_lshr_b32 s16, s16, 20
    s_lshr_b32 s7, s30, 2
    s_mul_i32 s7, s7, s16
    s_sub_u32 s17, s28, s7
    s_mul_i32 s18, s16, 349526
    s_lshr_b32 s18, s18, 20
    s_mul_i32 s3, s18, 3
    s_sub_u32 s19, s16, s3
    s_mul_i32 s6, s18, 80
    s_lshl_b32 s7, s19, 5
    s_add_u32 s6, s6, s7
    v_add_lshl_u32 v4, v2, s6, 1
    v_mul_u32_u24 v5, 5120, v3
    v_add_u32 v4, v4, v5
    s_mul_i32 s22, s17, 81920
    s_add_u32 s7, s22, 0
    buffer_load_ushort v8, v4, s[40:43], s7 offen
    s_add_u32 s7, s22, 1280
    buffer_load_ushort v24, v4, s[40:43], s7 offen
    s_add_u32 s7, s22, 2560
    buffer_load_ushort v9, v4, s[40:43], s7 offen
    s_add_u32 s7, s22, 3840
    buffer_load_ushort v25, v4, s[40:43], s7 offen
    s_add_u32 s7, s22, 10240
    buffer_load_ushort v10, v4, s[40:43], s7 offen
    s_add_u32 s7, s22, 11520
    buffer_load_ushort v26, v4, s[40:43], s7 offen
    s_add_u32 s7, s22, 12800
    buffer_load_ushort v11, v4, s[40:43], s7 offen
    s_add_u32 s7, s22, 14080
    buffer_load_ushort v27, v4, s[40:43], s7 offen
    s_add_u32 s7, s22, 20480
    buffer_load_ushort v12, v4, s[40:43], s7 offen
    s_add_u32 s7, s22, 21760
    buffer_load_ushort v28, v4, s[40:43], s7 offen
    s_add_u32 s7, s22, 23040
    buffer_load_ushort v13, v4, s[40:43], s7 offen
    s_add_u32 s7, s22, 24320
    buffer_load_ushort v29, v4, s[40:43], s7 offen
    s_add_u32 s7, s22, 30720
    buffer_load_ushort v14, v4, s[40:43], s7 offen
    s_add_u32 s7, s22, 32000
    buffer_load_ushort v30, v4, s[40:43], s7 offen
    s_add_u32 s7, s22, 33280
    buffer_load_ushort v15, v4, s[40:43], s7 offen
    s_add_u32 s7, s22, 34560
    buffer_load_ushort v31, v4, s[40:43], s7 offen
    s_add_u32 s7, s22, 40960
    buffer_load_ushort v16, v4, s[40:43], s7 offen
    s_add_u32 s7, s22, 42240
    buffer_load_ushort v32, v4, s[40:43], s7 offen
    s_add_u32 s7, s22, 43520
    buffer_load_ushort v17, v4, s[40:43], s7 offen
    s_add_u32 s7, s22, 44800
    buffer_load_ushort v33, v4, s[40:43], s7 offen
    s_add_u32 s7, s22, 51200
    buffer_load_ushort v18, v4, s[40:43], s7 offen
    s_add_u32 s7, s22, 52480
    buffer_load_ushort v34, v4, s[40:43], s7 offen
    s_add_u32 s7, s22, 53760
    buffer_load_ushort v19, v4, s[40:43], s7 offen
    s_add_u32 s7, s22, 55040
    buffer_load_ushort v35, v4, s[40:43], s7 offen
    s_add_u32 s7, s22, 61440
    buffer_load_ushort v20, v4, s[40:43], s7 offen
    s_add_u32 s7, s22, 62720
    buffer_load_ushort v36, v4, s[40:43], s7 offen
    s_add_u32 s7, s22, 64000
    buffer_load_ushort v21, v4, s[40:43], s7 offen
    s_add_u32 s7, s22, 65280
    buffer_load_ushort v37, v4, s[40:43], s7 offen
    s_add_u32 s7, s22, 71680
    buffer_load_ushort v22, v4, s[40:43], s7 offen
    s_add_u32 s7, s22, 72960
    buffer_load_ushort v38, v4, s[40:43], s7 offen
    s_add_u32 s7, s22, 74240
    buffer_load_ushort v23, v4, s[40:43], s7 offen
    s_add_u32 s7, s22, 75520
    buffer_load_ushort v39, v4, s[40:43], s7 offen
    s_mul_i32 s22, s18, s30
    s_lshl_b32 s7, s17, 2
    s_add_u32 s22, s22, s7
    s_mul_i32 s22, s22, 2560
    s_lshl_b32 s7, s19, 10
    s_add_u32 s22, s22, s7
    s_add_u32 s22, s22, s31
    v_mov_b32 v4, v1
    s_cmp_lg_u32 s19, 2
    s_cbranch_scc1 L_k_half_108
    v_and_b32 v4, 0xf0, v1
    v_lshl_add_u32 v4, v3, 8, v4
    s_mov_b32 exec_lo, 0xffff
    s_mov_b32 exec_hi, 0xffff
L_k_half_108:
    s_waitcnt vmcnt(0)
    v_lshl_or_b32 v8, v24, 16, v8
    v_lshl_or_b32 v9, v25, 16, v9
    v_lshl_or_b32 v10, v26, 16, v10
    v_lshl_or_b32 v11, v27, 16, v11
    buffer_store_dwordx4 v[8:11], v4, s[8:11], s22 offen sc1
    s_add_u32 s22, s22, 2560
    v_lshl_or_b32 v12, v28, 16, v12
    v_lshl_or_b32 v13, v29, 16, v13
    v_lshl_or_b32 v14, v30, 16, v14
    v_lshl_or_b32 v15, v31, 16, v15
    buffer_store_dwordx4 v[12:15], v4, s[8:11], s22 offen sc1
    s_add_u32 s22, s22, 2560
    v_lshl_or_b32 v16, v32, 16, v16
    v_lshl_or_b32 v17, v33, 16, v17
    v_lshl_or_b32 v18, v34, 16, v18
    v_lshl_or_b32 v19, v35, 16, v19
    buffer_store_dwordx4 v[16:19], v4, s[8:11], s22 offen sc1
    s_add_u32 s22, s22, 2560
    v_lshl_or_b32 v20, v36, 16, v20
    v_lshl_or_b32 v21, v37, 16, v21
    v_lshl_or_b32 v22, v38, 16, v22
    v_lshl_or_b32 v23, v39, 16, v23
    buffer_store_dwordx4 v[20:23], v4, s[8:11], s22 offen sc1
    s_add_u32 s22, s22, 2560
    s_mov_b64 exec, -1
L_k_pkd_107:
    s_lshl_b32 s6, s15, 8
    s_add_u32 s6, s6, s2
    s_lshl_b32 s6, s6, 7
    s_add_u32 s6, s6, 0x54000
    v_mov_b32 v8, 0
    v_mov_b32 v9, s50
    s_mov_b64 exec, 1
    s_waitcnt vmcnt(0)
    buffer_store_dword v9, v8, s[8:11], s6 offen sc1
    s_mov_b64 exec, -1
L_k_noside_101:
    s_cmp_eq_u32 s27, 1
    s_cbranch_scc1 L_k_ra
    s_mul_i32 s30, s13, 7680
    s_add_u32 s30, s30, 0x54000
    s_mul_i32 s31, s13, 3840
    s_add_u32 s31, s31, 0x63000
    v_lshrrev_b32 v4, 4, v1
    v_min_u32 v5, 29, v4
    v_min_u32 v4, 59, v4
    v_lshlrev_b32 v4, 7, v4
    v_lshlrev_b32 v5, 7, v5
    v_mov_b32 v12, 159792
    s_cmp_lg_u32 s15, 0
    s_cbranch_scc1 L_k_gw_111
    s_mov_b32 s29, 0x8000
L_k_gp_109:
    buffer_load_dword v6, v4, s[8:11], s30 offen sc1
    buffer_load_dword v7, v5, s[8:11], s31 offen sc1
    s_waitcnt vmcnt(0)
    v_xor_b32 v6, s50, v6
    v_xor_b32 v7, s50, v7
    v_or_b32 v6, v6, v7
    v_cmp_ne_u32 vcc, 0, v6
    s_sub_u32 s29, s29, 1
    s_cbranch_scc1 L_k_go_110
    s_cbranch_vccz L_k_go_110
    s_sleep 8
    s_branch L_k_gp_109
L_k_go_110:
    v_mov_b32 v13, 1
    ds_write_b32 v12, v13
    s_waitcnt lgkmcnt(0)
    s_branch L_k_gd_112
L_k_gw_111:
    ds_read_b32 v13, v12
    s_waitcnt lgkmcnt(0)
    v_readfirstlane_b32 s3, v13
    s_cmp_eq_u32 s3, 1
    s_cbranch_scc1 L_k_gd_112
    s_sleep 8
    s_branch L_k_gw_111
L_k_gd_112:
    s_waitcnt vmcnt(0)
L_k_ra:
    s_mul_i32 s20, s15, 3072
    s_lshl_b32 s16, s12, 1
    s_lshr_b32 s3, s15, 1
    s_add_u32 s16, s16, s3
    s_mul_i32 s21, s15, 2048
    s_add_u32 s21, s21, 12288
    s_mul_i32 s18, s16, 40960
    s_and_b32 s3, s15, 1
    s_mul_i32 s3, s3, 2048
    s_add_u32 s18, s18, s3
    s_add_u32 s18, s18, 0xe00000
    s_mul_i32 s3, s12, 81920
    s_add_u32 s18, s18, s3
    s_mul_i32 s19, s13, 122880
    s_add_u32 s19, s19, s20
    s_add_u32 s19, s19, 0x500000
    s_mul_i32 s19, s13, 102400
    s_lshl_b32 s3, s15, 10
    s_add_u32 s19, s19, s3
    s_add_u32 s19, s19, 0x500000
    s_mul_i32 s26, s15, 1024
    s_add_u32 s26, s26, 12288
    s_mul_i32 s22, s16, 40960
    s_and_b32 s3, s15, 1
    s_mul_i32 s3, s3, 1024
    s_add_u32 s22, s22, s3
    s_add_u32 s22, s22, 0xe14000
    s_mul_i32 s3, s12, 81920
    s_add_u32 s22, s22, s3
    s_mul_i32 s23, s13, 245760
    s_add_u32 s23, s23, s20
    s_add_u32 s23, s23, 0x600000
    s_mul_i32 s3, s13, 5
    s_add_u32 s3, s3, 3
    s_lshr_b32 s3, s3, 2
    s_cmp_ge_u32 s3, 10
    s_cselect_b32 s3, 0, s3
    s_sub_u32 s32, 10, s3
    s_mov_b32 s33, s32
    s_mul_i32 s6, s3, 4096
    s_add_u32 s18, s18, s6
    s_mul_i32 s6, s3, 10240
    s_add_u32 s19, s19, s6
    s_mul_i32 s34, s3, 52432
    s_lshr_b32 s34, s34, 16
    s_and_b32 s3, s12, 7
    s_mul_i32 s3, s3, 5
    s_lshr_b32 s3, s3, 1
    s_sub_u32 s35, 20, s3
    s_mov_b32 s36, s35
    s_mul_i32 s6, s3, 2048
    s_add_u32 s22, s22, s6
    s_mul_i32 s6, s3, 12288
    s_add_u32 s23, s23, s6
    v_mov_b32 v6, 159776
L_k_w6_113:
    ds_read_b32 v11, v6
    s_waitcnt lgkmcnt(0)
    v_readfirstlane_b32 s3, v11
    s_cmp_ge_u32 s3, 8
    s_cbranch_scc1 L_k_w6_113x
    s_sleep 16
    s_branch L_k_w6_113
L_k_w6_113x:
    s_mul_i32 s6, s13, 320
    s_add_u32 s6, s6, 5120
    s_mov_b32 m0, 122880
    s_nop 0
    buffer_load_dwordx4 v1, s[8:11], s6 offen offset:0 sc1 lds
    s_add_u32 s6, s6, 7680
    s_mov_b32 m0, 125952
    s_nop 0
    buffer_load_dwordx4 v1, s[8:11], s6 offen offset:0 sc1 lds
    s_mul_i32 s6, s13, 1536
    s_lshl_b32 s7, s15, 9
    s_add_u32 s6, s6, s7
    s_add_u32 s6, s6, 0x20000
    v_lshrrev_b32 v10, 1, v1
    buffer_load_dwordx2 v[12:13], v10, s[8:11], s6 offen
    s_add_u32 s6, s6, 12288
    buffer_load_dwordx2 v[14:15], v10, s[8:11], s6 offen
    s_add_u32 s6, s6, 12288
    buffer_load_dwordx2 v[16:17], v10, s[8:11], s6 offen
    s_add_u32 s6, s6, 12288
    buffer_load_dwordx2 v[18:19], v10, s[8:11], s6 offen
    s_add_u32 s6, s6, 12288
    buffer_load_dwordx2 v[20:21], v10, s[8:11], s6 offen
    s_add_u32 s6, s6, 12288
    buffer_load_dwordx2 v[22:23], v10, s[8:11], s6 offen
    s_add_u32 s6, s6, 12288
    buffer_load_dwordx2 v[24:25], v10, s[8:11], s6 offen
    s_add_u32 s6, s6, 12288
    buffer_load_dwordx2 v[26:27], v10, s[8:11], s6 offen
    s_add_u32 s6, s6, 12288
    buffer_load_dwordx2 v[28:29], v10, s[8:11], s6 offen
    s_add_u32 s6, s6, 12288
    buffer_load_dwordx2 v[30:31], v10, s[8:11], s6 offen
    s_add_u32 s6, s6, 12288
    s_mov_b32 s40, s60
    s_mov_b32 s41, s61
    s_mov_b32 s42, 0x280000
    s_mov_b32 s43, 0x20000
    s_mul_i32 s6, s12, 81920
    s_mul_i32 s7, s13, 160
    s_add_u32 s6, s6, s7
    s_mul_i32 s7, s15, 192
    v_lshrrev_b32 v32, 4, v1
    v_add_u32 v32, s7, v32
    s_mul_i32 s7, s15, 3072
    s_add_u32 m0, s7, 126976
    v_mov_b32 v36, 0x40000000
    v_mul_u32_u24 v33, 6554, v32
    v_lshrrev_b32 v33, 16, v33
    v_mul_u32_u24 v34, 10, v33
    v_sub_u32 v34, v32, v34
    v_mul_u32_u24 v33, 1280, v33
    v_lshl_add_u32 v33, v34, 4, v33
    v_cmp_gt_u32 vcc, 0x280, v32
    v_add_u32 v32, 64, v32
    s_nop 0
    v_cndmask_b32 v33, v36, v33, vcc
    buffer_load_dwordx4 v33, s[40:43], s6 offen lds
    s_add_u32 m0, m0, 1024
    v_mul_u32_u24 v33, 6554, v32
    v_lshrrev_b32 v33, 16, v33
    v_mul_u32_u24 v34, 10, v33
    v_sub_u32 v34, v32, v34
    v_mul_u32_u24 v33, 1280, v33
    v_lshl_add_u32 v33, v34, 4, v33
    v_cmp_gt_u32 vcc, 0x280, v32
    v_add_u32 v32, 64, v32
    s_nop 0
    v_cndmask_b32 v33, v36, v33, vcc
    buffer_load_dwordx4 v33, s[40:43], s6 offen lds
    s_add_u32 m0, m0, 1024
    v_mul_u32_u24 v33, 6554, v32
    v_lshrrev_b32 v33, 16, v33
    v_mul_u32_u24 v34, 10, v33
    v_sub_u32 v34, v32, v34
    v_mul_u32_u24 v33, 1280, v33
    v_lshl_add_u32 v33, v34, 4, v33
    v_cmp_gt_u32 vcc, 0x280, v32
    v_add_u32 v32, 64, v32
    s_nop 0
    v_cndmask_b32 v33, v36, v33, vcc
    buffer_load_dwordx4 v33, s[40:43], s6 offen lds
    s_add_u32 m0, m0, 1024
    s_lshl_b32 s7, s15, 10
    s_cmp_ge_u32 s15, 2
    s_cbranch_scc1 L_k_cw_114
    s_add_u32 m0, s7, 69632
    s_add_u32 s3, s19, 8192
    buffer_load_dwordx4 v1, s[8:11], s3 offen lds
L_k_cw_114:
    s_add_u32 m0, s7, 61440
    s_add_u32 s3, s19, 4096
    buffer_load_dwordx4 v1, s[8:11], s19 offen lds
    s_add_u32 m0, s7, 65536
    s_add_u32 s19, s19, 10240
    buffer_load_dwordx4 v1, s[8:11], s3 offen lds
    s_sub_u32 s33, s33, 1
    s_cmp_eq_u32 s33, 0
    s_cselect_b32 s3, 102400, 0
    s_sub_u32 s19, s19, s3
    s_lshl_b32 s7, s15, 10
    s_cmp_ge_u32 s15, 2
    s_cbranch_scc1 L_k_cw_115
    s_add_u32 m0, s7, 90112
    s_add_u32 s3, s19, 8192
    buffer_load_dwordx4 v1, s[8:11], s3 offen lds
L_k_cw_115:
    s_add_u32 m0, s7, 81920
    s_add_u32 s3, s19, 4096
    buffer_load_dwordx4 v1, s[8:11], s19 offen lds
    s_add_u32 m0, s7, 86016
    s_add_u32 s19, s19, 10240
    buffer_load_dwordx4 v1, s[8:11], s3 offen lds
    s_sub_u32 s33, s33, 1
    s_cmp_eq_u32 s33, 0
    s_cselect_b32 s3, 102400, 0
    s_sub_u32 s19, s19, s3
    s_lshl_b32 s7, s15, 10
    s_cmp_ge_u32 s15, 2
    s_cbranch_scc1 L_k_cw_116
    s_add_u32 m0, s7, 110592
    s_add_u32 s3, s19, 8192
    buffer_load_dwordx4 v1, s[8:11], s3 offen lds
L_k_cw_116:
    s_add_u32 m0, s7, 102400
    s_add_u32 s3, s19, 4096
    buffer_load_dwordx4 v1, s[8:11], s19 offen lds
    s_add_u32 m0, s7, 106496
    s_add_u32 s19, s19, 10240
    buffer_load_dwordx4 v1, s[8:11], s3 offen lds
    s_sub_u32 s33, s33, 1
    s_cmp_eq_u32 s33, 0
    s_cselect_b32 s3, 102400, 0
    s_sub_u32 s19, s19, s3
    s_waitcnt vmcnt(9)
    s_cmp_eq_u32 s15, 3
    s_cbranch_scc1 L_k_nou_117
    v_add_f32 v12, v12, v14
    v_add_f32 v13, v13, v15
    v_add_f32 v12, v12, v16
    v_add_f32 v13, v13, v17
    v_add_f32 v12, v12, v18
    v_add_f32 v13, v13, v19
    v_add_f32 v12, v12, v20
    v_add_f32 v13, v13, v21
    v_add_f32 v12, v12, v22
    v_add_f32 v13, v13, v23
    v_add_f32 v12, v12, v24
    v_add_f32 v13, v13, v25
    v_add_f32 v12, v12, v26
    v_add_f32 v13, v13, v27
    v_add_f32 v12, v12, v28
    v_add_f32 v13, v13, v29
    v_add_f32 v12, v12, v30
    v_add_f32 v13, v13, v31
    s_lshl_b32 s7, s15, 9
    s_add_u32 s7, s7, 123904
    v_add_u32 v10, s7, v10
    ds_write_b64 v10, v[12:13]
    s_waitcnt lgkmcnt(0)
L_k_nou_117:
    s_cmp_eq_u32 s27, 1
    s_cbranch_scc1 L_k_wend
L_k_vote2:
    s_barrier
    v_mov_b32 v44, 159744
    ds_read_b128 v[40:43], v44
    s_waitcnt lgkmcnt(0)
    v_or_b32 v40, v40, v41
    v_or_b32 v40, v40, v42
    v_or_b32 v40, v40, v43
    s_nop 0
    v_readfirstlane_b32 s3, v40
    s_cmp_eq_u32 s3, 0
    s_cbranch_scc1 L_k_la
    s_mov_b32 s27, 1
    s_waitcnt vmcnt(0)
    s_mov_b32 s24, 0
L_k_hmax:
    s_barrier
    s_add_u32 s3, s49, 0
    s_and_b32 s3, s3, 7
    s_mul_i32 s3, s3, 26624
    s_add_u32 s31, s46, s3
    s_add_u32 m0, s47, 0
    s_add_u32 s48, s31, 0
    buffer_load_dwordx4 v1, s[8:11], s48 offen sc1 lds
    s_add_u32 m0, s47, 4096
    s_add_u32 s48, s31, 4096
    buffer_load_dwordx4 v1, s[8:11], s48 offen sc1 lds
    s_add_u32 m0, s47, 8192
    s_add_u32 s48, s31, 8192
    buffer_load_dwordx4 v1, s[8:11], s48 offen sc1 lds
    s_add_u32 m0, s47, 12288
    s_add_u32 s48, s31, 12288
    buffer_load_dwordx4 v1, s[8:11], s48 offen sc1 lds
    s_add_u32 m0, s47, 16384
    s_add_u32 s48, s31, 16384
    buffer_load_dwordx4 v1, s[8:11], s48 offen sc1 lds
    s_add_u32 m0, s47, 20480
    s_add_u32 s48, s31, 20480
    buffer_load_dwordx4 v1, s[8:11], s48 offen sc1 lds
    s_cmp_ge_u32 s15, 2
    s_cbranch_scc1 L_k_d_118
    s_add_u32 m0, s47, 24576
    s_add_u32 s48, s31, 24576
    buffer_load_dwordx4 v1, s[8:11], s48 offen sc1 lds
L_k_d_118:
    s_add_u32 s49, s49, 1
    s_waitcnt vmcnt(0)
    s_barrier
    s_add_u32 s24, s24, 1
    s_cmp_lt_u32 s24, 8
    s_cbranch_scc1 L_k_hmax
    s_barrier
    s_branch L_k_hmain
L_k_wend:
    s_barrier
L_k_la:
    s_waitcnt vmcnt(0)
    v_lshrrev_b32 v8, 4, v1
    v_min_u32 v8, 31, v8
    s_mul_i32 s3, s34, 4
    v_add_u32 v8, s3, v8
    v_subrev_u32 v9, 32, v8
    v_min_u32 v8, v8, v9
    v_lshlrev_b32 v8, 2, v8
    s_lshl_b32 s28, s12, 8
    s_add_u32 s28, s28, 0x14020
    s_mov_b64 s[24:25], 0
    s_mov_b32 s30, 0xff
    s_mov_b32 s31, 0x0
    s_mov_b32 s29, 0x8000
L_k_gl_119:
    s_andn2_b64 vcc, s[30:31], s[24:25]
    s_cbranch_scc0 L_k_go_120
    s_sub_u32 s29, s29, 1
    s_cbranch_scc1 L_k_go_120
    buffer_load_dword v9, v8, s[8:11], s28 offen sc1
    s_waitcnt vmcnt(0)
    v_cmp_eq_u32 s[24:25], s50, v9
    s_nop 0
    s_branch L_k_gl_119
L_k_go_120:
    s_add_u32 m0, s21, 61440
    s_nop 0
    buffer_load_dwordx4 v1, s[8:11], s18 offen offset:0 sc1 lds
    buffer_load_dwordx4 v1, s[8:11], s18 offen offset:1024 sc1 lds
    s_add_u32 s18, s18, 4096
    s_sub_u32 s32, s32, 1
    s_cmp_eq_u32 s32, 0
    s_cselect_b32 s3, 40960, 0
    s_sub_u32 s18, s18, s3
    s_waitcnt vmcnt(0)
    s_barrier
    s_mov_b32 s30, 0xfff
    s_mov_b32 s31, 0x0
    s_mov_b32 s29, 0x8000
L_k_gl_121:
    s_andn2_b64 vcc, s[30:31], s[24:25]
    s_cbranch_scc0 L_k_go_122
    s_sub_u32 s29, s29, 1
    s_cbranch_scc1 L_k_go_122
    buffer_load_dword v9, v8, s[8:11], s28 offen sc1
    s_waitcnt vmcnt(0)
    v_cmp_eq_u32 s[24:25], s50, v9
    s_nop 0
    s_branch L_k_gl_121
L_k_go_122:
    s_add_u32 m0, s21, 81920
    s_nop 0
    buffer_load_dwordx4 v1, s[8:11], s18 offen offset:0 sc1 lds
    buffer_load_dwordx4 v1, s[8:11], s18 offen offset:1024 sc1 lds
    s_add_u32 s18, s18, 4096
    s_sub_u32 s32, s32, 1
    s_cmp_eq_u32 s32, 0
    s_cselect_b32 s3, 40960, 0
    s_sub_u32 s18, s18, s3
    s_mov_b32 s30, 0xffff
    s_mov_b32 s31, 0x0
    s_mov_b32 s29, 0x8000
L_k_gl_123:
    s_andn2_b64 vcc, s[30:31], s[24:25]
    s_cbranch_scc0 L_k_go_124
    s_sub_u32 s29, s29, 1
    s_cbranch_scc1 L_k_go_124
    buffer_load_dword v9, v8, s[8:11], s28 offen sc1
    s_waitcnt vmcnt(0)
    v_cmp_eq_u32 s[24:25], s50, v9
    s_nop 0
    s_branch L_k_gl_123
L_k_go_124:
    s_add_u32 m0, s21, 102400
    s_nop 0
    buffer_load_dwordx4 v1, s[8:11], s18 offen offset:0 sc1 lds
    buffer_load_dwordx4 v1, s[8:11], s18 offen offset:1024 sc1 lds
    s_add_u32 s18, s18, 4096
    s_sub_u32 s32, s32, 1
    s_cmp_eq_u32 s32, 0
    s_cselect_b32 s3, 40960, 0
    s_sub_u32 s18, s18, s3
    s_add_u32 m0, s21, 0
    s_nop 0
    buffer_load_dwordx4 v1, s[8:11], s18 offen offset:0 sc1 lds
    buffer_load_dwordx4 v1, s[8:11], s18 offen offset:1024 sc1 lds
    s_add_u32 s18, s18, 4096
    s_sub_u32 s32, s32, 1
    s_cmp_eq_u32 s32, 0
    s_cselect_b32 s3, 40960, 0
    s_sub_u32 s18, s18, s3
    s_lshl_b32 s7, s15, 10
    s_cmp_ge_u32 s15, 2
    s_cbranch_scc1 L_k_cw_125
    s_add_u32 m0, s7, 8192
    s_add_u32 s3, s19, 8192
    buffer_load_dwordx4 v1, s[8:11], s3 offen lds
L_k_cw_125:
    s_add_u32 m0, s7, 0
    s_add_u32 s3, s19, 4096
    buffer_load_dwordx4 v1, s[8:11], s19 offen lds
    s_add_u32 m0, s7, 4096
    s_add_u32 s19, s19, 10240
    buffer_load_dwordx4 v1, s[8:11], s3 offen lds
    s_sub_u32 s33, s33, 1
    s_cmp_eq_u32 s33, 0
    s_cselect_b32 s3, 102400, 0
    s_sub_u32 s19, s19, s3
    s_mov_b32 s30, 0xfffff
    s_mov_b32 s31, 0x0
    s_mov_b32 s29, 0x8000
L_k_gl_126:
    s_andn2_b64 vcc, s[30:31], s[24:25]
    s_cbranch_scc0 L_k_go_127
    s_sub_u32 s29, s29, 1
    s_cbranch_scc1 L_k_go_127
    buffer_load_dword v9, v8, s[8:11], s28 offen sc1
    s_waitcnt vmcnt(0)
    v_cmp_eq_u32 s[24:25], s50, v9
    s_nop 0
    s_branch L_k_gl_126
L_k_go_127:
    s_add_u32 m0, s21, 20480
    s_nop 0
    buffer_load_dwordx4 v1, s[8:11], s18 offen offset:0 sc1 lds
    buffer_load_dwordx4 v1, s[8:11], s18 offen offset:1024 sc1 lds
    s_add_u32 s18, s18, 4096
    s_sub_u32 s32, s32, 1
    s_cmp_eq_u32 s32, 0
    s_cselect_b32 s3, 40960, 0
    s_sub_u32 s18, s18, s3
    s_lshl_b32 s7, s15, 10
    s_cmp_ge_u32 s15, 2
    s_cbranch_scc1 L_k_cw_128
    s_add_u32 m0, s7, 28672
    s_add_u32 s3, s19, 8192
    buffer_load_dwordx4 v1, s[8:11], s3 offen lds
L_k_cw_128:
    s_add_u32 m0, s7, 20480
    s_add_u32 s3, s19, 4096
    buffer_load_dwordx4 v1, s[8:11], s19 offen lds
    s_add_u32 m0, s7, 24576
    s_add_u32 s19, s19, 10240
    buffer_load_dwordx4 v1, s[8:11], s3 offen lds
    s_sub_u32 s33, s33, 1
    s_cmp_eq_u32 s33, 0
    s_cselect_b32 s3, 102400, 0
    s_sub_u32 s19, s19, s3
    s_waitcnt vmcnt(10)
    s_barrier
    s_mov_b32 s30, 0xffffff
    s_mov_b32 s31, 0x0
    s_mov_b32 s29, 0x8000
L_k_gl_129:
    s_andn2_b64 vcc, s[30:31], s[24:25]
    s_cbranch_scc0 L_k_go_130
    s_sub_u32 s29, s29, 1
    s_cbranch_scc1 L_k_go_130
    buffer_load_dword v9, v8, s[8:11], s28 offen sc1
    s_waitcnt vmcnt(0)
    v_cmp_eq_u32 s[24:25], s50, v9
    s_nop 0
    s_branch L_k_gl_129
L_k_go_130:
    s_add_u32 m0, s21, 40960
    s_nop 0
    buffer_load_dwordx4 v1, s[8:11], s18 offen offset:0 sc1 lds
    buffer_load_dwordx4 v1, s[8:11], s18 offen offset:1024 sc1 lds
    s_add_u32 s18, s18, 4096
    s_sub_u32 s32, s32, 1
    s_cmp_eq_u32 s32, 0
    s_cselect_b32 s3, 40960, 0
    s_sub_u32 s18, s18, s3
    s_lshl_b32 s7, s15, 10
    s_cmp_ge_u32 s15, 2
    s_cbranch_scc1 L_k_cw_131
    s_add_u32 m0, s7, 49152
    s_add_u32 s3, s19, 8192
    buffer_load_dwordx4 v1, s[8:11], s3 offen lds
L_k_cw_131:
    s_add_u32 m0, s7, 40960
    s_add_u32 s3, s19, 4096
    buffer_load_dwordx4 v1, s[8:11], s19 offen lds
    s_add_u32 m0, s7, 45056
    s_add_u32 s19, s19, 10240
    buffer_load_dwordx4 v1, s[8:11], s3 offen lds
    s_sub_u32 s33, s33, 1
    s_cmp_eq_u32 s33, 0
    s_cselect_b32 s3, 102400, 0
    s_sub_u32 s19, s19, s3
    s_waitcnt vmcnt(12)
    s_barrier
    s_mov_b32 s30, 0xfffffff
    s_mov_b32 s31, 0x0
    s_mov_b32 s29, 0x8000
L_k_gl_132:
    s_andn2_b64 vcc, s[30:31], s[24:25]
    s_cbranch_scc0 L_k_go_133
    s_sub_u32 s29, s29, 1
    s_cbranch_scc1 L_k_go_133
    buffer_load_dword v9, v8, s[8:11], s28 offen sc1
    s_waitcnt vmcnt(0)
    v_cmp_eq_u32 s[24:25], s50, v9
    s_nop 0
    s_branch L_k_gl_132
L_k_go_133:
    s_add_u32 m0, s21, 61440
    s_nop 0
    buffer_load_dwordx4 v1, s[8:11], s18 offen offset:0 sc1 lds
    buffer_load_dwordx4 v1, s[8:11], s18 offen offset:1024 sc1 lds
    s_add_u32 s18, s18, 4096
    s_sub_u32 s32, s32, 1
    s_cmp_eq_u32 s32, 0
    s_cselect_b32 s3, 40960, 0
    s_sub_u32 s18, s18, s3
    s_lshl_b32 s7, s15, 10
    s_cmp_ge_u32 s15, 2
    s_cbranch_scc1 L_k_cw_134
    s_add_u32 m0, s7, 69632
    s_add_u32 s3, s19, 8192
    buffer_load_dwordx4 v1, s[8:11], s3 offen lds
L_k_cw_134:
    s_add_u32 m0, s7, 61440
    s_add_u32 s3, s19, 4096
    buffer_load_dwordx4 v1, s[8:11], s19 offen lds
    s_add_u32 m0, s7, 65536
    s_add_u32 s19, s19, 10240
    buffer_load_dwordx4 v1, s[8:11], s3 offen lds
    s_sub_u32 s33, s33, 1
    s_cmp_eq_u32 s33, 0
    s_cselect_b32 s3, 102400, 0
    s_sub_u32 s19, s19, s3
    s_waitcnt vmcnt(12)
    s_barrier
    s_mov_b32 s30, 0xffffffff
    s_mov_b32 s31, 0x0
    s_mov_b32 s29, 0x8000
L_k_gl_135:
    s_andn2_b64 vcc, s[30:31], s[24:25]
    s_cbranch_scc0 L_k_go_136
    s_sub_u32 s29, s29, 1
    s_cbranch_scc1 L_k_go_136
    buffer_load_dword v9, v8, s[8:11], s28 offen sc1
    s_waitcnt vmcnt(0)
    v_cmp_eq_u32 s[24:25], s50, v9
    s_nop 0
    s_branch L_k_gl_135
L_k_go_136:
    s_add_u32 m0, s21, 81920
    s_nop 0
    buffer_load_dwordx4 v1, s[8:11], s18 offen offset:0 sc1 lds
    buffer_load_dwordx4 v1, s[8:11], s18 offen offset:1024 sc1 lds
    s_add_u32 s18, s18, 4096
    s_sub_u32 s32, s32, 1
    s_cmp_eq_u32 s32, 0
    s_cselect_b32 s3, 40960, 0
    s_sub_u32 s18, s18, s3
    s_lshl_b32 s7, s15, 10
    s_cmp_ge_u32 s15, 2
    s_cbranch_scc1 L_k_cw_137
    s_add_u32 m0, s7, 90112
    s_add_u32 s3, s19, 8192
    buffer_load_dwordx4 v1, s[8:11], s3 offen lds
L_k_cw_137:
    s_add_u32 m0, s7, 81920
    s_add_u32 s3, s19, 4096
    buffer_load_dwordx4 v1, s[8:11], s19 offen lds
    s_add_u32 m0, s7, 86016
    s_add_u32 s19, s19, 10240
    buffer_load_dwordx4 v1, s[8:11], s3 offen lds
    s_sub_u32 s33, s33, 1
    s_cmp_eq_u32 s33, 0
    s_cselect_b32 s3, 102400, 0
    s_sub_u32 s19, s19, s3
    s_waitcnt vmcnt(12)
    s_barrier
    s_add_u32 m0, s21, 102400
    s_nop 0
    buffer_load_dwordx4 v1, s[8:11], s18 offen offset:0 sc1 lds
    buffer_load_dwordx4 v1, s[8:11], s18 offen offset:1024 sc1 lds
    s_add_u32 s18, s18, 4096
    s_sub_u32 s32, s32, 1
    s_cmp_eq_u32 s32, 0
    s_cselect_b32 s3, 40960, 0
    s_sub_u32 s18, s18, s3
    s_lshl_b32 s7, s15, 10
    s_cmp_ge_u32 s15, 2
    s_cbranch_scc1 L_k_cw_138
    s_add_u32 m0, s7, 110592
    s_add_u32 s3, s19, 8192
    buffer_load_dwordx4 v1, s[8:11], s3 offen lds
L_k_cw_138:
    s_add_u32 m0, s7, 102400
    s_add_u32 s3, s19, 4096
    buffer_load_dwordx4 v1, s[8:11], s19 offen lds
    s_add_u32 m0, s7, 106496
    s_add_u32 s19, s19, 10240
    buffer_load_dwordx4 v1, s[8:11], s3 offen lds
    s_sub_u32 s33, s33, 1
    s_cmp_eq_u32 s33, 0
    s_cselect_b32 s3, 102400, 0
    s_sub_u32 s19, s19, s3
    s_waitcnt vmcnt(12)
    s_barrier
    s_add_u32 m0, s21, 0
    s_nop 0
    buffer_load_dwordx4 v1, s[8:11], s18 offen offset:0 sc1 lds
    buffer_load_dwordx4 v1, s[8:11], s18 offen offset:1024 sc1 lds
    s_add_u32 s18, s18, 4096
    s_sub_u32 s32, s32, 1
    s_cmp_eq_u32 s32, 0
    s_cselect_b32 s3, 40960, 0
    s_sub_u32 s18, s18, s3
    s_lshl_b32 s7, s15, 10
    s_cmp_ge_u32 s15, 2
    s_cbranch_scc1 L_k_cw_139
    s_add_u32 m0, s7, 8192
    s_add_u32 s3, s19, 8192
    buffer_load_dwordx4 v1, s[8:11], s3 offen lds
L_k_cw_139:
    s_add_u32 m0, s7, 0
    s_add_u32 s3, s19, 4096
    buffer_load_dwordx4 v1, s[8:11], s19 offen lds
    s_add_u32 m0, s7, 4096
    s_add_u32 s19, s19, 10240
    buffer_load_dwordx4 v1, s[8:11], s3 offen lds
    s_sub_u32 s33, s33, 1
    s_cmp_eq_u32 s33, 0
    s_cselect_b32 s3, 102400, 0
    s_sub_u32 s19, s19, s3
    s_waitcnt vmcnt(12)
    s_barrier
    s_add_u32 m0, s20, 20480
    s_nop 0
    buffer_load_dwordx4 v1, s[8:11], s23 offen offset:0  lds
    buffer_load_dwordx4 v1, s[8:11], s23 offen offset:1024  lds
    buffer_load_dwordx4 v1, s[8:11], s23 offen offset:2048  lds
    s_add_u32 s23, s23, 12288
    s_sub_u32 s36, s36, 1
    s_cmp_eq_u32 s36, 0
    s_cselect_b32 s3, 245760, 0
    s_sub_u32 s23, s23, s3
    s_waitcnt vmcnt(11)
    s_barrier
    s_add_u32 m0, s20, 40960
    s_nop 0
    buffer_load_dwordx4 v1, s[8:11], s23 offen offset:0  lds
    buffer_load_dwordx4 v1, s[8:11], s23 offen offset:1024  lds
    buffer_load_dwordx4 v1, s[8:11], s23 offen offset:2048  lds
    s_add_u32 s23, s23, 12288
    s_sub_u32 s36, s36, 1
    s_cmp_eq_u32 s36, 0
    s_cselect_b32 s3, 245760, 0
    s_sub_u32 s23, s23, s3
    s_waitcnt vmcnt(10)
    s_barrier
    s_add_u32 m0, s20, 61440
    s_nop 0
    buffer_load_dwordx4 v1, s[8:11], s23 offen offset:0  lds
    buffer_load_dwordx4 v1, s[8:11], s23 offen offset:1024  lds
    buffer_load_dwordx4 v1, s[8:11], s23 offen offset:2048  lds
    s_add_u32 s23, s23, 12288
    s_sub_u32 s36, s36, 1
    s_cmp_eq_u32 s36, 0
    s_cselect_b32 s3, 245760, 0
    s_sub_u32 s23, s23, s3
    s_waitcnt vmcnt(9)
    s_barrier
    s_add_u32 m0, s20, 81920
    s_nop 0
    buffer_load_dwordx4 v1, s[8:11], s23 offen offset:0  lds
    buffer_load_dwordx4 v1, s[8:11], s23 offen offset:1024  lds
    buffer_load_dwordx4 v1, s[8:11], s23 offen offset:2048  lds
    s_add_u32 s23, s23, 12288
    s_sub_u32 s36, s36, 1
    s_cmp_eq_u32 s36, 0
    s_cselect_b32 s3, 245760, 0
    s_sub_u32 s23, s23, s3
    s_lshl_b32 s3, s12, 8
    s_add_u32 s3, s3, 0x18000
    v_lshrrev_b32 v8, 2, v1
    v_min_u32 v8, 60, v8
    s_mov_b32 s29, 0x8000
L_k_hp_140:
    buffer_load_dword v9, v8, s[8:11], s3 offen sc1
    s_waitcnt vmcnt(0)
    v_cmp_ne_u32 vcc, s50, v9
    s_sub_u32 s29, s29, 1
    s_cbranch_scc1 L_k_ho_141
    s_cbranch_vccnz L_k_hp_140
L_k_ho_141:
    s_lshl_b32 s3, s12, 8
    s_add_u32 s3, s3, 0x10020
    v_lshrrev_b32 v8, 2, v1
    v_min_u32 v8, 188, v8
    s_mov_b32 s29, 0x8000
L_k_hp_142:
    buffer_load_dword v9, v8, s[8:11], s3 offen sc1
    s_waitcnt vmcnt(0)
    v_cmp_ne_u32 vcc, s50, v9
    s_sub_u32 s29, s29, 1
    s_cbranch_scc1 L_k_ho_143
    s_cbranch_vccnz L_k_hp_142
L_k_ho_143:
    s_add_u32 m0, s26, 20480
    s_nop 0
    buffer_load_dwordx4 v1, s[8:11], s22 offen offset:0 sc1 lds
    s_add_u32 s22, s22, 2048
    s_sub_u32 s35, s35, 1
    s_cmp_eq_u32 s35, 0
    s_cselect_b32 s3, 40960, 0
    s_sub_u32 s22, s22, s3
    s_waitcnt vmcnt(0)
    s_barrier
    s_add_u32 m0, s26, 40960
    s_nop 0
    buffer_load_dwordx4 v1, s[8:11], s22 offen offset:0 sc1 lds
    s_add_u32 s22, s22, 2048
    s_sub_u32 s35, s35, 1
    s_cmp_eq_u32 s35, 0
    s_cselect_b32 s3, 40960, 0
    s_sub_u32 s22, s22, s3
    s_add_u32 m0, s26, 61440
    s_nop 0
    buffer_load_dwordx4 v1, s[8:11], s22 offen offset:0 sc1 lds
    s_add_u32 s22, s22, 2048
    s_sub_u32 s35, s35, 1
    s_cmp_eq_u32 s35, 0
    s_cselect_b32 s3, 40960, 0
    s_sub_u32 s22, s22, s3
    s_add_u32 m0, s26, 81920
    s_nop 0
    buffer_load_dwordx4 v1, s[8:11], s22 offen offset:0 sc1 lds
    s_add_u32 s22, s22, 2048
    s_sub_u32 s35, s35, 1
    s_cmp_eq_u32 s35, 0
    s_cselect_b32 s3, 40960, 0
    s_sub_u32 s22, s22, s3
    s_mul_i32 s6, s12, 12288
    s_add_u32 s6, s6, s20
    s_add_u32 s6, s6, 0x1300000
    s_add_u32 m0, s20, 126976
    s_nop 0
    buffer_load_dwordx4 v1, s[8:11], s6 offen offset:0 sc1 lds
    buffer_load_dwordx4 v1, s[8:11], s6 offen offset:1024 sc1 lds
    buffer_load_dwordx4 v1, s[8:11], s6 offen offset:2048 sc1 lds
    s_add_u32 m0, s26, 102400
    s_nop 0
    buffer_load_dwordx4 v1, s[8:11], s22 offen offset:0 sc1 lds
    s_add_u32 s22, s22, 2048
    s_sub_u32 s35, s35, 1
    s_cmp_eq_u32 s35, 0
    s_cselect_b32 s3, 40960, 0
    s_sub_u32 s22, s22, s3
    s_add_u32 m0, s20, 102400
    s_nop 0
    buffer_load_dwordx4 v1, s[8:11], s23 offen offset:0  lds
    buffer_load_dwordx4 v1, s[8:11], s23 offen offset:1024  lds
    buffer_load_dwordx4 v1, s[8:11], s23 offen offset:2048  lds
    s_add_u32 s23, s23, 12288
    s_sub_u32 s36, s36, 1
    s_cmp_eq_u32 s36, 0
    s_cselect_b32 s3, 245760, 0
    s_sub_u32 s23, s23, s3
    s_mul_i32 s21, s15, 2048
    s_add_u32 s21, s21, 12288
    s_mul_i32 s18, s16, 131072
    s_and_b32 s3, s15, 1
    s_mul_i32 s3, s3, 2048
    s_add_u32 s18, s18, s3
    s_add_u32 s18, s18, 0x1d00000
    s_mul_i32 s19, s13, 393216
    s_add_u32 s19, s19, s20
    s_add_u32 s19, s19, 0x16c0000
    s_and_b32 s3, s12, 7
    s_mul_i32 s3, s3, 8
    s_lshr_b32 s3, s3, 1
    s_sub_u32 s38, 32, s3
    s_mov_b32 s39, s38
    s_mul_i32 s6, s3, 4096
    s_add_u32 s18, s18, s6
    s_mul_i32 s6, s3, 12288
    s_add_u32 s19, s19, s6
    s_waitcnt vmcnt(9)
    s_barrier
    s_add_u32 m0, s26, 0
    s_nop 0
    buffer_load_dwordx4 v1, s[8:11], s22 offen offset:0 sc1 lds
    s_add_u32 s22, s22, 2048
    s_sub_u32 s35, s35, 1
    s_cmp_eq_u32 s35, 0
    s_cselect_b32 s3, 40960, 0
    s_sub_u32 s22, s22, s3
    s_add_u32 m0, s20, 0
    s_nop 0
    buffer_load_dwordx4 v1, s[8:11], s23 offen offset:0  lds
    buffer_load_dwordx4 v1, s[8:11], s23 offen offset:1024  lds
    buffer_load_dwordx4 v1, s[8:11], s23 offen offset:2048  lds
    s_add_u32 s23, s23, 12288
    s_sub_u32 s36, s36, 1
    s_cmp_eq_u32 s36, 0
    s_cselect_b32 s3, 245760, 0
    s_sub_u32 s23, s23, s3
    s_waitcnt vmcnt(12)
    s_barrier
    s_add_u32 m0, s26, 20480
    s_nop 0
    buffer_load_dwordx4 v1, s[8:11], s22 offen offset:0 sc1 lds
    s_add_u32 s22, s22, 2048
    s_sub_u32 s35, s35, 1
    s_cmp_eq_u32 s35, 0
    s_cselect_b32 s3, 40960, 0
    s_sub_u32 s22, s22, s3
    s_add_u32 m0, s20, 20480
    s_nop 0
    buffer_load_dwordx4 v1, s[8:11], s23 offen offset:0  lds
    buffer_load_dwordx4 v1, s[8:11], s23 offen offset:1024  lds
    buffer_load_dwordx4 v1, s[8:11], s23 offen offset:2048  lds
    s_add_u32 s23, s23, 12288
    s_sub_u32 s36, s36, 1
    s_cmp_eq_u32 s36, 0
    s_cselect_b32 s3, 245760, 0
    s_sub_u32 s23, s23, s3
    s_waitcnt vmcnt(15)
    s_barrier
    s_add_u32 m0, s26, 40960
    s_nop 0
    buffer_load_dwordx4 v1, s[8:11], s22 offen offset:0 sc1 lds
    s_add_u32 s22, s22, 2048
    s_sub_u32 s35, s35, 1
    s_cmp_eq_u32 s35, 0
    s_cselect_b32 s3, 40960, 0
    s_sub_u32 s22, s22, s3
    s_add_u32 m0, s20, 40960
    s_nop 0
    buffer_load_dwordx4 v1, s[8:11], s23 offen offset:0  lds
    buffer_load_dwordx4 v1, s[8:11], s23 offen offset:1024  lds
    buffer_load_dwordx4 v1, s[8:11], s23 offen offset:2048  lds
    s_add_u32 s23, s23, 12288
    s_sub_u32 s36, s36, 1
    s_cmp_eq_u32 s36, 0
    s_cselect_b32 s3, 245760, 0
    s_sub_u32 s23, s23, s3
    s_waitcnt vmcnt(12)
    s_barrier
    s_add_u32 m0, s26, 61440
    s_nop 0
    buffer_load_dwordx4 v1, s[8:11], s22 offen offset:0 sc1 lds
    s_add_u32 s22, s22, 2048
    s_sub_u32 s35, s35, 1
    s_cmp_eq_u32 s35, 0
    s_cselect_b32 s3, 40960, 0
    s_sub_u32 s22, s22, s3
    s_add_u32 m0, s20, 61440
    s_nop 0
    buffer_load_dwordx4 v1, s[8:11], s23 offen offset:0  lds
    buffer_load_dwordx4 v1, s[8:11], s23 offen offset:1024  lds
    buffer_load_dwordx4 v1, s[8:11], s23 offen offset:2048  lds
    s_add_u32 s23, s23, 12288
    s_sub_u32 s36, s36, 1
    s_cmp_eq_u32 s36, 0
    s_cselect_b32 s3, 245760, 0
    s_sub_u32 s23, s23, s3
    s_waitcnt vmcnt(12)
    s_barrier
    s_add_u32 m0, s26, 81920
    s_nop 0
    buffer_load_dwordx4 v1, s[8:11], s22 offen offset:0 sc1 lds
    s_add_u32 s22, s22, 2048
    s_sub_u32 s35, s35, 1
    s_cmp_eq_u32 s35, 0
    s_cselect_b32 s3, 40960, 0
    s_sub_u32 s22, s22, s3
    s_add_u32 m0, s20, 81920
    s_nop 0
    buffer_load_dwordx4 v1, s[8:11], s23 offen offset:0  lds
    buffer_load_dwordx4 v1, s[8:11], s23 offen offset:1024  lds
    buffer_load_dwordx4 v1, s[8:11], s23 offen offset:2048  lds
    s_add_u32 s23, s23, 12288
    s_sub_u32 s36, s36, 1
    s_cmp_eq_u32 s36, 0
    s_cselect_b32 s3, 245760, 0
    s_sub_u32 s23, s23, s3
    s_waitcnt vmcnt(12)
    s_barrier
    s_add_u32 m0, s26, 102400
    s_nop 0
    buffer_load_dwordx4 v1, s[8:11], s22 offen offset:0 sc1 lds
    s_add_u32 s22, s22, 2048
    s_sub_u32 s35, s35, 1
    s_cmp_eq_u32 s35, 0
    s_cselect_b32 s3, 40960, 0
    s_sub_u32 s22, s22, s3
    s_add_u32 m0, s20, 102400
    s_nop 0
    buffer_load_dwordx4 v1, s[8:11], s23 offen offset:0  lds
    buffer_load_dwordx4 v1, s[8:11], s23 offen offset:1024  lds
    buffer_load_dwordx4 v1, s[8:11], s23 offen offset:2048  lds
    s_add_u32 s23, s23, 12288
    s_sub_u32 s36, s36, 1
    s_cmp_eq_u32 s36, 0
    s_cselect_b32 s3, 245760, 0
    s_sub_u32 s23, s23, s3
    s_waitcnt vmcnt(12)
    s_barrier
    s_add_u32 m0, s26, 0
    s_nop 0
    buffer_load_dwordx4 v1, s[8:11], s22 offen offset:0 sc1 lds
    s_add_u32 s22, s22, 2048
    s_sub_u32 s35, s35, 1
    s_cmp_eq_u32 s35, 0
    s_cselect_b32 s3, 40960, 0
    s_sub_u32 s22, s22, s3
    s_add_u32 m0, s20, 0
    s_nop 0
    buffer_load_dwordx4 v1, s[8:11], s23 offen offset:0  lds
    buffer_load_dwordx4 v1, s[8:11], s23 offen offset:1024  lds
    buffer_load_dwordx4 v1, s[8:11], s23 offen offset:2048  lds
    s_add_u32 s23, s23, 12288
    s_sub_u32 s36, s36, 1
    s_cmp_eq_u32 s36, 0
    s_cselect_b32 s3, 245760, 0
    s_sub_u32 s23, s23, s3
    s_waitcnt vmcnt(12)
    s_barrier
    s_add_u32 m0, s26, 20480
    s_nop 0
    buffer_load_dwordx4 v1, s[8:11], s22 offen offset:0 sc1 lds
    s_add_u32 s22, s22, 2048
    s_sub_u32 s35, s35, 1
    s_cmp_eq_u32 s35, 0
    s_cselect_b32 s3, 40960, 0
    s_sub_u32 s22, s22, s3
    s_add_u32 m0, s20, 20480
    s_nop 0
    buffer_load_dwordx4 v1, s[8:11], s23 offen offset:0  lds
    buffer_load_dwordx4 v1, s[8:11], s23 offen offset:1024  lds
    buffer_load_dwordx4 v1, s[8:11], s23 offen offset:2048  lds
    s_add_u32 s23, s23, 12288
    s_sub_u32 s36, s36, 1
    s_cmp_eq_u32 s36, 0
    s_cselect_b32 s3, 245760, 0
    s_sub_u32 s23, s23, s3
    s_waitcnt vmcnt(12)
    s_barrier
    s_add_u32 m0, s26, 40960
    s_nop 0
    buffer_load_dwordx4 v1, s[8:11], s22 offen offset:0 sc1 lds
    s_add_u32 s22, s22, 2048
    s_sub_u32 s35, s35, 1
    s_cmp_eq_u32 s35, 0
    s_cselect_b32 s3, 40960, 0
    s_sub_u32 s22, s22, s3
    s_add_u32 m0, s20, 40960
    s_nop 0
    buffer_load_dwordx4 v1, s[8:11], s23 offen offset:0  lds
    buffer_load_dwordx4 v1, s[8:11], s23 offen offset:1024  lds
    buffer_load_dwordx4 v1, s[8:11], s23 offen offset:2048  lds
    s_add_u32 s23, s23, 12288
    s_sub_u32 s36, s36, 1
    s_cmp_eq_u32 s36, 0
    s_cselect_b32 s3, 245760, 0
    s_sub_u32 s23, s23, s3
    s_waitcnt vmcnt(12)
    s_barrier
    s_add_u32 m0, s26, 61440
    s_nop 0
    buffer_load_dwordx4 v1, s[8:11], s22 offen offset:0 sc1 lds
    s_add_u32 s22, s22, 2048
    s_sub_u32 s35, s35, 1
    s_cmp_eq_u32 s35, 0
    s_cselect_b32 s3, 40960, 0
    s_sub_u32 s22, s22, s3
    s_add_u32 m0, s20, 61440
    s_nop 0
    buffer_load_dwordx4 v1, s[8:11], s23 offen offset:0  lds
    buffer_load_dwordx4 v1, s[8:11], s23 offen offset:1024  lds
    buffer_load_dwordx4 v1, s[8:11], s23 offen offset:2048  lds
    s_add_u32 s23, s23, 12288
    s_sub_u32 s36, s36, 1
    s_cmp_eq_u32 s36, 0
    s_cselect_b32 s3, 245760, 0
    s_sub_u32 s23, s23, s3
    s_waitcnt vmcnt(12)
    s_barrier
    s_add_u32 m0, s26, 81920
    s_nop 0
    buffer_load_dwordx4 v1, s[8:11], s22 offen offset:0 sc1 lds
    s_add_u32 s22, s22, 2048
    s_sub_u32 s35, s35, 1
    s_cmp_eq_u32 s35, 0
    s_cselect_b32 s3, 40960, 0
    s_sub_u32 s22, s22, s3
    s_add_u32 m0, s20, 81920
    s_nop 0
    buffer_load_dwordx4 v1, s[8:11], s23 offen offset:0  lds
    buffer_load_dwordx4 v1, s[8:11], s23 offen offset:1024  lds
    buffer_load_dwordx4 v1, s[8:11], s23 offen offset:2048  lds
    s_add_u32 s23, s23, 12288
    s_sub_u32 s36, s36, 1
    s_cmp_eq_u32 s36, 0
    s_cselect_b32 s3, 245760, 0
    s_sub_u32 s23, s23, s3
    s_waitcnt vmcnt(12)
    s_barrier
    s_add_u32 m0, s26, 102400
    s_nop 0
    buffer_load_dwordx4 v1, s[8:11], s22 offen offset:0 sc1 lds
    s_add_u32 s22, s22, 2048
    s_sub_u32 s35, s35, 1
    s_cmp_eq_u32 s35, 0
    s_cselect_b32 s3, 40960, 0
    s_sub_u32 s22, s22, s3
    s_add_u32 m0, s20, 102400
    s_nop 0
    buffer_load_dwordx4 v1, s[8:11], s23 offen offset:0  lds
    buffer_load_dwordx4 v1, s[8:11], s23 offen offset:1024  lds
    buffer_load_dwordx4 v1, s[8:11], s23 offen offset:2048  lds
    s_add_u32 s23, s23, 12288
    s_sub_u32 s36, s36, 1
    s_cmp_eq_u32 s36, 0
    s_cselect_b32 s3, 245760, 0
    s_sub_u32 s23, s23, s3
    s_waitcnt vmcnt(12)
    s_barrier
    s_add_u32 m0, s26, 0
    s_nop 0
    buffer_load_dwordx4 v1, s[8:11], s22 offen offset:0 sc1 lds
    s_add_u32 s22, s22, 2048
    s_sub_u32 s35, s35, 1
    s_cmp_eq_u32 s35, 0
    s_cselect_b32 s3, 40960, 0
    s_sub_u32 s22, s22, s3
    s_add_u32 m0, s20, 0
    s_nop 0
    buffer_load_dwordx4 v1, s[8:11], s23 offen offset:0  lds
    buffer_load_dwordx4 v1, s[8:11], s23 offen offset:1024  lds
    buffer_load_dwordx4 v1, s[8:11], s23 offen offset:2048  lds
    s_add_u32 s23, s23, 12288
    s_sub_u32 s36, s36, 1
    s_cmp_eq_u32 s36, 0
    s_cselect_b32 s3, 245760, 0
    s_sub_u32 s23, s23, s3
    s_waitcnt vmcnt(12)
    s_barrier
    s_add_u32 m0, s26, 20480
    s_nop 0
    buffer_load_dwordx4 v1, s[8:11], s22 offen offset:0 sc1 lds
    s_add_u32 s22, s22, 2048
    s_sub_u32 s35, s35, 1
    s_cmp_eq_u32 s35, 0
    s_cselect_b32 s3, 40960, 0
    s_sub_u32 s22, s22, s3
    s_add_u32 m0, s20, 20480
    s_nop 0
    buffer_load_dwordx4 v1, s[8:11], s23 offen offset:0  lds
    buffer_load_dwordx4 v1, s[8:11], s23 offen offset:1024  lds
    buffer_load_dwordx4 v1, s[8:11], s23 offen offset:2048  lds
    s_add_u32 s23, s23, 12288
    s_sub_u32 s36, s36, 1
    s_cmp_eq_u32 s36, 0
    s_cselect_b32 s3, 245760, 0
    s_sub_u32 s23, s23, s3
    s_waitcnt vmcnt(12)
    s_barrier
    s_add_u32 m0, s26, 40960
    s_nop 0
    buffer_load_dwordx4 v1, s[8:11], s22 offen offset:0 sc1 lds
    s_add_u32 s22, s22, 2048
    s_sub_u32 s35, s35, 1
    s_cmp_eq_u32 s35, 0
    s_cselect_b32 s3, 40960, 0
    s_sub_u32 s22, s22, s3
    s_add_u32 m0, s20, 40960
    s_nop 0
    buffer_load_dwordx4 v1, s[8:11], s23 offen offset:0  lds
    buffer_load_dwordx4 v1, s[8:11], s23 offen offset:1024  lds
    buffer_load_dwordx4 v1, s[8:11], s23 offen offset:2048  lds
    s_add_u32 s23, s23, 12288
    s_sub_u32 s36, s36, 1
    s_cmp_eq_u32 s36, 0
    s_cselect_b32 s3, 245760, 0
    s_sub_u32 s23, s23, s3
    s_waitcnt vmcnt(12)
    s_barrier
    s_waitcnt vmcnt(8)
    s_barrier
    s_waitcnt vmcnt(4)
    s_barrier
    s_waitcnt vmcnt(0)
    s_barrier
    s_mul_i32 s30, s13, 4608
    s_add_u32 s30, s30, 0x6a800
    v_lshrrev_b32 v4, 4, v1
    v_min_u32 v4, 35, v4
    v_lshlrev_b32 v4, 7, v4
    v_mov_b32 v12, 159788
    s_cmp_lg_u32 s15, 0
    s_cbranch_scc1 L_k_gw_146
    s_mov_b32 s29, 0x8000
L_k_gp_144:
    buffer_load_dword v6, v4, s[8:11], s30 offen sc1
    s_waitcnt vmcnt(0)
    v_xor_b32 v6, s50, v6
    v_cmp_ne_u32 vcc, 0, v6
    s_sub_u32 s29, s29, 1
    s_cbranch_scc1 L_k_go_145
    s_cbranch_vccz L_k_go_145
    s_sleep 2
    s_branch L_k_gp_144
L_k_go_145:
    v_mov_b32 v13, 1
    ds_write_b32 v12, v13
    s_waitcnt lgkmcnt(0)
    s_branch L_k_gd_147
L_k_gw_146:
    ds_read_b32 v13, v12
    s_waitcnt lgkmcnt(0)
    v_readfirstlane_b32 s3, v13
    s_cmp_eq_u32 s3, 1
    s_cbranch_scc1 L_k_gd_147
    s_sleep 1
    s_branch L_k_gw_146
L_k_gd_147:
    s_waitcnt vmcnt(0)
    s_barrier
    s_add_u32 m0, s21, 61440
    s_nop 0
    buffer_load_dwordx4 v1, s[8:11], s18 offen offset:0 sc1 lds
    buffer_load_dwordx4 v1, s[8:11], s18 offen offset:1024 sc1 lds
    s_add_u32 s18, s18, 4096
    s_sub_u32 s38, s38, 1
    s_cmp_eq_u32 s38, 0
    s_cselect_b32 s3, 131072, 0
    s_sub_u32 s18, s18, s3
    s_add_u32 m0, s21, 81920
    s_nop 0
    buffer_load_dwordx4 v1, s[8:11], s18 offen offset:0 sc1 lds
    buffer_load_dwordx4 v1, s[8:11], s18 offen offset:1024 sc1 lds
    s_add_u32 s18, s18, 4096
    s_sub_u32 s38, s38, 1
    s_cmp_eq_u32 s38, 0
    s_cselect_b32 s3, 131072, 0
    s_sub_u32 s18, s18, s3
    s_add_u32 m0, s21, 102400
    s_nop 0
    buffer_load_dwordx4 v1, s[8:11], s18 offen offset:0 sc1 lds
    buffer_load_dwordx4 v1, s[8:11], s18 offen offset:1024 sc1 lds
    s_add_u32 s18, s18, 4096
    s_sub_u32 s38, s38, 1
    s_cmp_eq_u32 s38, 0
    s_cselect_b32 s3, 131072, 0
    s_sub_u32 s18, s18, s3
    s_add_u32 m0, s21, 0
    s_nop 0
    buffer_load_dwordx4 v1, s[8:11], s18 offen offset:0 sc1 lds
    buffer_load_dwordx4 v1, s[8:11], s18 offen offset:1024 sc1 lds
    s_add_u32 s18, s18, 4096
    s_sub_u32 s38, s38, 1
    s_cmp_eq_u32 s38, 0
    s_cselect_b32 s3, 131072, 0
    s_sub_u32 s18, s18, s3
    s_mul_i32 s26, s15, 2048
    s_add_u32 s26, s26, 12288
    s_mul_i32 s22, s16, 49152
    s_and_b32 s3, s15, 1
    s_mul_i32 s3, s3, 2048
    s_add_u32 s22, s22, s3
    s_add_u32 s22, s22, 0xe00000
    s_mul_i32 s3, s12, 65536
    s_add_u32 s22, s22, s3
    s_mul_i32 s23, s13, 147456
    s_add_u32 s23, s23, s20
    s_add_u32 s23, s23, 0x800000
    s_mul_i32 s23, s13, 122880
    s_lshl_b32 s3, s15, 10
    s_add_u32 s23, s23, s3
    s_add_u32 s23, s23, 0x800000
    s_and_b32 s3, s12, 7
    s_mul_i32 s3, s3, 3
    s_lshr_b32 s3, s3, 1
    s_sub_u32 s32, 12, s3
    s_mov_b32 s33, s32
    s_mul_i32 s6, s3, 4096
    s_add_u32 s22, s22, s6
    s_mul_i32 s6, s3, 10240
    s_add_u32 s23, s23, s6
    s_lshl_b32 s28, s13, 12
    s_add_u32 s28, s28, 0x4c000
    s_and_b32 s3, s12, 7
    s_lshl_b32 s3, s3, 2
    v_add_u32 v8, s3, v2
    v_and_b32 v8, 31, v8
    v_lshlrev_b32 v8, 7, v8
    s_mov_b32 s24, 0
    s_mov_b32 s25, 0
    s_lshl_b32 s25, s25, 1
    s_or_b32 s25, s25, 1
    s_mov_b32 s29, 0x8000
L_k_zl_148:
    s_andn2_b32 s3, s25, s24
    s_cbranch_scc0 L_k_zo_149
    s_sub_u32 s29, s29, 1
    s_cbranch_scc1 L_k_zo_149
    buffer_load_dword v9, v8, s[8:11], s28 offen sc1
    s_waitcnt vmcnt(0)
    v_cmp_eq_u32 vcc, s50, v9
    s_nop 0
    s_mov_b32 s24, vcc_lo
    s_branch L_k_zl_148
L_k_zo_149:
    s_add_u32 m0, s20, 61440
    s_nop 0
    buffer_load_dwordx4 v1, s[8:11], s19 offen offset:0 sc1 lds
    buffer_load_dwordx4 v1, s[8:11], s19 offen offset:1024 sc1 lds
    buffer_load_dwordx4 v1, s[8:11], s19 offen offset:2048 sc1 lds
    s_add_u32 s19, s19, 12288
    s_sub_u32 s39, s39, 1
    s_cmp_eq_u32 s39, 0
    s_cselect_b32 s3, 393216, 0
    s_sub_u32 s19, s19, s3
    s_waitcnt vmcnt(0)
    s_barrier
    s_lshl_b32 s25, s25, 1
    s_or_b32 s25, s25, 1
    s_mov_b32 s29, 0x8000
L_k_zl_150:
    s_andn2_b32 s3, s25, s24
    s_cbranch_scc0 L_k_zo_151
    s_sub_u32 s29, s29, 1
    s_cbranch_scc1 L_k_zo_151
    buffer_load_dword v9, v8, s[8:11], s28 offen sc1
    s_waitcnt vmcnt(0)
    v_cmp_eq_u32 vcc, s50, v9
    s_nop 0
    s_mov_b32 s24, vcc_lo
    s_branch L_k_zl_150
L_k_zo_151:
    s_add_u32 m0, s20, 81920
    s_nop 0
    buffer_load_dwordx4 v1, s[8:11], s19 offen offset:0 sc1 lds
    buffer_load_dwordx4 v1, s[8:11], s19 offen offset:1024 sc1 lds
    buffer_load_dwordx4 v1, s[8:11], s19 offen offset:2048 sc1 lds
    s_add_u32 s19, s19, 12288
    s_sub_u32 s39, s39, 1
    s_cmp_eq_u32 s39, 0
    s_cselect_b32 s3, 393216, 0
    s_sub_u32 s19, s19, s3
    s_lshl_b32 s25, s25, 1
    s_or_b32 s25, s25, 1
    s_mov_b32 s29, 0x8000
L_k_zl_152:
    s_andn2_b32 s3, s25, s24
    s_cbranch_scc0 L_k_zo_153
    s_sub_u32 s29, s29, 1
    s_cbranch_scc1 L_k_zo_153
    buffer_load_dword v9, v8, s[8:11], s28 offen sc1
    s_waitcnt vmcnt(0)
    v_cmp_eq_u32 vcc, s50, v9
    s_nop 0
    s_mov_b32 s24, vcc_lo
    s_branch L_k_zl_152
L_k_zo_153:
    s_add_u32 m0, s20, 102400
    s_nop 0
    buffer_load_dwordx4 v1, s[8:11], s19 offen offset:0 sc1 lds
    buffer_load_dwordx4 v1, s[8:11], s19 offen offset:1024 sc1 lds
    buffer_load_dwordx4 v1, s[8:11], s19 offen offset:2048 sc1 lds
    s_add_u32 s19, s19, 12288
    s_sub_u32 s39, s39, 1
    s_cmp_eq_u32 s39, 0
    s_cselect_b32 s3, 393216, 0
    s_sub_u32 s19, s19, s3
    s_lshl_b32 s25, s25, 1
    s_or_b32 s25, s25, 1
    s_mov_b32 s29, 0x8000
L_k_zl_154:
    s_andn2_b32 s3, s25, s24
    s_cbranch_scc0 L_k_zo_155
    s_sub_u32 s29, s29, 1
    s_cbranch_scc1 L_k_zo_155
    buffer_load_dword v9, v8, s[8:11], s28 offen sc1
    s_waitcnt vmcnt(0)
    v_cmp_eq_u32 vcc, s50, v9
    s_nop 0
    s_mov_b32 s24, vcc_lo
    s_branch L_k_zl_154
L_k_zo_155:
    s_add_u32 m0, s20, 0
    s_nop 0
    buffer_load_dwordx4 v1, s[8:11], s19 offen offset:0 sc1 lds
    buffer_load_dwordx4 v1, s[8:11], s19 offen offset:1024 sc1 lds
    buffer_load_dwordx4 v1, s[8:11], s19 offen offset:2048 sc1 lds
    s_add_u32 s19, s19, 12288
    s_sub_u32 s39, s39, 1
    s_cmp_eq_u32 s39, 0
    s_cselect_b32 s3, 393216, 0
    s_sub_u32 s19, s19, s3
    s_add_u32 m0, s21, 20480
    s_nop 0
    buffer_load_dwordx4 v1, s[8:11], s18 offen offset:0 sc1 lds
    buffer_load_dwordx4 v1, s[8:11], s18 offen offset:1024 sc1 lds
    s_add_u32 s18, s18, 4096
    s_sub_u32 s38, s38, 1
    s_cmp_eq_u32 s38, 0
    s_cselect_b32 s3, 131072, 0
    s_sub_u32 s18, s18, s3
    s_lshl_b32 s25, s25, 1
    s_or_b32 s25, s25, 1
    s_mov_b32 s29, 0x8000
L_k_zl_156:
    s_andn2_b32 s3, s25, s24
    s_cbranch_scc0 L_k_zo_157
    s_sub_u32 s29, s29, 1
    s_cbranch_scc1 L_k_zo_157
    buffer_load_dword v9, v8, s[8:11], s28 offen sc1
    s_waitcnt vmcnt(0)
    v_cmp_eq_u32 vcc, s50, v9
    s_nop 0
    s_mov_b32 s24, vcc_lo
    s_branch L_k_zl_156
L_k_zo_157:
    s_add_u32 m0, s20, 20480
    s_nop 0
    buffer_load_dwordx4 v1, s[8:11], s19 offen offset:0 sc1 lds
    buffer_load_dwordx4 v1, s[8:11], s19 offen offset:1024 sc1 lds
    buffer_load_dwordx4 v1, s[8:11], s19 offen offset:2048 sc1 lds
    s_add_u32 s19, s19, 12288
    s_sub_u32 s39, s39, 1
    s_cmp_eq_u32 s39, 0
    s_cselect_b32 s3, 393216, 0
    s_sub_u32 s19, s19, s3
    s_waitcnt vmcnt(11)
    s_barrier
    s_add_u32 m0, s21, 40960
    s_nop 0
    buffer_load_dwordx4 v1, s[8:11], s18 offen offset:0 sc1 lds
    buffer_load_dwordx4 v1, s[8:11], s18 offen offset:1024 sc1 lds
    s_add_u32 s18, s18, 4096
    s_sub_u32 s38, s38, 1
    s_cmp_eq_u32 s38, 0
    s_cselect_b32 s3, 131072, 0
    s_sub_u32 s18, s18, s3
    s_lshl_b32 s25, s25, 1
    s_or_b32 s25, s25, 1
    s_mov_b32 s29, 0x8000
L_k_zl_158:
    s_andn2_b32 s3, s25, s24
    s_cbranch_scc0 L_k_zo_159
    s_sub_u32 s29, s29, 1
    s_cbranch_scc1 L_k_zo_159
    buffer_load_dword v9, v8, s[8:11], s28 offen sc1
    s_waitcnt vmcnt(0)
    v_cmp_eq_u32 vcc, s50, v9
    s_nop 0
    s_mov_b32 s24, vcc_lo
    s_branch L_k_zl_158
L_k_zo_159:
    s_add_u32 m0, s20, 40960
    s_nop 0
    buffer_load_dwordx4 v1, s[8:11], s19 offen offset:0 sc1 lds
    buffer_load_dwordx4 v1, s[8:11], s19 offen offset:1024 sc1 lds
    buffer_load_dwordx4 v1, s[8:11], s19 offen offset:2048 sc1 lds
    s_add_u32 s19, s19, 12288
    s_sub_u32 s39, s39, 1
    s_cmp_eq_u32 s39, 0
    s_cselect_b32 s3, 393216, 0
    s_sub_u32 s19, s19, s3
    s_mov_b32 s30, 4
L_k_lloop:
    s_waitcnt vmcnt(13)
    s_barrier
    s_add_u32 m0, s21, 61440
    s_nop 0
    buffer_load_dwordx4 v1, s[8:11], s18 offen offset:0 sc1 lds
    buffer_load_dwordx4 v1, s[8:11], s18 offen offset:1024 sc1 lds
    s_add_u32 s18, s18, 4096
    s_sub_u32 s38, s38, 1
    s_cmp_eq_u32 s38, 0
    s_cselect_b32 s3, 131072, 0
    s_sub_u32 s18, s18, s3
    s_lshl_b32 s25, s25, 1
    s_or_b32 s25, s25, 1
    s_mov_b32 s29, 0x8000
L_k_zl_160:
    s_andn2_b32 s3, s25, s24
    s_cbranch_scc0 L_k_zo_161
    s_sub_u32 s29, s29, 1
    s_cbranch_scc1 L_k_zo_161
    buffer_load_dword v9, v8, s[8:11], s28 offen sc1
    s_waitcnt vmcnt(0)
    v_cmp_eq_u32 vcc, s50, v9
    s_nop 0
    s_mov_b32 s24, vcc_lo
    s_branch L_k_zl_160
L_k_zo_161:
    s_add_u32 m0, s20, 61440
    s_nop 0
    buffer_load_dwordx4 v1, s[8:11], s19 offen offset:0 sc1 lds
    buffer_load_dwordx4 v1, s[8:11], s19 offen offset:1024 sc1 lds
    buffer_load_dwordx4 v1, s[8:11], s19 offen offset:2048 sc1 lds
    s_add_u32 s19, s19, 12288
    s_sub_u32 s39, s39, 1
    s_cmp_eq_u32 s39, 0
    s_cselect_b32 s3, 393216, 0
    s_sub_u32 s19, s19, s3
    s_waitcnt vmcnt(15)
    s_barrier
    s_add_u32 m0, s21, 81920
    s_nop 0
    buffer_load_dwordx4 v1, s[8:11], s18 offen offset:0 sc1 lds
    buffer_load_dwordx4 v1, s[8:11], s18 offen offset:1024 sc1 lds
    s_add_u32 s18, s18, 4096
    s_sub_u32 s38, s38, 1
    s_cmp_eq_u32 s38, 0
    s_cselect_b32 s3, 131072, 0
    s_sub_u32 s18, s18, s3
    s_lshl_b32 s25, s25, 1
    s_or_b32 s25, s25, 1
    s_mov_b32 s29, 0x8000
L_k_zl_162:
    s_andn2_b32 s3, s25, s24
    s_cbranch_scc0 L_k_zo_163
    s_sub_u32 s29, s29, 1
    s_cbranch_scc1 L_k_zo_163
    buffer_load_dword v9, v8, s[8:11], s28 offen sc1
    s_waitcnt vmcnt(0)
    v_cmp_eq_u32 vcc, s50, v9
    s_nop 0
    s_mov_b32 s24, vcc_lo
    s_branch L_k_zl_162
L_k_zo_163:
    s_add_u32 m0, s20, 81920
    s_nop 0
    buffer_load_dwordx4 v1, s[8:11], s19 offen offset:0 sc1 lds
    buffer_load_dwordx4 v1, s[8:11], s19 offen offset:1024 sc1 lds
    buffer_load_dwordx4 v1, s[8:11], s19 offen offset:2048 sc1 lds
    s_add_u32 s19, s19, 12288
    s_sub_u32 s39, s39, 1
    s_cmp_eq_u32 s39, 0
    s_cselect_b32 s3, 393216, 0
    s_sub_u32 s19, s19, s3
    s_waitcnt vmcnt(15)
    s_barrier
    s_add_u32 m0, s21, 102400
    s_nop 0
    buffer_load_dwordx4 v1, s[8:11], s18 offen offset:0 sc1 lds
    buffer_load_dwordx4 v1, s[8:11], s18 offen offset:1024 sc1 lds
    s_add_u32 s18, s18, 4096
    s_sub_u32 s38, s38, 1
    s_cmp_eq_u32 s38, 0
    s_cselect_b32 s3, 131072, 0
    s_sub_u32 s18, s18, s3
    s_lshl_b32 s25, s25, 1
    s_or_b32 s25, s25, 1
    s_mov_b32 s29, 0x8000
L_k_zl_164:
    s_andn2_b32 s3, s25, s24
    s_cbranch_scc0 L_k_zo_165
    s_sub_u32 s29, s29, 1
    s_cbranch_scc1 L_k_zo_165
    buffer_load_dword v9, v8, s[8:11], s28 offen sc1
    s_waitcnt vmcnt(0)
    v_cmp_eq_u32 vcc, s50, v9
    s_nop 0
    s_mov_b32 s24, vcc_lo
    s_branch L_k_zl_164
L_k_zo_165:
    s_add_u32 m0, s20, 102400
    s_nop 0
    buffer_load_dwordx4 v1, s[8:11], s19 offen offset:0 sc1 lds
    buffer_load_dwordx4 v1, s[8:11], s19 offen offset:1024 sc1 lds
    buffer_load_dwordx4 v1, s[8:11], s19 offen offset:2048 sc1 lds
    s_add_u32 s19, s19, 12288
    s_sub_u32 s39, s39, 1
    s_cmp_eq_u32 s39, 0
    s_cselect_b32 s3, 393216, 0
    s_sub_u32 s19, s19, s3
    s_waitcnt vmcnt(15)
    s_barrier
    s_add_u32 m0, s21, 0
    s_nop 0
    buffer_load_dwordx4 v1, s[8:11], s18 offen offset:0 sc1 lds
    buffer_load_dwordx4 v1, s[8:11], s18 offen offset:1024 sc1 lds
    s_add_u32 s18, s18, 4096
    s_sub_u32 s38, s38, 1
    s_cmp_eq_u32 s38, 0
    s_cselect_b32 s3, 131072, 0
    s_sub_u32 s18, s18, s3
    s_lshl_b32 s25, s25, 1
    s_or_b32 s25, s25, 1
    s_mov_b32 s29, 0x8000
L_k_zl_166:
    s_andn2_b32 s3, s25, s24
    s_cbranch_scc0 L_k_zo_167
    s_sub_u32 s29, s29, 1
    s_cbranch_scc1 L_k_zo_167
    buffer_load_dword v9, v8, s[8:11], s28 offen sc1
    s_waitcnt vmcnt(0)
    v_cmp_eq_u32 vcc, s50, v9
    s_nop 0
    s_mov_b32 s24, vcc_lo
    s_branch L_k_zl_166
L_k_zo_167:
    s_add_u32 m0, s20, 0
    s_nop 0
    buffer_load_dwordx4 v1, s[8:11], s19 offen offset:0 sc1 lds
    buffer_load_dwordx4 v1, s[8:11], s19 offen offset:1024 sc1 lds
    buffer_load_dwordx4 v1, s[8:11], s19 offen offset:2048 sc1 lds
    s_add_u32 s19, s19, 12288
    s_sub_u32 s39, s39, 1
    s_cmp_eq_u32 s39, 0
    s_cselect_b32 s3, 393216, 0
    s_sub_u32 s19, s19, s3
    s_waitcnt vmcnt(15)
    s_barrier
    s_add_u32 m0, s21, 20480
    s_nop 0
    buffer_load_dwordx4 v1, s[8:11], s18 offen offset:0 sc1 lds
    buffer_load_dwordx4 v1, s[8:11], s18 offen offset:1024 sc1 lds
    s_add_u32 s18, s18, 4096
    s_sub_u32 s38, s38, 1
    s_cmp_eq_u32 s38, 0
    s_cselect_b32 s3, 131072, 0
    s_sub_u32 s18, s18, s3
    s_lshl_b32 s25, s25, 1
    s_or_b32 s25, s25, 1
    s_mov_b32 s29, 0x8000
L_k_zl_168:
    s_andn2_b32 s3, s25, s24
    s_cbranch_scc0 L_k_zo_169
    s_sub_u32 s29, s29, 1
    s_cbranch_scc1 L_k_zo_169
    buffer_load_dword v9, v8, s[8:11], s28 offen sc1
    s_waitcnt vmcnt(0)
    v_cmp_eq_u32 vcc, s50, v9
    s_nop 0
    s_mov_b32 s24, vcc_lo
    s_branch L_k_zl_168
L_k_zo_169:
    s_add_u32 m0, s20, 20480
    s_nop 0
    buffer_load_dwordx4 v1, s[8:11], s19 offen offset:0 sc1 lds
    buffer_load_dwordx4 v1, s[8:11], s19 offen offset:1024 sc1 lds
    buffer_load_dwordx4 v1, s[8:11], s19 offen offset:2048 sc1 lds
    s_add_u32 s19, s19, 12288
    s_sub_u32 s39, s39, 1
    s_cmp_eq_u32 s39, 0
    s_cselect_b32 s3, 393216, 0
    s_sub_u32 s19, s19, s3
    s_waitcnt vmcnt(15)
    s_barrier
    s_add_u32 m0, s21, 40960
    s_nop 0
    buffer_load_dwordx4 v1, s[8:11], s18 offen offset:0 sc1 lds
    buffer_load_dwordx4 v1, s[8:11], s18 offen offset:1024 sc1 lds
    s_add_u32 s18, s18, 4096
    s_sub_u32 s38, s38, 1
    s_cmp_eq_u32 s38, 0
    s_cselect_b32 s3, 131072, 0
    s_sub_u32 s18, s18, s3
    s_lshl_b32 s25, s25, 1
    s_or_b32 s25, s25, 1
    s_mov_b32 s29, 0x8000
L_k_zl_170:
    s_andn2_b32 s3, s25, s24
    s_cbranch_scc0 L_k_zo_171
    s_sub_u32 s29, s29, 1
    s_cbranch_scc1 L_k_zo_171
    buffer_load_dword v9, v8, s[8:11], s28 offen sc1
    s_waitcnt vmcnt(0)
    v_cmp_eq_u32 vcc, s50, v9
    s_nop 0
    s_mov_b32 s24, vcc_lo
    s_branch L_k_zl_170
L_k_zo_171:
    s_add_u32 m0, s20, 40960
    s_nop 0
    buffer_load_dwordx4 v1, s[8:11], s19 offen offset:0 sc1 lds
    buffer_load_dwordx4 v1, s[8:11], s19 offen offset:1024 sc1 lds
    buffer_load_dwordx4 v1, s[8:11], s19 offen offset:2048 sc1 lds
    s_add_u32 s19, s19, 12288
    s_sub_u32 s39, s39, 1
    s_cmp_eq_u32 s39, 0
    s_cselect_b32 s3, 393216, 0
    s_sub_u32 s19, s19, s3
    s_sub_u32 s30, s30, 1
    s_cmp_lg_u32 s30, 0
    s_cbranch_scc1 L_k_lloop
    s_waitcnt vmcnt(15)
    s_barrier
    s_add_u32 m0, s21, 61440
    s_nop 0
    buffer_load_dwordx4 v1, s[8:11], s18 offen offset:0 sc1 lds
    buffer_load_dwordx4 v1, s[8:11], s18 offen offset:1024 sc1 lds
    s_add_u32 s18, s18, 4096
    s_sub_u32 s38, s38, 1
    s_cmp_eq_u32 s38, 0
    s_cselect_b32 s3, 131072, 0
    s_sub_u32 s18, s18, s3
    s_lshl_b32 s25, s25, 1
    s_or_b32 s25, s25, 1
    s_mov_b32 s29, 0x8000
L_k_zl_172:
    s_andn2_b32 s3, s25, s24
    s_cbranch_scc0 L_k_zo_173
    s_sub_u32 s29, s29, 1
    s_cbranch_scc1 L_k_zo_173
    buffer_load_dword v9, v8, s[8:11], s28 offen sc1
    s_waitcnt vmcnt(0)
    v_cmp_eq_u32 vcc, s50, v9
    s_nop 0
    s_mov_b32 s24, vcc_lo
    s_branch L_k_zl_172
L_k_zo_173:
    s_add_u32 m0, s20, 61440
    s_nop 0
    buffer_load_dwordx4 v1, s[8:11], s19 offen offset:0 sc1 lds
    buffer_load_dwordx4 v1, s[8:11], s19 offen offset:1024 sc1 lds
    buffer_load_dwordx4 v1, s[8:11], s19 offen offset:2048 sc1 lds
    s_add_u32 s19, s19, 12288
    s_sub_u32 s39, s39, 1
    s_cmp_eq_u32 s39, 0
    s_cselect_b32 s3, 393216, 0
    s_sub_u32 s19, s19, s3
    s_waitcnt vmcnt(15)
    s_barrier
    s_add_u32 m0, s21, 81920
    s_nop 0
    buffer_load_dwordx4 v1, s[8:11], s18 offen offset:0 sc1 lds
    buffer_load_dwordx4 v1, s[8:11], s18 offen offset:1024 sc1 lds
    s_add_u32 s18, s18, 4096
    s_sub_u32 s38, s38, 1
    s_cmp_eq_u32 s38, 0
    s_cselect_b32 s3, 131072, 0
    s_sub_u32 s18, s18, s3
    s_lshl_b32 s25, s25, 1
    s_or_b32 s25, s25, 1
    s_mov_b32 s29, 0x8000
L_k_zl_174:
    s_andn2_b32 s3, s25, s24
    s_cbranch_scc0 L_k_zo_175
    s_sub_u32 s29, s29, 1
    s_cbranch_scc1 L_k_zo_175
    buffer_load_dword v9, v8, s[8:11], s28 offen sc1
    s_waitcnt vmcnt(0)
    v_cmp_eq_u32 vcc, s50, v9
    s_nop 0
    s_mov_b32 s24, vcc_lo
    s_branch L_k_zl_174
L_k_zo_175:
    s_add_u32 m0, s20, 81920
    s_nop 0
    buffer_load_dwordx4 v1, s[8:11], s19 offen offset:0 sc1 lds
    buffer_load_dwordx4 v1, s[8:11], s19 offen offset:1024 sc1 lds
    buffer_load_dwordx4 v1, s[8:11], s19 offen offset:2048 sc1 lds
    s_add_u32 s19, s19, 12288
    s_sub_u32 s39, s39, 1
    s_cmp_eq_u32 s39, 0
    s_cselect_b32 s3, 393216, 0
    s_sub_u32 s19, s19, s3
    s_waitcnt vmcnt(15)
    s_barrier
    s_lshl_b32 s7, s15, 10
    s_cmp_ge_u32 s15, 2
    s_cbranch_scc1 L_k_cw_176
    s_add_u32 m0, s7, 110592
    s_add_u32 s3, s23, 8192
    buffer_load_dwordx4 v1, s[8:11], s3 offen lds
L_k_cw_176:
    s_add_u32 m0, s7, 102400
    s_add_u32 s3, s23, 4096
    buffer_load_dwordx4 v1, s[8:11], s23 offen lds
    s_add_u32 m0, s7, 106496
    s_add_u32 s23, s23, 10240
    buffer_load_dwordx4 v1, s[8:11], s3 offen lds
    s_sub_u32 s33, s33, 1
    s_cmp_eq_u32 s33, 0
    s_cselect_b32 s3, 122880, 0
    s_sub_u32 s23, s23, s3
    s_waitcnt vmcnt(12)
    s_barrier
    s_lshl_b32 s7, s15, 10
    s_cmp_ge_u32 s15, 2
    s_cbranch_scc1 L_k_cw_177
    s_add_u32 m0, s7, 8192
    s_add_u32 s3, s23, 8192
    buffer_load_dwordx4 v1, s[8:11], s3 offen lds
L_k_cw_177:
    s_add_u32 m0, s7, 0
    s_add_u32 s3, s23, 4096
    buffer_load_dwordx4 v1, s[8:11], s23 offen lds
    s_add_u32 m0, s7, 4096
    s_add_u32 s23, s23, 10240
    buffer_load_dwordx4 v1, s[8:11], s3 offen lds
    s_sub_u32 s33, s33, 1
    s_cmp_eq_u32 s33, 0
    s_cselect_b32 s3, 122880, 0
    s_sub_u32 s23, s23, s3
    s_waitcnt vmcnt(9)
    s_barrier
    s_lshl_b32 s7, s15, 10
    s_cmp_ge_u32 s15, 2
    s_cbranch_scc1 L_k_cw_178
    s_add_u32 m0, s7, 28672
    s_add_u32 s3, s23, 8192
    buffer_load_dwordx4 v1, s[8:11], s3 offen lds
L_k_cw_178:
    s_add_u32 m0, s7, 20480
    s_add_u32 s3, s23, 4096
    buffer_load_dwordx4 v1, s[8:11], s23 offen lds
    s_add_u32 m0, s7, 24576
    s_add_u32 s23, s23, 10240
    buffer_load_dwordx4 v1, s[8:11], s3 offen lds
    s_sub_u32 s33, s33, 1
    s_cmp_eq_u32 s33, 0
    s_cselect_b32 s3, 122880, 0
    s_sub_u32 s23, s23, s3
    s_waitcnt vmcnt(6)
    s_barrier
    s_lshl_b32 s7, s15, 10
    s_cmp_ge_u32 s15, 2
    s_cbranch_scc1 L_k_cw_179
    s_add_u32 m0, s7, 49152
    s_add_u32 s3, s23, 8192
    buffer_load_dwordx4 v1, s[8:11], s3 offen lds
L_k_cw_179:
    s_add_u32 m0, s7, 40960
    s_add_u32 s3, s23, 4096
    buffer_load_dwordx4 v1, s[8:11], s23 offen lds
    s_add_u32 m0, s7, 45056
    s_add_u32 s23, s23, 10240
    buffer_load_dwordx4 v1, s[8:11], s3 offen lds
    s_sub_u32 s33, s33, 1
    s_cmp_eq_u32 s33, 0
    s_cselect_b32 s3, 122880, 0
    s_sub_u32 s23, s23, s3
    s_lshl_b32 s3, s12, 8
    s_add_u32 s3, s3, 0x12020
    v_lshrrev_b32 v8, 2, v1
    v_min_u32 v8, 188, v8
    s_mov_b32 s29, 0x8000
L_k_hp_180:
    buffer_load_dword v9, v8, s[8:11], s3 offen sc1
    s_waitcnt vmcnt(0)
    v_cmp_ne_u32 vcc, s50, v9
    s_sub_u32 s29, s29, 1
    s_cbranch_scc1 L_k_ho_181
    s_cbranch_vccnz L_k_hp_180
L_k_ho_181:
    s_add_u32 m0, s26, 102400
    s_nop 0
    buffer_load_dwordx4 v1, s[8:11], s22 offen offset:0 sc1 lds
    buffer_load_dwordx4 v1, s[8:11], s22 offen offset:1024 sc1 lds
    s_add_u32 s22, s22, 4096
    s_sub_u32 s32, s32, 1
    s_cmp_eq_u32 s32, 0
    s_cselect_b32 s3, 49152, 0
    s_sub_u32 s22, s22, s3
    s_waitcnt vmcnt(0)
    s_barrier
    s_add_u32 m0, s26, 0
    s_nop 0
    buffer_load_dwordx4 v1, s[8:11], s22 offen offset:0 sc1 lds
    buffer_load_dwordx4 v1, s[8:11], s22 offen offset:1024 sc1 lds
    s_add_u32 s22, s22, 4096
    s_sub_u32 s32, s32, 1
    s_cmp_eq_u32 s32, 0
    s_cselect_b32 s3, 49152, 0
    s_sub_u32 s22, s22, s3
    s_add_u32 m0, s26, 20480
    s_nop 0
    buffer_load_dwordx4 v1, s[8:11], s22 offen offset:0 sc1 lds
    buffer_load_dwordx4 v1, s[8:11], s22 offen offset:1024 sc1 lds
    s_add_u32 s22, s22, 4096
    s_sub_u32 s32, s32, 1
    s_cmp_eq_u32 s32, 0
    s_cselect_b32 s3, 49152, 0
    s_sub_u32 s22, s22, s3
    s_add_u32 m0, s26, 40960
    s_nop 0
    buffer_load_dwordx4 v1, s[8:11], s22 offen offset:0 sc1 lds
    buffer_load_dwordx4 v1, s[8:11], s22 offen offset:1024 sc1 lds
    s_add_u32 s22, s22, 4096
    s_sub_u32 s32, s32, 1
    s_cmp_eq_u32 s32, 0
    s_cselect_b32 s3, 49152, 0
    s_sub_u32 s22, s22, s3
    s_add_u32 m0, s26, 61440
    s_nop 0
    buffer_load_dwordx4 v1, s[8:11], s22 offen offset:0 sc1 lds
    buffer_load_dwordx4 v1, s[8:11], s22 offen offset:1024 sc1 lds
    s_add_u32 s22, s22, 4096
    s_sub_u32 s32, s32, 1
    s_cmp_eq_u32 s32, 0
    s_cselect_b32 s3, 49152, 0
    s_sub_u32 s22, s22, s3
    s_lshl_b32 s7, s15, 10
    s_cmp_ge_u32 s15, 2
    s_cbranch_scc1 L_k_cw_182
    s_add_u32 m0, s7, 69632
    s_add_u32 s3, s23, 8192
    buffer_load_dwordx4 v1, s[8:11], s3 offen lds
L_k_cw_182:
    s_add_u32 m0, s7, 61440
    s_add_u32 s3, s23, 4096
    buffer_load_dwordx4 v1, s[8:11], s23 offen lds
    s_add_u32 m0, s7, 65536
    s_add_u32 s23, s23, 10240
    buffer_load_dwordx4 v1, s[8:11], s3 offen lds
    s_sub_u32 s33, s33, 1
    s_cmp_eq_u32 s33, 0
    s_cselect_b32 s3, 122880, 0
    s_sub_u32 s23, s23, s3
    s_waitcnt vmcnt(8)
    s_barrier
    s_add_u32 m0, s26, 81920
    s_nop 0
    buffer_load_dwordx4 v1, s[8:11], s22 offen offset:0 sc1 lds
    buffer_load_dwordx4 v1, s[8:11], s22 offen offset:1024 sc1 lds
    s_add_u32 s22, s22, 4096
    s_sub_u32 s32, s32, 1
    s_cmp_eq_u32 s32, 0
    s_cselect_b32 s3, 49152, 0
    s_sub_u32 s22, s22, s3
    s_lshl_b32 s7, s15, 10
    s_cmp_ge_u32 s15, 2
    s_cbranch_scc1 L_k_cw_183
    s_add_u32 m0, s7, 90112
    s_add_u32 s3, s23, 8192
    buffer_load_dwordx4 v1, s[8:11], s3 offen lds
L_k_cw_183:
    s_add_u32 m0, s7, 81920
    s_add_u32 s3, s23, 4096
    buffer_load_dwordx4 v1, s[8:11], s23 offen lds
    s_add_u32 m0, s7, 86016
    s_add_u32 s23, s23, 10240
    buffer_load_dwordx4 v1, s[8:11], s3 offen lds
    s_sub_u32 s33, s33, 1
    s_cmp_eq_u32 s33, 0
    s_cselect_b32 s3, 122880, 0
    s_sub_u32 s23, s23, s3
    s_waitcnt vmcnt(10)
    s_barrier
    s_add_u32 m0, s26, 102400
    s_nop 0
    buffer_load_dwordx4 v1, s[8:11], s22 offen offset:0 sc1 lds
    buffer_load_dwordx4 v1, s[8:11], s22 offen offset:1024 sc1 lds
    s_add_u32 s22, s22, 4096
    s_sub_u32 s32, s32, 1
    s_cmp_eq_u32 s32, 0
    s_cselect_b32 s3, 49152, 0
    s_sub_u32 s22, s22, s3
    s_lshl_b32 s7, s15, 10
    s_cmp_ge_u32 s15, 2
    s_cbranch_scc1 L_k_cw_184
    s_add_u32 m0, s7, 110592
    s_add_u32 s3, s23, 8192
    buffer_load_dwordx4 v1, s[8:11], s3 offen lds
L_k_cw_184:
    s_add_u32 m0, s7, 102400
    s_add_u32 s3, s23, 4096
    buffer_load_dwordx4 v1, s[8:11], s23 offen lds
    s_add_u32 m0, s7, 106496
    s_add_u32 s23, s23, 10240
    buffer_load_dwordx4 v1, s[8:11], s3 offen lds
    s_sub_u32 s33, s33, 1
    s_cmp_eq_u32 s33, 0
    s_cselect_b32 s3, 122880, 0
    s_sub_u32 s23, s23, s3
    s_waitcnt vmcnt(12)
    s_barrier
    s_add_u32 m0, s26, 0
    s_nop 0
    buffer_load_dwordx4 v1, s[8:11], s22 offen offset:0 sc1 lds
    buffer_load_dwordx4 v1, s[8:11], s22 offen offset:1024 sc1 lds
    s_add_u32 s22, s22, 4096
    s_sub_u32 s32, s32, 1
    s_cmp_eq_u32 s32, 0
    s_cselect_b32 s3, 49152, 0
    s_sub_u32 s22, s22, s3
    s_lshl_b32 s7, s15, 10
    s_cmp_ge_u32 s15, 2
    s_cbranch_scc1 L_k_cw_185
    s_add_u32 m0, s7, 8192
    s_add_u32 s3, s23, 8192
    buffer_load_dwordx4 v1, s[8:11], s3 offen lds
L_k_cw_185:
    s_add_u32 m0, s7, 0
    s_add_u32 s3, s23, 4096
    buffer_load_dwordx4 v1, s[8:11], s23 offen lds
    s_add_u32 m0, s7, 4096
    s_add_u32 s23, s23, 10240
    buffer_load_dwordx4 v1, s[8:11], s3 offen lds
    s_sub_u32 s33, s33, 1
    s_cmp_eq_u32 s33, 0
    s_cselect_b32 s3, 122880, 0
    s_sub_u32 s23, s23, s3
    s_waitcnt vmcnt(12)
    s_barrier
    s_add_u32 m0, s26, 20480
    s_nop 0
    buffer_load_dwordx4 v1, s[8:11], s22 offen offset:0 sc1 lds
    buffer_load_dwordx4 v1, s[8:11], s22 offen offset:1024 sc1 lds
    s_add_u32 s22, s22, 4096
    s_sub_u32 s32, s32, 1
    s_cmp_eq_u32 s32, 0
    s_cselect_b32 s3, 49152, 0
    s_sub_u32 s22, s22, s3
    s_lshl_b32 s7, s15, 10
    s_cmp_ge_u32 s15, 2
    s_cbranch_scc1 L_k_cw_186
    s_add_u32 m0, s7, 28672
    s_add_u32 s3, s23, 8192
    buffer_load_dwordx4 v1, s[8:11], s3 offen lds
L_k_cw_186:
    s_add_u32 m0, s7, 20480
    s_add_u32 s3, s23, 4096
    buffer_load_dwordx4 v1, s[8:11], s23 offen lds
    s_add_u32 m0, s7, 24576
    s_add_u32 s23, s23, 10240
    buffer_load_dwordx4 v1, s[8:11], s3 offen lds
    s_sub_u32 s33, s33, 1
    s_cmp_eq_u32 s33, 0
    s_cselect_b32 s3, 122880, 0
    s_sub_u32 s23, s23, s3
    s_waitcnt vmcnt(12)
    s_barrier
    s_add_u32 m0, s26, 40960
    s_nop 0
    buffer_load_dwordx4 v1, s[8:11], s22 offen offset:0 sc1 lds
    buffer_load_dwordx4 v1, s[8:11], s22 offen offset:1024 sc1 lds
    s_add_u32 s22, s22, 4096
    s_sub_u32 s32, s32, 1
    s_cmp_eq_u32 s32, 0
    s_cselect_b32 s3, 49152, 0
    s_sub_u32 s22, s22, s3
    s_lshl_b32 s7, s15, 10
    s_cmp_ge_u32 s15, 2
    s_cbranch_scc1 L_k_cw_187
    s_add_u32 m0, s7, 49152
    s_add_u32 s3, s23, 8192
    buffer_load_dwordx4 v1, s[8:11], s3 offen lds
L_k_cw_187:
    s_add_u32 m0, s7, 40960
    s_add_u32 s3, s23, 4096
    buffer_load_dwordx4 v1, s[8:11], s23 offen lds
    s_add_u32 m0, s7, 45056
    s_add_u32 s23, s23, 10240
    buffer_load_dwordx4 v1, s[8:11], s3 offen lds
    s_sub_u32 s33, s33, 1
    s_cmp_eq_u32 s33, 0
    s_cselect_b32 s3, 122880, 0
    s_sub_u32 s23, s23, s3
    s_waitcnt vmcnt(12)
    s_barrier
    s_add_u32 m0, s26, 61440
    s_nop 0
    buffer_load_dwordx4 v1, s[8:11], s22 offen offset:0 sc1 lds
    buffer_load_dwordx4 v1, s[8:11], s22 offen offset:1024 sc1 lds
    s_add_u32 s22, s22, 4096
    s_sub_u32 s32, s32, 1
    s_cmp_eq_u32 s32, 0
    s_cselect_b32 s3, 49152, 0
    s_sub_u32 s22, s22, s3
    s_lshl_b32 s7, s15, 10
    s_cmp_ge_u32 s15, 2
    s_cbranch_scc1 L_k_cw_188
    s_add_u32 m0, s7, 69632
    s_add_u32 s3, s23, 8192
    buffer_load_dwordx4 v1, s[8:11], s3 offen lds
L_k_cw_188:
    s_add_u32 m0, s7, 61440
    s_add_u32 s3, s23, 4096
    buffer_load_dwordx4 v1, s[8:11], s23 offen lds
    s_add_u32 m0, s7, 65536
    s_add_u32 s23, s23, 10240
    buffer_load_dwordx4 v1, s[8:11], s3 offen lds
    s_sub_u32 s33, s33, 1
    s_cmp_eq_u32 s33, 0
    s_cselect_b32 s3, 122880, 0
    s_sub_u32 s23, s23, s3
    s_waitcnt vmcnt(12)
    s_barrier
    s_add_u32 m0, s26, 81920
    s_nop 0
    buffer_load_dwordx4 v1, s[8:11], s22 offen offset:0 sc1 lds
    buffer_load_dwordx4 v1, s[8:11], s22 offen offset:1024 sc1 lds
    s_add_u32 s22, s22, 4096
    s_sub_u32 s32, s32, 1
    s_cmp_eq_u32 s32, 0
    s_cselect_b32 s3, 49152, 0
    s_sub_u32 s22, s22, s3
    s_lshl_b32 s7, s15, 10
    s_cmp_ge_u32 s15, 2
    s_cbranch_scc1 L_k_cw_189
    s_add_u32 m0, s7, 90112
    s_add_u32 s3, s23, 8192
    buffer_load_dwordx4 v1, s[8:11], s3 offen lds
L_k_cw_189:
    s_add_u32 m0, s7, 81920
    s_add_u32 s3, s23, 4096
    buffer_load_dwordx4 v1, s[8:11], s23 offen lds
    s_add_u32 m0, s7, 86016
    s_add_u32 s23, s23, 10240
    buffer_load_dwordx4 v1, s[8:11], s3 offen lds
    s_sub_u32 s33, s33, 1
    s_cmp_eq_u32 s33, 0
    s_cselect_b32 s3, 122880, 0
    s_sub_u32 s23, s23, s3
    s_waitcnt vmcnt(12)
    s_barrier
    s_waitcnt vmcnt(8)
    s_barrier
    s_waitcnt vmcnt(4)
    s_barrier
    s_waitcnt vmcnt(0)
    s_barrier
L_k_end:
L_k_exit:
    s_endpgm
L_k_textend:

.section .rodata,"a"
.p2align 6
.amdhsa_kernel adaLN_cond__grouped_kv_mqa__mixer_gmlp__prompt_kernel
  .amdhsa_next_free_vgpr 168
  .amdhsa_next_free_sgpr 64
  .amdhsa_accum_offset 168
  .amdhsa_group_segment_fixed_size 0
  .amdhsa_kernarg_size 120
  .amdhsa_user_sgpr_count 2
  .amdhsa_user_sgpr_kernarg_segment_ptr 1
  .amdhsa_system_sgpr_workgroup_id_x 1
.end_amdhsa_kernel
```
